```python
import torch

def _softmax(x, axis=-1):
    return torch.softmax(x, dim=axis)
def _gelu(x):
    return torch.nn.functional.gelu(x, approximate="tanh")
def _silu(x):
    return torch.nn.functional.silu(x)
def _sigmoid(x):
    return torch.sigmoid(x)
def _layernorm(x, axis=-1, eps=1e-5):
    m = x.mean(dim=axis, keepdim=True)
    v = x.var(dim=axis, keepdim=True, unbiased=False)
    return (x - m) / torch.sqrt(v + eps)
def _scatter_add(tgt, idx, src, axis=0):
    return tgt.clone().index_add_(axis, idx, src)
def _segment_sum(src, seg, n):
    out = torch.zeros((n,) + src.shape[1:], dtype=src.dtype)
    return out.index_add_(0, seg, src)
def _pad(x, pw):
    flat = tuple(v for pair in reversed(pw) for v in pair)
    return torch.nn.functional.pad(x, flat)

kernel_name = 'interleave_layers__ssm_conv_s4__geglu_ffn__prompt'

def setup_inputs():

    _w = (lambda a: (lambda t: t.to(torch.bfloat16) if t.is_floating_point() else t)(torch.as_tensor(a)))
    def _A_setup():
        B, L, D, N = 1, 2048, 512, 128
        A_re = -(lambda _x: torch.exp(torch.as_tensor(_x)))((lambda *s: torch.randn(*s, dtype=torch.bfloat16) * 1.6)(D, N))
        A_im = torch.pi * (lambda *s: torch.randn(*s, dtype=torch.bfloat16) * 0.2)(D, N)
        B_re = (lambda *s: torch.randn(*s, dtype=torch.bfloat16) * 0.2)(D, N)
        B_im = (lambda *s: torch.randn(*s, dtype=torch.bfloat16) * 0.2)(D, N)
        C_re = (lambda *s: torch.randn(*s, dtype=torch.bfloat16) * 0.2)(D, N)
        C_im = (lambda *s: torch.randn(*s, dtype=torch.bfloat16) * 0.2)(D, N)
        log_dt = (lambda *s: torch.randn(*s, dtype=torch.bfloat16) * 0.2)(D) * 0.5 - 4.0
        Dskip = (lambda *s: torch.randn(*s, dtype=torch.bfloat16) * 0.2)(D)
        return {
            "u": _w((lambda *s: torch.randn(*s, dtype=torch.bfloat16) * 0.05)(B, L, D)),
            "A_re": _w(A_re),
            "A_im": _w(A_im),
            "B_re": _w(B_re),
            "B_im": _w(B_im),
            "C_re": _w(C_re),
            "C_im": _w(C_im),
            "log_dt": _w(log_dt),
            "Dskip": _w(Dskip),
        }
    _A_in = _A_setup()

    def _B_setup():
        B, S, D, F = 1, 2048, 512, 1376
        return {
            "x": _w((lambda *s: torch.randn(*s, dtype=torch.bfloat16) * 0.05)(B, S, D)),
            "w_gate": _w((lambda *s: torch.randn(*s, dtype=torch.bfloat16) * 0.05)(D, F)),
            "w_up": _w((lambda *s: torch.randn(*s, dtype=torch.bfloat16) * 0.05)(D, F)),
            "w_down": _w((lambda *s: torch.randn(*s, dtype=torch.bfloat16) * 0.05)(F, D)),
        }
    _B_in = _B_setup()

    return {
        "A_u": _A_in["u"],
        "A_A_re": _A_in["A_re"],
        "A_A_im": _A_in["A_im"],
        "A_B_re": _A_in["B_re"],
        "A_B_im": _A_in["B_im"],
        "A_C_re": _A_in["C_re"],
        "A_C_im": _A_in["C_im"],
        "A_log_dt": _A_in["log_dt"],
        "A_Dskip": _A_in["Dskip"],
        "B_x": _B_in["x"],
        "B_w_gate": _B_in["w_gate"],
        "B_w_up": _B_in["w_up"],
        "B_w_down": _B_in["w_down"],
    }

def reference(A_u, A_A_re, A_A_im, A_B_re, A_B_im, A_C_re, A_C_im, A_log_dt, A_Dskip, B_x, B_w_gate, B_w_up, B_w_down):
    def _A_ref(u, A_re, A_im, B_re, B_im, C_re, C_im, log_dt, Dskip):
        Bsz, L, D = u.shape
        dt = torch.exp(log_dt)[:, None]
        A = A_re + 1j * A_im
        Bc = B_re + 1j * B_im
        Cc = C_re + 1j * C_im
        logdA = dt * A
        dB = dt * Bc
        l = (lambda x, dt: x.to(dt))(torch.arange(L), A_re.dtype)
        P = torch.exp(logdA[:, :, None] * l[None, None, :])
        K = torch.einsum("dn,dnl,dn->dl", Cc, P, dB).real
        L2 = 2 * L
        Kp = _pad(K, ((0, 0), (0, L)))
        up = (lambda x, *d: x.permute(*d))(u, 0, 2, 1)
        up = _pad(up, ((0, 0), (0, 0), (0, L)))
        Kf = (lambda x, axes=(-2,-1): torch.fft.rfft2(x.float(), dim=axes))(Kp[:, None, :], axes=(-2, -1))
        Uf = (lambda x, axes=(-2,-1): torch.fft.rfft2(x.float(), dim=axes))(up[:, :, None, :], axes=(-2, -1))
        Yf = Uf * Kf[None, :, :, :]
        y = (lambda x, s, axes=(-2,-1): torch.fft.irfft2(x, s=s, dim=axes).to(torch.bfloat16))(Yf, (1, L2), axes=(-2, -1))[:, :, 0, :L]
        y = (lambda x, *d: x.permute(*d))(y, 0, 2, 1) + u * Dskip[None, None, :]
        return y

    def _B_ref(x, w_gate, w_up, w_down):
        return (_gelu(x @ w_gate) * (x @ w_up)) @ w_down

    x = A_u
    x = x + _A_ref(_layernorm(x, axis=-1), A_A_re, A_A_im, A_B_re, A_B_im, A_C_re, A_C_im, A_log_dt, A_Dskip)
    x = x + _B_ref(_layernorm(x, axis=-1), B_w_gate, B_w_up, B_w_down)
    x = x + _A_ref(_layernorm(x, axis=-1), A_A_re, A_A_im, A_B_re, A_B_im, A_C_re, A_C_im, A_log_dt, A_Dskip)
    x = x + _B_ref(_layernorm(x, axis=-1), B_w_gate, B_w_up, B_w_down)
    return x
```

```asm
; @launch grid=(256,1,1) block=(256,1,1) lds=157952
.amdgcn_target "amdgcn-amd-amdhsa--gfx950"
.text
.p2align 8
.globl interleave_layers__ssm_conv_s4__geglu_ffn__prompt_kernel
.type interleave_layers__ssm_conv_s4__geglu_ffn__prompt_kernel,@function
interleave_layers__ssm_conv_s4__geglu_ffn__prompt_kernel:
    s_cmp_ge_u32 s2, 256
    s_cbranch_scc1 done
    s_load_dwordx16 s[68:83], s[0:1], 0
    s_load_dwordx16 s[84:99], s[0:1], 64
    s_getpc_b64 s[26:27]
pc0:
    s_bfe_u32 s3, s2, 262147
    s_lshl_b32 s3, s3, 7
    v_lshl_add_u32 v1, v0, 11, s3
    v_cmp_gt_u32 vcc, done-pc0, v1
    s_nop 1
    s_mov_b64 exec, vcc
    global_load_dword v254, v1, s[26:27]
    s_mov_b64 exec, -1
    v_lshrrev_b32 v1, 6, v0
    v_and_b32 v2, 63, v0
    v_readfirstlane_b32 s3, v1
    v_and_b32 v3, 15, v0
    v_lshrrev_b32 v4, 4, v2
    v_lshlrev_b32 v5, 4, v2
    v_lshlrev_b32 v6, 4, v0
    s_lshr_b32 s62, s2, 3
    s_and_b32 s63, s2, 7
    s_lshl_b32 s26, s62, 16
    s_lshl_b32 s27, s63, 7
    s_add_u32 s26, s26, s27
    v_lshrrev_b32 v52, 3, v0
    v_and_b32 v53, 7, v0
    v_lshlrev_b32 v228, 10, v52
    v_lshl_add_u32 v228, v53, 4, v228
    v_add_u32 v228, s26, v228
    v_add_u32 v229, 0x8000, v228
    s_lshl_b32 s26, s2, 13
    s_lshl_b32 s27, s3, 11
    s_add_u32 s26, s26, s27
    v_add_u32 v230, s26, v5
    v_and_b32 v57, 127, v0
    s_lshl_b32 s26, s2, 9
    v_lshl_add_u32 v231, v2, 3, s26
    v_mov_b32 v236, 0
    v_mov_b32 v237, 0
    v_mov_b32 v238, 0
    v_mov_b32 v239, 0
    s_lshl_b32 s26, s2, 10
    s_lshl_b32 s27, s3, 14
    s_add_u32 s26, s26, s27
    s_add_u32 s26, s26, 33226752
    s_and_b32 s100, s2, 3
    s_lshl_b32 s100, s100, 6
    s_cmp_ge_u32 s2, 32
    s_cselect_b32 s26, 1073741824, s26
    s_cselect_b32 s100, 1073741824, s100
    s_mul_i32 s27, s2, 768
    s_add_u32 s27, s27, 33030144
    s_cmp_eq_u32 s3, 1
    s_cselect_b32 s26, s27, s26
    s_cselect_b32 s30, 0x2f0, -1
    s_cselect_b32 s100, 1073741824, s100
    s_lshl_b32 s27, s2, 6
    s_add_u32 s27, s27, 32522240
    s_cmp_eq_u32 s3, 3
    s_cselect_b32 s26, s27, s26
    s_cselect_b32 s30, 0x30, s30
    s_cselect_b32 s100, 1073741824, s100
    v_min_u32 v233, s30, v5
    s_lshr_b32 s18, s2, 4
    s_and_b32 s19, s2, 15
    s_mul_i32 s12, s19, 88064
    s_mul_i32 s17, s18, 172
    s_add_u32 s12, s12, s17
    v_and_b32 v62, 3, v0
    v_mov_b32 v54, 1073741824
    v_mul_u32_u24 v240, 5958, v0
    v_lshrrev_b32 v240, 16, v240
    v_mul_u32_u24 v63, 11, v240
    v_sub_u32 v63, v0, v63
    v_lshlrev_b32 v63, 4, v63
    v_min_u32 v242, 156, v63
    v_mul_u32_u24 v63, 2752, v240
    v_add_u32 v234, v63, v242
    v_add_u32 v1, 256, v0
    v_mul_u32_u24 v241, 5958, v1
    v_lshrrev_b32 v241, 16, v241
    v_mul_u32_u24 v63, 11, v241
    v_sub_u32 v63, v1, v63
    v_lshlrev_b32 v63, 4, v63
    v_min_u32 v243, 156, v63
    v_mul_u32_u24 v63, 2752, v241
    v_add_u32 v235, v63, v243
    v_cmp_gt_u32 vcc, 96, v0
    s_nop 1
    v_cndmask_b32 v235, v54, v235, vcc
    s_mul_i32 s10, s2, 5958
    s_lshr_b32 s10, s10, 16
    s_mul_i32 s17, s10, 11
    s_sub_u32 s101, s2, s17
    s_mul_i32 s10, s10, 86
    s_lshl_b32 s17, s101, 3
    s_add_u32 s10, s10, s17
    s_lshl_b32 s10, s10, 10
    s_add_u32 s11, s10, 4096
    s_lshl_b32 s17, s101, 2
    s_add_u32 s17, s17, s3
    s_cmp_ge_u32 s17, 42
    s_cselect_b32 s11, 1073741824, s11
    s_lshl_b32 s101, s2, 2
    s_waitcnt lgkmcnt(0)
    s_mov_b32 s20, s98
    s_and_b32 s21, s99, 0xffff
    s_mov_b32 s22, 33554432
    s_mov_b32 s23, 0x00020000
    buffer_store_dwordx4 v[236:239], v233, s[20:23], s26 offen sc1
    global_load_dwordx4 v[64:67], v228, s[68:69]
    global_load_dwordx4 v[68:71], v229, s[68:69]
    global_load_dwordx4 v[72:75], v230, s[68:69]
    global_load_dwordx4 v[76:79], v230, s[68:69] offset:1024
    s_cmp_eq_u32 s3, 1
    s_cselect_b64 s[70:71], s[74:75], s[70:71]
    s_cselect_b64 s[72:73], s[76:77], s[72:73]
    s_cmp_ge_u32 s3, 2
    s_cselect_b64 s[70:71], s[78:79], s[70:71]
    s_cselect_b64 s[72:73], s[80:81], s[72:73]
    global_load_dwordx2 v[176:177], v231, s[70:71]
    global_load_dwordx2 v[178:179], v231, s[72:73]
    s_load_dword s26, s[82:83], s101
    s_load_dword s27, s[84:85], s101
    s_mov_b32 s28, s94
    s_and_b32 s29, s95, 0xffff
    s_mov_b32 s30, 2097152
    s_mov_b32 s31, 0x00020000
    s_mov_b32 s84, s88
    s_and_b32 s85, s89, 0xffff
    s_mov_b32 s86, 1409024
    s_mov_b32 s87, 0x00020000
    s_mov_b32 s88, s90
    s_and_b32 s89, s91, 0xffff
    s_mov_b32 s90, 1409024
    s_mov_b32 s91, 0x00020000
    s_mov_b32 s92, s92
    s_and_b32 s93, s93, 0xffff
    s_mov_b32 s94, 1409024
    s_mov_b32 s95, 0x00020000
    s_mov_b64 s[24:25], s[98:99]
    s_mov_b32 s96, s96
    s_and_b32 s97, s97, 0xffff
    s_mov_b32 s98, 256
    s_mov_b32 s99, 0x00020000
    v_mov_b32 v35, 0x3727c5ac
    v_mov_b32 v32, 1
    v_cmp_gt_u32 vcc, 8, v0
    v_lshlrev_b32 v1, 12, v0
    s_nop 0
    v_cndmask_b32 v30, v54, v1, vcc
    v_cmp_eq_u32 vcc, 0, v0
    s_nop 1
    v_cndmask_b32 v31, v54, v1, vcc
    s_cmp_eq_u32 s3, 3
    s_cselect_b32 s15, 1073741824, 0
    v_add_u32 v33, s15, v5
    s_and_b32 s4, s2, 3
    s_lshl_b32 s4, s4, 2
    s_bfe_u32 s5, s2, 0x20003
    s_add_u32 s5, s5, s4
    s_lshr_b32 s13, s3, 1
    s_and_b32 s14, s3, 1
    s_mov_b32 s32, 0
    s_mov_b32 s33, 1
    s_lshl_b32 s34, s2, 13
    s_mov_b32 s35, 32505856
    s_lshl_b32 s39, s3, 10
    s_lshl_b32 s15, s13, 12
    s_lshl_b32 s16, s14, 10
    s_add_u32 s15, s15, s16
    s_add_u32 s36, s34, s15
    s_add_u32 s36, s36, 2097152
    s_add_u32 s15, s15, 102400
    v_add_u32 v13, s15, v5
    s_mul_i32 s15, s5, 11
    s_mul_i32 s16, s3, 3
    s_add_u32 s15, s15, s16
    s_lshl_b32 s16, s15, 14
    s_add_u32 s40, s16, 26214400
    s_bfe_u32 s15, s2, 0x20002
    s_lshl_b32 s15, s15, 6
    s_lshr_b32 s16, s2, 4
    s_lshl_b32 s16, s16, 2
    s_add_u32 s15, s15, s16
    s_and_b32 s16, s2, 3
    s_add_u32 s15, s15, s16
    s_lshr_b32 s16, s15, 3
    s_lshl_b32 s16, s16, 7
    s_and_b32 s17, s15, 7
    s_lshl_b32 s17, s17, 2
    s_add_u32 s46, s16, s17
    s_bfe_u32 s15, s2, 0x20005
    s_lshl_b32 s15, s15, 6
    s_lshr_b32 s16, s2, 7
    s_lshl_b32 s16, s16, 5
    s_add_u32 s15, s15, s16
    s_and_b32 s16, s2, 31
    s_add_u32 s15, s15, s16
    s_lshr_b32 s16, s15, 3
    s_lshl_b32 s16, s16, 7
    s_and_b32 s17, s15, 7
    s_lshl_b32 s17, s17, 2
    s_add_u32 s8, s16, s17
    s_lshr_b32 s16, s2, 3
    s_lshl_b32 s16, s16, 7
    s_and_b32 s17, s2, 7
    s_lshl_b32 s17, s17, 2
    s_add_u32 s47, s16, s17
    s_mov_b32 s49, 0x3b000000
    s_mul_i32 s15, s5, 11264
    s_mul_i32 s16, s3, 192
    s_add_u32 s15, s15, s16
    s_add_u32 s50, s15, 31457280
    v_lshlrev_b32 v7, 3, v0
    v_add_u32 v8, 102400, v7
    v_lshlrev_b32 v9, 3, v4
    v_sub_u32 v9, v9, v3
    v_add_u32 v9, 143, v9
    s_lshl_b32 s15, s14, 7
    v_subrev_u32 v9, s15, v9
    v_and_b32 v1, 1, v9
    v_mul_u32_u24 v1, 4158, v1
    v_lshl_add_u32 v9, v9, 1, v1
    s_mul_i32 s15, s13, 8320
    s_add_u32 s15, s15, 141312
    v_add_u32 v9, s15, v9
    v_lshlrev_b32 v10, 5, v3
    v_lshl_add_u32 v10, v4, 4, v10
    s_mul_i32 s15, s13, 4608
    s_lshl_b32 s16, s14, 8
    s_sub_u32 s15, s15, s16
    s_add_u32 s15, s15, 131360
    v_add_u32 v10, s15, v10
    v_lshrrev_b32 v1, 5, v2
    v_lshl_add_u32 v11, v1, 7, v5
    s_mul_i32 s15, s3, 4608
    s_add_u32 s15, s15, 65536
    v_add_u32 v11, s15, v11
    v_mul_u32_u24 v12, 1152, v1
    v_and_b32 v1, 1, v2
    v_mul_u32_u24 v1, 640, v1
    v_add_u32 v12, v12, v1
    v_bfe_u32 v1, v2, 1, 4
    v_lshl_add_u32 v12, v1, 4, v12
    s_mul_i32 s15, s13, 9216
    s_mul_i32 s16, s14, 2304
    s_add_u32 s15, s15, s16
    s_add_u32 s15, s15, 65536
    v_add_u32 v12, s15, v12
    v_cmp_eq_u32 s[52:53], 1, v62
    v_cmp_eq_u32 s[54:55], 2, v62
    v_cmp_eq_u32 s[56:57], 3, v62
    v_mul_u32_u24 v248, 704, v3
    v_lshl_add_u32 v248, v4, 4, v248
    s_and_b32 s15, s2, 7
    s_lshl_b32 s15, s15, 12
    v_lshl_add_u32 v1, v53, 2, s15
    v_lshrrev_b32 v29, 3, v0
    v_lshl_add_u32 v29, v29, 7, v1
    v_bfe_u32 v249, v0, 3, 1
    v_lshl_add_u32 v249, s5, 1, v249
    v_lshl_add_u32 v249, v249, 7, v1
    v_lshrrev_b32 v1, 7, v0
    v_mul_u32_u24 v1, 4608, v1
    v_lshl_add_u32 v1, v57, 2, v1
    v_add_u32 v1, 131072, v1
    ds_write_b32 v1, v236
    v_bfe_u32 v1, v0, 2, 2
    v_mul_u32_u24 v1, 4160, v1
    v_lshl_add_u32 v1, v62, 4, v1
    v_add_u32 v1, 145408, v1
    ds_write_b128 v1, v[236:239]
    v_mov_b32 v1, 28012
    ds_write_b32 v1, v236
    ds_write_b32 v1, v236 offset:32768
    v_sub_u32 v50, 2047, v7
    v_cmp_gt_i32 vcc, 257, v50
    v_subrev_u32 v56, 0, v50
    v_cvt_f32_i32 v1, v56
    v_cvt_pk_bf16_f32 v1, v1, v1
    v_and_b32 v1, 0xffff, v1
    v_subrev_u32 v1, 0x4280, v1
    v_cndmask_b32 v56, v1, v56, vcc
    v_lshlrev_b32 v36, 1, v56
    v_subrev_u32 v56, 1, v50
    v_cvt_f32_i32 v1, v56
    v_cvt_pk_bf16_f32 v1, v1, v1
    v_and_b32 v1, 0xffff, v1
    v_subrev_u32 v1, 0x4280, v1
    v_cndmask_b32 v56, v1, v56, vcc
    v_lshlrev_b32 v37, 1, v56
    v_subrev_u32 v56, 2, v50
    v_cvt_f32_i32 v1, v56
    v_cvt_pk_bf16_f32 v1, v1, v1
    v_and_b32 v1, 0xffff, v1
    v_subrev_u32 v1, 0x4280, v1
    v_cndmask_b32 v56, v1, v56, vcc
    v_lshlrev_b32 v38, 1, v56
    v_subrev_u32 v56, 3, v50
    v_cvt_f32_i32 v1, v56
    v_cvt_pk_bf16_f32 v1, v1, v1
    v_and_b32 v1, 0xffff, v1
    v_subrev_u32 v1, 0x4280, v1
    v_cndmask_b32 v56, v1, v56, vcc
    v_lshlrev_b32 v39, 1, v56
    v_subrev_u32 v56, 4, v50
    v_cvt_f32_i32 v1, v56
    v_cvt_pk_bf16_f32 v1, v1, v1
    v_and_b32 v1, 0xffff, v1
    v_subrev_u32 v1, 0x4280, v1
    v_cndmask_b32 v56, v1, v56, vcc
    v_lshlrev_b32 v40, 1, v56
    v_subrev_u32 v56, 5, v50
    v_cvt_f32_i32 v1, v56
    v_cvt_pk_bf16_f32 v1, v1, v1
    v_and_b32 v1, 0xffff, v1
    v_subrev_u32 v1, 0x4280, v1
    v_cndmask_b32 v56, v1, v56, vcc
    v_lshlrev_b32 v41, 1, v56
    v_subrev_u32 v56, 6, v50
    v_cvt_f32_i32 v1, v56
    v_cvt_pk_bf16_f32 v1, v1, v1
    v_and_b32 v1, 0xffff, v1
    v_subrev_u32 v1, 0x4280, v1
    v_cndmask_b32 v56, v1, v56, vcc
    v_lshlrev_b32 v42, 1, v56
    v_subrev_u32 v56, 7, v50
    v_cvt_f32_i32 v1, v56
    v_cvt_pk_bf16_f32 v1, v1, v1
    v_and_b32 v1, 0xffff, v1
    v_subrev_u32 v1, 0x4280, v1
    v_cndmask_b32 v56, v1, v56, vcc
    v_lshlrev_b32 v43, 1, v56
    v_subrev_u32 v56, 8, v50
    v_cvt_f32_i32 v1, v56
    v_cvt_pk_bf16_f32 v1, v1, v1
    v_and_b32 v1, 0xffff, v1
    v_subrev_u32 v1, 0x4280, v1
    v_cndmask_b32 v56, v1, v56, vcc
    v_lshlrev_b32 v44, 1, v56
    v_add_u32 v44, 2, v44
    v_mul_u32_u24 v52, 144, v52
    v_lshl_add_u32 v52, v53, 4, v52
    v_add_u32 v52, 65536, v52
    s_lshl_b32 s16, s63, 18
    s_lshl_b32 s17, s62, 7
    s_add_u32 s62, s16, s17
    v_lshrrev_b32 v128, 4, v2
    v_lshlrev_b32 v128, 3, v128
    v_bfe_u32 v129, v2, 2, 2
    v_add_u32 v128, v128, v129
    v_mul_u32_u24 v128, 144, v128
    v_and_b32 v129, 3, v2
    v_lshl_add_u32 v128, v129, 3, v128
    v_lshl_add_u32 v128, s3, 5, v128
    v_and_b32 v129, 15, v2
    v_lshl_add_u32 v129, s3, 4, v129
    v_mul_u32_u24 v129, 4096, v129
    v_and_b32 v130, 0x30, v2
    v_add_u32 v129, v129, v130
    v_add_u32 v128, 65536, v128
    v_mul_u32_u24 v240, 352, v240
    v_lshl_add_u32 v240, v242, 1, v240
    v_add_u32 v45, 81920, v240
    v_mul_u32_u24 v241, 352, v241
    v_lshl_add_u32 v241, v243, 1, v241
    v_add_u32 v46, 81920, v241
    v_and_b32 v1, 31, v0
    v_mul_u32_u24 v1, 352, v1
    v_add_u32 v1, 81920, v1
    v_mov_b32 v58, 0x3f80
    ds_write2_b32 v1, v58, v236 offset0:86 offset1:87
    v_lshrrev_b32 v1, 2, v2
    v_mul_u32_u24 v58, 352, v1
    v_lshl_add_u32 v58, v62, 3, v58
    s_lshl_b32 s16, s3, 5
    s_add_u32 s16, s16, 81920
    v_add_u32 v58, s16, v58
    s_mul_i32 s16, s3, 1152
    s_add_u32 s16, s16, 114688
    v_add_u32 v59, s16, v5
    v_and_b32 v1, 3, v1
    v_mul_u32_u24 v63, 1152, v1
    v_lshl_add_u32 v63, v62, 3, v63
    v_lshl_add_u32 v63, v4, 5, v63
    s_lshl_b32 s16, s3, 8
    s_add_u32 s16, s16, 114688
    v_add_u32 v63, s16, v63
    s_min_u32 s16, s3, 2
    s_lshl_b32 s16, s16, 10
    v_lshl_add_u32 v232, v2, 3, s16
    v_lshl_add_u32 v1, v3, 2, s3
    v_lshlrev_b32 v55, 4, v4
    v_lshl_add_u32 v55, v1, 6, v55
    v_cmp_gt_u32 vcc, 11, v1
    s_nop 1
    v_cndmask_b32 v55, v54, v55, vcc
    s_mul_i32 s16, s18, 180224
    s_lshl_b32 s17, s19, 10
    s_lshl_b32 s6, s3, 14
    s_add_u32 s16, s16, s6
    s_add_u32 s16, s16, s17
    s_add_u32 s6, s16, 26214400
    s_mul_i32 s17, s2, 704
    s_add_u32 s7, s17, 31457280
    s_mul_i32 s16, s2, 1490
    s_lshr_b32 s16, s16, 16
    v_xor_b32 v56, s16, v4
    v_lshlrev_b32 v56, 10, v56
    v_and_b32 v1, 1, v0
    v_lshl_add_u32 v56, v1, 7, v56
    v_bfe_u32 v1, v0, 1, 3
    v_lshl_add_u32 v56, v1, 4, v56
    s_lshr_b32 s16, s2, 2
    s_lshl_b32 s16, s16, 12
    s_and_b32 s17, s2, 3
    s_lshl_b32 s17, s17, 8
    s_add_u32 s16, s16, s17
    s_mul_i32 s17, s3, 360448
    s_add_u32 s16, s16, s17
    s_add_u32 s16, s16, 29360128
    s_cmp_ge_u32 s2, 176
    s_cselect_b32 s63, 1073741824, s16
    v_lshrrev_b32 v138, 5, v2
    v_lshlrev_b32 v138, 13, v138
    v_and_b32 v1, 1, v4
    v_lshl_add_u32 v138, v1, 2, v138
    v_cmp_eq_u32 vcc, 0, v3
    s_nop 1
    v_cndmask_b32 v138, v54, v138, vcc
    s_lshl_b32 s16, s2, 5
    s_lshl_b32 s17, s3, 3
    s_add_u32 s16, s16, s17
    s_add_u32 s9, s16, 32505856
    buffer_load_dwordx4 v[80:83], v234, s[84:87], s12 offen
    buffer_load_dwordx4 v[84:87], v234, s[88:91], s12 offen
    buffer_load_dwordx4 v[88:91], v235, s[84:87], s12 offen
    buffer_load_dwordx4 v[92:95], v235, s[88:91], s12 offen
    v_lshlrev_b32 v1, 24, v2
    s_waitcnt vmcnt(10)
    buffer_atomic_add v32, v1, s[96:99], s100 offen sc1
    s_waitcnt vmcnt(10)
    ds_write_b128 v52, v[64:67]
    s_waitcnt vmcnt(9)
    ds_write_b128 v52, v[68:71] offset:4608
    s_waitcnt vmcnt(8)
    v_lshlrev_b32 v132, 16, v72
    v_and_b32 v133, 0xffff0000, v72
    v_add_f32 v134, v132, v133
    v_mul_f32 v136, v132, v132
    v_fmac_f32 v136, v133, v133
    v_lshlrev_b32 v132, 16, v73
    v_and_b32 v133, 0xffff0000, v73
    v_add_f32 v134, v134, v132
    v_fmac_f32 v136, v132, v132
    v_add_f32 v134, v134, v133
    v_fmac_f32 v136, v133, v133
    v_lshlrev_b32 v132, 16, v74
    v_and_b32 v133, 0xffff0000, v74
    v_add_f32 v134, v134, v132
    v_fmac_f32 v136, v132, v132
    v_add_f32 v134, v134, v133
    v_fmac_f32 v136, v133, v133
    v_lshlrev_b32 v132, 16, v75
    v_and_b32 v133, 0xffff0000, v75
    v_add_f32 v134, v134, v132
    v_fmac_f32 v136, v132, v132
    v_add_f32 v134, v134, v133
    v_fmac_f32 v136, v133, v133
    s_waitcnt vmcnt(7)
    v_lshlrev_b32 v132, 16, v76
    v_and_b32 v133, 0xffff0000, v76
    v_add_f32 v135, v132, v133
    v_mul_f32 v137, v132, v132
    v_fmac_f32 v137, v133, v133
    v_lshlrev_b32 v132, 16, v77
    v_and_b32 v133, 0xffff0000, v77
    v_add_f32 v135, v135, v132
    v_fmac_f32 v137, v132, v132
    v_add_f32 v135, v135, v133
    v_fmac_f32 v137, v133, v133
    v_lshlrev_b32 v132, 16, v78
    v_and_b32 v133, 0xffff0000, v78
    v_add_f32 v135, v135, v132
    v_fmac_f32 v137, v132, v132
    v_add_f32 v135, v135, v133
    v_fmac_f32 v137, v133, v133
    v_lshlrev_b32 v132, 16, v79
    v_and_b32 v133, 0xffff0000, v79
    v_add_f32 v135, v135, v132
    v_fmac_f32 v137, v132, v132
    v_add_f32 v135, v135, v133
    v_fmac_f32 v137, v133, v133
    v_permlane32_swap_b32 v134, v136
    s_nop 0
    v_permlane32_swap_b32 v135, v137
    v_add_f32 v134, v134, v136
    v_add_f32 v135, v135, v137
    s_waitcnt lgkmcnt(0)
    v_mov_b32 v60, s26
    v_mov_b32 v61, s27
    v_permlane16_swap_b32 v134, v135
    v_add_f32 v134, v134, v135
    s_waitcnt vmcnt(6)
    ds_write_b64 v232, v[176:177] offset:29696
    s_waitcnt vmcnt(5)
    ds_write_b64 v232, v[178:179] offset:30208
    v_lshlrev_b32 v1, 1, v57
    s_waitcnt lgkmcnt(0)
    s_barrier
    ds_read_b64_tr_b16 v[120:121], v128 offset:0
    ds_read_b64_tr_b16 v[122:123], v128 offset:576
    ds_read_b64_tr_b16 v[124:125], v128 offset:4608
    ds_read_b64_tr_b16 v[126:127], v128 offset:5184
    ds_read_u16 v106, v1 offset:29696
    ds_read_u16 v107, v1 offset:30208
    ds_read_u16 v108, v1 offset:30720
    ds_read_u16 v109, v1 offset:31232
    ds_read_u16 v110, v1 offset:31744
    ds_read_u16 v111, v1 offset:32256
    ds_read_u16 v114, v1 offset:29952
    ds_read_u16 v115, v1 offset:30464
    ds_read_u16 v116, v1 offset:30976
    ds_read_u16 v117, v1 offset:31488
    ds_read_u16 v118, v1 offset:32000
    ds_read_u16 v119, v1 offset:32512
    v_add_f32_dpp v134, v134, v134 row_ror:8 row_mask:0xf bank_mask:0xf
    v_mov_b32 v72, 0x3f803f80
    s_nop 0
    v_add_f32_dpp v134, v134, v134 row_ror:4 row_mask:0xf bank_mask:0xf
    v_mov_b32 v73, 0x3f803f80
    s_nop 0
    v_add_f32_dpp v134, v134, v134 row_ror:2 row_mask:0xf bank_mask:0xf
    v_mov_b32 v74, 0x3f803f80
    s_nop 0
    v_add_f32_dpp v134, v134, v134 row_ror:1 row_mask:0xf bank_mask:0xf
    v_mov_b32 v75, 0x3f803f80
    s_waitcnt lgkmcnt(14)
    buffer_store_dwordx4 v[120:123], v129, s[20:23], s62 offen sc1
    s_waitcnt lgkmcnt(12)
    buffer_store_dwordx4 v[124:127], v129, s[20:23], s62 offen offset:64 sc1
    buffer_store_dword v134, v138, s[20:23], s9 offen sc1
    buffer_load_dwordx4 v[96:99], v6, s[92:95], s10 offen
    buffer_load_dwordx4 v[100:103], v6, s[92:95], s11 offen
    v_lshlrev_b32 v57, 2, v57
    v_lshlrev_b32 v105, 16, v60
    v_and_b32 v113, 0xffff0000, v60
    v_mul_f32 v105, 0x3fb8aa3b, v105
    v_mul_f32 v113, 0x3fb8aa3b, v113
    v_exp_f32 v105, v105
    v_exp_f32 v113, v113
    s_waitcnt lgkmcnt(11)
    v_lshlrev_b32 v106, 16, v106
    s_waitcnt lgkmcnt(5)
    v_lshlrev_b32 v114, 16, v114
    v_lshlrev_b32 v107, 16, v107
    s_waitcnt lgkmcnt(4)
    v_lshlrev_b32 v115, 16, v115
    v_lshlrev_b32 v108, 16, v108
    s_waitcnt lgkmcnt(3)
    v_lshlrev_b32 v116, 16, v116
    v_lshlrev_b32 v109, 16, v109
    s_waitcnt lgkmcnt(2)
    v_lshlrev_b32 v117, 16, v117
    v_lshlrev_b32 v110, 16, v110
    s_waitcnt lgkmcnt(1)
    v_lshlrev_b32 v118, 16, v118
    v_lshlrev_b32 v111, 16, v111
    s_waitcnt lgkmcnt(0)
    v_lshlrev_b32 v119, 16, v119
    v_cvt_pk_bf16_f32 v105, v105, v105
    v_cvt_pk_bf16_f32 v113, v113, v113
    v_lshlrev_b32 v105, 16, v105
    v_lshlrev_b32 v113, 16, v113
    v_mul_f32 v106, v105, v106
    v_mul_f32 v114, v113, v114
    v_mul_f32 v107, v105, v107
    v_mul_f32 v115, v113, v115
    v_mul_f32 v108, v105, v108
    v_mul_f32 v116, v113, v116
    v_mul_f32 v109, v105, v109
    v_mul_f32 v117, v113, v117
    s_waitcnt lgkmcnt(0)
    s_cmp_ge_u32 s3, 2
    s_cbranch_scc1 kg_aside
    v_mul_f32 v66, 0x4138aa3b, v106
    v_mul_f32 v70, 0x4138aa3b, v114
    v_mul_f32 v67, 0x3fa2f983, v107
    v_mul_f32 v71, 0x3fa2f983, v115
    v_exp_f32 v66, v66
    v_exp_f32 v70, v70
    v_fract_f32 v67, v67
    v_fract_f32 v71, v71
    v_cos_f32 v122, v67
    v_cos_f32 v186, v71
    v_sin_f32 v123, v67
    v_sin_f32 v187, v71
    v_mul_f32 v122, v122, v66
    v_mul_f32 v186, v186, v70
    v_mul_f32 v123, v123, v66
    v_mul_f32 v187, v187, v70
    v_mov_b32 v64, 0x3f80
    v_mov_b32 v68, 0x3f80
    ds_write_b32 v57, v64 offset:11088
    ds_write_b32 v57, v68 offset:43856
    v_cvt_pk_bf16_f32 v65, v122, v123
    v_cvt_pk_bf16_f32 v69, v186, v187
    ds_write_b32 v57, v65 offset:11616
    ds_write_b32 v57, v69 offset:44384
    v_pk_mul_f32 v[124:125], v[122:123], v[122:123] op_sel:[0,0] op_sel_hi:[0,1]
    v_pk_mul_f32 v[188:189], v[186:187], v[186:187] op_sel:[0,0] op_sel_hi:[0,1]
    v_pk_fma_f32 v[124:125], v[122:123], v[122:123], v[124:125] op_sel:[1,1,0] op_sel_hi:[1,0,1] neg_lo:[1,0,0]
    v_pk_fma_f32 v[188:189], v[186:187], v[186:187], v[188:189] op_sel:[1,1,0] op_sel_hi:[1,0,1] neg_lo:[1,0,0]
    v_cvt_pk_bf16_f32 v64, v124, v125
    v_cvt_pk_bf16_f32 v68, v188, v189
    ds_write_b32 v57, v64 offset:12144
    ds_write_b32 v57, v68 offset:44912
    v_pk_mul_f32 v[126:127], v[122:123], v[124:125] op_sel:[0,0] op_sel_hi:[0,1]
    v_pk_mul_f32 v[190:191], v[186:187], v[188:189] op_sel:[0,0] op_sel_hi:[0,1]
    v_pk_fma_f32 v[126:127], v[122:123], v[124:125], v[126:127] op_sel:[1,1,0] op_sel_hi:[1,0,1] neg_lo:[1,0,0]
    v_pk_fma_f32 v[190:191], v[186:187], v[188:189], v[190:191] op_sel:[1,1,0] op_sel_hi:[1,0,1] neg_lo:[1,0,0]
    v_cvt_pk_bf16_f32 v65, v126, v127
    v_cvt_pk_bf16_f32 v69, v190, v191
    ds_write_b32 v57, v65 offset:12672
    ds_write_b32 v57, v69 offset:45440
    v_pk_mul_f32 v[128:129], v[124:125], v[124:125] op_sel:[0,0] op_sel_hi:[0,1]
    v_pk_mul_f32 v[192:193], v[188:189], v[188:189] op_sel:[0,0] op_sel_hi:[0,1]
    v_pk_fma_f32 v[128:129], v[124:125], v[124:125], v[128:129] op_sel:[1,1,0] op_sel_hi:[1,0,1] neg_lo:[1,0,0]
    v_pk_fma_f32 v[192:193], v[188:189], v[188:189], v[192:193] op_sel:[1,1,0] op_sel_hi:[1,0,1] neg_lo:[1,0,0]
    v_cvt_pk_bf16_f32 v64, v128, v129
    v_cvt_pk_bf16_f32 v68, v192, v193
    ds_write_b32 v57, v64 offset:13200
    ds_write_b32 v57, v68 offset:45968
    v_pk_mul_f32 v[130:131], v[122:123], v[128:129] op_sel:[0,0] op_sel_hi:[0,1]
    v_pk_mul_f32 v[194:195], v[186:187], v[192:193] op_sel:[0,0] op_sel_hi:[0,1]
    v_pk_fma_f32 v[130:131], v[122:123], v[128:129], v[130:131] op_sel:[1,1,0] op_sel_hi:[1,0,1] neg_lo:[1,0,0]
    v_pk_fma_f32 v[194:195], v[186:187], v[192:193], v[194:195] op_sel:[1,1,0] op_sel_hi:[1,0,1] neg_lo:[1,0,0]
    v_cvt_pk_bf16_f32 v65, v130, v131
    v_cvt_pk_bf16_f32 v69, v194, v195
    ds_write_b32 v57, v65 offset:13728
    ds_write_b32 v57, v69 offset:46496
    v_pk_mul_f32 v[132:133], v[124:125], v[128:129] op_sel:[0,0] op_sel_hi:[0,1]
    v_pk_mul_f32 v[196:197], v[188:189], v[192:193] op_sel:[0,0] op_sel_hi:[0,1]
    v_pk_fma_f32 v[132:133], v[124:125], v[128:129], v[132:133] op_sel:[1,1,0] op_sel_hi:[1,0,1] neg_lo:[1,0,0]
    v_pk_fma_f32 v[196:197], v[188:189], v[192:193], v[196:197] op_sel:[1,1,0] op_sel_hi:[1,0,1] neg_lo:[1,0,0]
    v_cvt_pk_bf16_f32 v64, v132, v133
    v_cvt_pk_bf16_f32 v68, v196, v197
    ds_write_b32 v57, v64 offset:14256
    ds_write_b32 v57, v68 offset:47024
    v_pk_mul_f32 v[134:135], v[126:127], v[128:129] op_sel:[0,0] op_sel_hi:[0,1]
    v_pk_mul_f32 v[198:199], v[190:191], v[192:193] op_sel:[0,0] op_sel_hi:[0,1]
    v_pk_fma_f32 v[134:135], v[126:127], v[128:129], v[134:135] op_sel:[1,1,0] op_sel_hi:[1,0,1] neg_lo:[1,0,0]
    v_pk_fma_f32 v[198:199], v[190:191], v[192:193], v[198:199] op_sel:[1,1,0] op_sel_hi:[1,0,1] neg_lo:[1,0,0]
    v_cvt_pk_bf16_f32 v65, v134, v135
    v_cvt_pk_bf16_f32 v69, v198, v199
    ds_write_b32 v57, v65 offset:14784
    ds_write_b32 v57, v69 offset:47552
    v_pk_mul_f32 v[136:137], v[128:129], v[128:129] op_sel:[0,0] op_sel_hi:[0,1]
    v_pk_mul_f32 v[200:201], v[192:193], v[192:193] op_sel:[0,0] op_sel_hi:[0,1]
    v_pk_fma_f32 v[136:137], v[128:129], v[128:129], v[136:137] op_sel:[1,1,0] op_sel_hi:[1,0,1] neg_lo:[1,0,0]
    v_pk_fma_f32 v[200:201], v[192:193], v[192:193], v[200:201] op_sel:[1,1,0] op_sel_hi:[1,0,1] neg_lo:[1,0,0]
    v_cvt_pk_bf16_f32 v64, v136, v137
    v_cvt_pk_bf16_f32 v68, v200, v201
    ds_write_b32 v57, v64 offset:15312
    ds_write_b32 v57, v68 offset:48080
    v_pk_mul_f32 v[138:139], v[122:123], v[136:137] op_sel:[0,0] op_sel_hi:[0,1]
    v_pk_mul_f32 v[202:203], v[186:187], v[200:201] op_sel:[0,0] op_sel_hi:[0,1]
    v_pk_fma_f32 v[138:139], v[122:123], v[136:137], v[138:139] op_sel:[1,1,0] op_sel_hi:[1,0,1] neg_lo:[1,0,0]
    v_pk_fma_f32 v[202:203], v[186:187], v[200:201], v[202:203] op_sel:[1,1,0] op_sel_hi:[1,0,1] neg_lo:[1,0,0]
    v_cvt_pk_bf16_f32 v65, v138, v139
    v_cvt_pk_bf16_f32 v69, v202, v203
    ds_write_b32 v57, v65 offset:15840
    ds_write_b32 v57, v69 offset:48608
    v_pk_mul_f32 v[140:141], v[124:125], v[136:137] op_sel:[0,0] op_sel_hi:[0,1]
    v_pk_mul_f32 v[204:205], v[188:189], v[200:201] op_sel:[0,0] op_sel_hi:[0,1]
    v_pk_fma_f32 v[140:141], v[124:125], v[136:137], v[140:141] op_sel:[1,1,0] op_sel_hi:[1,0,1] neg_lo:[1,0,0]
    v_pk_fma_f32 v[204:205], v[188:189], v[200:201], v[204:205] op_sel:[1,1,0] op_sel_hi:[1,0,1] neg_lo:[1,0,0]
    v_cvt_pk_bf16_f32 v64, v140, v141
    v_cvt_pk_bf16_f32 v68, v204, v205
    ds_write_b32 v57, v64 offset:16368
    ds_write_b32 v57, v68 offset:49136
    v_pk_mul_f32 v[142:143], v[126:127], v[136:137] op_sel:[0,0] op_sel_hi:[0,1]
    v_pk_mul_f32 v[206:207], v[190:191], v[200:201] op_sel:[0,0] op_sel_hi:[0,1]
    v_pk_fma_f32 v[142:143], v[126:127], v[136:137], v[142:143] op_sel:[1,1,0] op_sel_hi:[1,0,1] neg_lo:[1,0,0]
    v_pk_fma_f32 v[206:207], v[190:191], v[200:201], v[206:207] op_sel:[1,1,0] op_sel_hi:[1,0,1] neg_lo:[1,0,0]
    v_cvt_pk_bf16_f32 v65, v142, v143
    v_cvt_pk_bf16_f32 v69, v206, v207
    ds_write_b32 v57, v65 offset:16896
    ds_write_b32 v57, v69 offset:49664
    v_pk_mul_f32 v[144:145], v[128:129], v[136:137] op_sel:[0,0] op_sel_hi:[0,1]
    v_pk_mul_f32 v[208:209], v[192:193], v[200:201] op_sel:[0,0] op_sel_hi:[0,1]
    v_pk_fma_f32 v[144:145], v[128:129], v[136:137], v[144:145] op_sel:[1,1,0] op_sel_hi:[1,0,1] neg_lo:[1,0,0]
    v_pk_fma_f32 v[208:209], v[192:193], v[200:201], v[208:209] op_sel:[1,1,0] op_sel_hi:[1,0,1] neg_lo:[1,0,0]
    v_cvt_pk_bf16_f32 v64, v144, v145
    v_cvt_pk_bf16_f32 v68, v208, v209
    ds_write_b32 v57, v64 offset:17424
    ds_write_b32 v57, v68 offset:50192
    v_pk_mul_f32 v[146:147], v[130:131], v[136:137] op_sel:[0,0] op_sel_hi:[0,1]
    v_pk_mul_f32 v[210:211], v[194:195], v[200:201] op_sel:[0,0] op_sel_hi:[0,1]
    v_pk_fma_f32 v[146:147], v[130:131], v[136:137], v[146:147] op_sel:[1,1,0] op_sel_hi:[1,0,1] neg_lo:[1,0,0]
    v_pk_fma_f32 v[210:211], v[194:195], v[200:201], v[210:211] op_sel:[1,1,0] op_sel_hi:[1,0,1] neg_lo:[1,0,0]
    v_cvt_pk_bf16_f32 v65, v146, v147
    v_cvt_pk_bf16_f32 v69, v210, v211
    ds_write_b32 v57, v65 offset:17952
    ds_write_b32 v57, v69 offset:50720
    v_pk_mul_f32 v[148:149], v[132:133], v[136:137] op_sel:[0,0] op_sel_hi:[0,1]
    v_pk_mul_f32 v[212:213], v[196:197], v[200:201] op_sel:[0,0] op_sel_hi:[0,1]
    v_pk_fma_f32 v[148:149], v[132:133], v[136:137], v[148:149] op_sel:[1,1,0] op_sel_hi:[1,0,1] neg_lo:[1,0,0]
    v_pk_fma_f32 v[212:213], v[196:197], v[200:201], v[212:213] op_sel:[1,1,0] op_sel_hi:[1,0,1] neg_lo:[1,0,0]
    v_cvt_pk_bf16_f32 v64, v148, v149
    v_cvt_pk_bf16_f32 v68, v212, v213
    ds_write_b32 v57, v64 offset:18480
    ds_write_b32 v57, v68 offset:51248
    v_pk_mul_f32 v[150:151], v[134:135], v[136:137] op_sel:[0,0] op_sel_hi:[0,1]
    v_pk_mul_f32 v[214:215], v[198:199], v[200:201] op_sel:[0,0] op_sel_hi:[0,1]
    v_pk_fma_f32 v[150:151], v[134:135], v[136:137], v[150:151] op_sel:[1,1,0] op_sel_hi:[1,0,1] neg_lo:[1,0,0]
    v_pk_fma_f32 v[214:215], v[198:199], v[200:201], v[214:215] op_sel:[1,1,0] op_sel_hi:[1,0,1] neg_lo:[1,0,0]
    v_cvt_pk_bf16_f32 v65, v150, v151
    v_cvt_pk_bf16_f32 v69, v214, v215
    ds_write_b32 v57, v65 offset:19008
    ds_write_b32 v57, v69 offset:51776
    v_pk_mul_f32 v[152:153], v[136:137], v[136:137] op_sel:[0,0] op_sel_hi:[0,1]
    v_pk_mul_f32 v[216:217], v[200:201], v[200:201] op_sel:[0,0] op_sel_hi:[0,1]
    v_pk_fma_f32 v[152:153], v[136:137], v[136:137], v[152:153] op_sel:[1,1,0] op_sel_hi:[1,0,1] neg_lo:[1,0,0]
    v_pk_fma_f32 v[216:217], v[200:201], v[200:201], v[216:217] op_sel:[1,1,0] op_sel_hi:[1,0,1] neg_lo:[1,0,0]
    v_cvt_pk_bf16_f32 v64, v152, v153
    v_cvt_pk_bf16_f32 v68, v216, v217
    ds_write_b32 v57, v64 offset:19536
    ds_write_b32 v57, v68 offset:52304
    v_pk_mul_f32 v[154:155], v[122:123], v[152:153] op_sel:[0,0] op_sel_hi:[0,1]
    v_pk_mul_f32 v[218:219], v[186:187], v[216:217] op_sel:[0,0] op_sel_hi:[0,1]
    v_pk_fma_f32 v[154:155], v[122:123], v[152:153], v[154:155] op_sel:[1,1,0] op_sel_hi:[1,0,1] neg_lo:[1,0,0]
    v_pk_fma_f32 v[218:219], v[186:187], v[216:217], v[218:219] op_sel:[1,1,0] op_sel_hi:[1,0,1] neg_lo:[1,0,0]
    v_cvt_pk_bf16_f32 v65, v154, v155
    v_cvt_pk_bf16_f32 v69, v218, v219
    ds_write_b32 v57, v65 offset:20064
    ds_write_b32 v57, v69 offset:52832
    v_pk_mul_f32 v[156:157], v[124:125], v[152:153] op_sel:[0,0] op_sel_hi:[0,1]
    v_pk_mul_f32 v[220:221], v[188:189], v[216:217] op_sel:[0,0] op_sel_hi:[0,1]
    v_pk_fma_f32 v[156:157], v[124:125], v[152:153], v[156:157] op_sel:[1,1,0] op_sel_hi:[1,0,1] neg_lo:[1,0,0]
    v_pk_fma_f32 v[220:221], v[188:189], v[216:217], v[220:221] op_sel:[1,1,0] op_sel_hi:[1,0,1] neg_lo:[1,0,0]
    v_cvt_pk_bf16_f32 v64, v156, v157
    v_cvt_pk_bf16_f32 v68, v220, v221
    ds_write_b32 v57, v64 offset:20592
    ds_write_b32 v57, v68 offset:53360
    v_pk_mul_f32 v[158:159], v[126:127], v[152:153] op_sel:[0,0] op_sel_hi:[0,1]
    v_pk_mul_f32 v[222:223], v[190:191], v[216:217] op_sel:[0,0] op_sel_hi:[0,1]
    v_pk_fma_f32 v[158:159], v[126:127], v[152:153], v[158:159] op_sel:[1,1,0] op_sel_hi:[1,0,1] neg_lo:[1,0,0]
    v_pk_fma_f32 v[222:223], v[190:191], v[216:217], v[222:223] op_sel:[1,1,0] op_sel_hi:[1,0,1] neg_lo:[1,0,0]
    v_cvt_pk_bf16_f32 v65, v158, v159
    v_cvt_pk_bf16_f32 v69, v222, v223
    ds_write_b32 v57, v65 offset:21120
    ds_write_b32 v57, v69 offset:53888
    v_pk_mul_f32 v[160:161], v[128:129], v[152:153] op_sel:[0,0] op_sel_hi:[0,1]
    v_pk_mul_f32 v[224:225], v[192:193], v[216:217] op_sel:[0,0] op_sel_hi:[0,1]
    v_pk_fma_f32 v[160:161], v[128:129], v[152:153], v[160:161] op_sel:[1,1,0] op_sel_hi:[1,0,1] neg_lo:[1,0,0]
    v_pk_fma_f32 v[224:225], v[192:193], v[216:217], v[224:225] op_sel:[1,1,0] op_sel_hi:[1,0,1] neg_lo:[1,0,0]
    v_cvt_pk_bf16_f32 v64, v160, v161
    v_cvt_pk_bf16_f32 v68, v224, v225
    ds_write_b32 v57, v64 offset:21648
    ds_write_b32 v57, v68 offset:54416
    v_pk_mul_f32 v[162:163], v[130:131], v[152:153] op_sel:[0,0] op_sel_hi:[0,1]
    v_pk_mul_f32 v[226:227], v[194:195], v[216:217] op_sel:[0,0] op_sel_hi:[0,1]
    v_pk_fma_f32 v[162:163], v[130:131], v[152:153], v[162:163] op_sel:[1,1,0] op_sel_hi:[1,0,1] neg_lo:[1,0,0]
    v_pk_fma_f32 v[226:227], v[194:195], v[216:217], v[226:227] op_sel:[1,1,0] op_sel_hi:[1,0,1] neg_lo:[1,0,0]
    v_cvt_pk_bf16_f32 v65, v162, v163
    v_cvt_pk_bf16_f32 v69, v226, v227
    ds_write_b32 v57, v65 offset:22176
    ds_write_b32 v57, v69 offset:54944
    v_pk_mul_f32 v[164:165], v[132:133], v[152:153] op_sel:[0,0] op_sel_hi:[0,1]
    v_pk_mul_f32 v[228:229], v[196:197], v[216:217] op_sel:[0,0] op_sel_hi:[0,1]
    v_pk_fma_f32 v[164:165], v[132:133], v[152:153], v[164:165] op_sel:[1,1,0] op_sel_hi:[1,0,1] neg_lo:[1,0,0]
    v_pk_fma_f32 v[228:229], v[196:197], v[216:217], v[228:229] op_sel:[1,1,0] op_sel_hi:[1,0,1] neg_lo:[1,0,0]
    v_cvt_pk_bf16_f32 v64, v164, v165
    v_cvt_pk_bf16_f32 v68, v228, v229
    ds_write_b32 v57, v64 offset:22704
    ds_write_b32 v57, v68 offset:55472
    v_pk_mul_f32 v[166:167], v[134:135], v[152:153] op_sel:[0,0] op_sel_hi:[0,1]
    v_pk_mul_f32 v[230:231], v[198:199], v[216:217] op_sel:[0,0] op_sel_hi:[0,1]
    v_pk_fma_f32 v[166:167], v[134:135], v[152:153], v[166:167] op_sel:[1,1,0] op_sel_hi:[1,0,1] neg_lo:[1,0,0]
    v_pk_fma_f32 v[230:231], v[198:199], v[216:217], v[230:231] op_sel:[1,1,0] op_sel_hi:[1,0,1] neg_lo:[1,0,0]
    v_cvt_pk_bf16_f32 v65, v166, v167
    v_cvt_pk_bf16_f32 v69, v230, v231
    ds_write_b32 v57, v65 offset:23232
    ds_write_b32 v57, v69 offset:56000
    v_pk_mul_f32 v[168:169], v[136:137], v[152:153] op_sel:[0,0] op_sel_hi:[0,1]
    v_pk_mul_f32 v[232:233], v[200:201], v[216:217] op_sel:[0,0] op_sel_hi:[0,1]
    v_pk_fma_f32 v[168:169], v[136:137], v[152:153], v[168:169] op_sel:[1,1,0] op_sel_hi:[1,0,1] neg_lo:[1,0,0]
    v_pk_fma_f32 v[232:233], v[200:201], v[216:217], v[232:233] op_sel:[1,1,0] op_sel_hi:[1,0,1] neg_lo:[1,0,0]
    v_cvt_pk_bf16_f32 v64, v168, v169
    v_cvt_pk_bf16_f32 v68, v232, v233
    ds_write_b32 v57, v64 offset:23760
    ds_write_b32 v57, v68 offset:56528
    v_pk_mul_f32 v[170:171], v[138:139], v[152:153] op_sel:[0,0] op_sel_hi:[0,1]
    v_pk_mul_f32 v[234:235], v[202:203], v[216:217] op_sel:[0,0] op_sel_hi:[0,1]
    v_pk_fma_f32 v[170:171], v[138:139], v[152:153], v[170:171] op_sel:[1,1,0] op_sel_hi:[1,0,1] neg_lo:[1,0,0]
    v_pk_fma_f32 v[234:235], v[202:203], v[216:217], v[234:235] op_sel:[1,1,0] op_sel_hi:[1,0,1] neg_lo:[1,0,0]
    v_cvt_pk_bf16_f32 v65, v170, v171
    v_cvt_pk_bf16_f32 v69, v234, v235
    ds_write_b32 v57, v65 offset:24288
    ds_write_b32 v57, v69 offset:57056
    v_pk_mul_f32 v[172:173], v[140:141], v[152:153] op_sel:[0,0] op_sel_hi:[0,1]
    v_pk_mul_f32 v[236:237], v[204:205], v[216:217] op_sel:[0,0] op_sel_hi:[0,1]
    v_pk_fma_f32 v[172:173], v[140:141], v[152:153], v[172:173] op_sel:[1,1,0] op_sel_hi:[1,0,1] neg_lo:[1,0,0]
    v_pk_fma_f32 v[236:237], v[204:205], v[216:217], v[236:237] op_sel:[1,1,0] op_sel_hi:[1,0,1] neg_lo:[1,0,0]
    v_cvt_pk_bf16_f32 v64, v172, v173
    v_cvt_pk_bf16_f32 v68, v236, v237
    ds_write_b32 v57, v64 offset:24816
    ds_write_b32 v57, v68 offset:57584
    v_pk_mul_f32 v[174:175], v[142:143], v[152:153] op_sel:[0,0] op_sel_hi:[0,1]
    v_pk_mul_f32 v[238:239], v[206:207], v[216:217] op_sel:[0,0] op_sel_hi:[0,1]
    v_pk_fma_f32 v[174:175], v[142:143], v[152:153], v[174:175] op_sel:[1,1,0] op_sel_hi:[1,0,1] neg_lo:[1,0,0]
    v_pk_fma_f32 v[238:239], v[206:207], v[216:217], v[238:239] op_sel:[1,1,0] op_sel_hi:[1,0,1] neg_lo:[1,0,0]
    v_cvt_pk_bf16_f32 v65, v174, v175
    v_cvt_pk_bf16_f32 v69, v238, v239
    ds_write_b32 v57, v65 offset:25344
    ds_write_b32 v57, v69 offset:58112
    v_pk_mul_f32 v[176:177], v[144:145], v[152:153] op_sel:[0,0] op_sel_hi:[0,1]
    v_pk_mul_f32 v[240:241], v[208:209], v[216:217] op_sel:[0,0] op_sel_hi:[0,1]
    v_pk_fma_f32 v[176:177], v[144:145], v[152:153], v[176:177] op_sel:[1,1,0] op_sel_hi:[1,0,1] neg_lo:[1,0,0]
    v_pk_fma_f32 v[240:241], v[208:209], v[216:217], v[240:241] op_sel:[1,1,0] op_sel_hi:[1,0,1] neg_lo:[1,0,0]
    v_cvt_pk_bf16_f32 v64, v176, v177
    v_cvt_pk_bf16_f32 v68, v240, v241
    ds_write_b32 v57, v64 offset:25872
    ds_write_b32 v57, v68 offset:58640
    v_pk_mul_f32 v[178:179], v[146:147], v[152:153] op_sel:[0,0] op_sel_hi:[0,1]
    v_pk_mul_f32 v[242:243], v[210:211], v[216:217] op_sel:[0,0] op_sel_hi:[0,1]
    v_pk_fma_f32 v[178:179], v[146:147], v[152:153], v[178:179] op_sel:[1,1,0] op_sel_hi:[1,0,1] neg_lo:[1,0,0]
    v_pk_fma_f32 v[242:243], v[210:211], v[216:217], v[242:243] op_sel:[1,1,0] op_sel_hi:[1,0,1] neg_lo:[1,0,0]
    v_cvt_pk_bf16_f32 v65, v178, v179
    v_cvt_pk_bf16_f32 v69, v242, v243
    ds_write_b32 v57, v65 offset:26400
    ds_write_b32 v57, v69 offset:59168
    v_pk_mul_f32 v[180:181], v[148:149], v[152:153] op_sel:[0,0] op_sel_hi:[0,1]
    v_pk_mul_f32 v[244:245], v[212:213], v[216:217] op_sel:[0,0] op_sel_hi:[0,1]
    v_pk_fma_f32 v[180:181], v[148:149], v[152:153], v[180:181] op_sel:[1,1,0] op_sel_hi:[1,0,1] neg_lo:[1,0,0]
    v_pk_fma_f32 v[244:245], v[212:213], v[216:217], v[244:245] op_sel:[1,1,0] op_sel_hi:[1,0,1] neg_lo:[1,0,0]
    v_cvt_pk_bf16_f32 v64, v180, v181
    v_cvt_pk_bf16_f32 v68, v244, v245
    ds_write_b32 v57, v64 offset:26928
    ds_write_b32 v57, v68 offset:59696
    v_pk_mul_f32 v[182:183], v[150:151], v[152:153] op_sel:[0,0] op_sel_hi:[0,1]
    v_pk_mul_f32 v[246:247], v[214:215], v[216:217] op_sel:[0,0] op_sel_hi:[0,1]
    v_pk_fma_f32 v[182:183], v[150:151], v[152:153], v[182:183] op_sel:[1,1,0] op_sel_hi:[1,0,1] neg_lo:[1,0,0]
    v_pk_fma_f32 v[246:247], v[214:215], v[216:217], v[246:247] op_sel:[1,1,0] op_sel_hi:[1,0,1] neg_lo:[1,0,0]
    v_cvt_pk_bf16_f32 v65, v182, v183
    v_cvt_pk_bf16_f32 v69, v246, v247
    ds_write_b32 v57, v65 offset:27456
    ds_write_b32 v57, v69 offset:60224
    s_waitcnt vmcnt(0) lgkmcnt(0)
    s_branch kg_join
kg_aside:
    v_mul_f32 v66, 0x3fb8aa3b, v106
    v_mul_f32 v70, 0x3fb8aa3b, v114
    v_mul_f32 v67, 0x3e22f983, v107
    v_mul_f32 v71, 0x3e22f983, v115
    v_exp_f32 v66, v66
    v_exp_f32 v70, v70
    v_fract_f32 v67, v67
    v_fract_f32 v71, v71
    v_cos_f32 v164, v67
    v_cos_f32 v228, v71
    v_sin_f32 v165, v67
    v_sin_f32 v229, v71
    v_mul_f32 v164, v164, v66
    v_mul_f32 v228, v228, v70
    v_mul_f32 v165, v165, v66
    v_mul_f32 v229, v229, v70
    v_mul_f32 v176, 0x43b8aa3b, v106
    v_mul_f32 v240, 0x43b8aa3b, v114
    v_mul_f32 v177, 0x4222f983, v107
    v_mul_f32 v241, 0x4222f983, v115
    v_exp_f32 v176, v176
    v_exp_f32 v240, v240
    v_fract_f32 v177, v177
    v_fract_f32 v241, v241
    v_cos_f32 v170, v177
    v_cos_f32 v234, v241
    v_sin_f32 v171, v177
    v_sin_f32 v235, v241
    v_mul_f32 v170, v170, v176
    v_mul_f32 v234, v234, v240
    v_mul_f32 v171, v171, v176
    v_mul_f32 v235, v235, v240
    v_pk_mul_f32 v[120:121], v[108:109], v[110:111] op_sel:[0,0] op_sel_hi:[0,1]
    v_pk_mul_f32 v[184:185], v[116:117], v[118:119] op_sel:[0,0] op_sel_hi:[0,1]
    v_pk_fma_f32 v[120:121], v[108:109], v[110:111], v[120:121] op_sel:[1,1,0] op_sel_hi:[1,0,1] neg_lo:[1,0,0]
    v_pk_fma_f32 v[184:185], v[116:117], v[118:119], v[184:185] op_sel:[1,1,0] op_sel_hi:[1,0,1] neg_lo:[1,0,0]
    v_pk_mul_f32 v[166:167], v[164:165], v[164:165] op_sel:[0,0] op_sel_hi:[0,1]
    v_pk_mul_f32 v[230:231], v[228:229], v[228:229] op_sel:[0,0] op_sel_hi:[0,1]
    v_pk_fma_f32 v[166:167], v[164:165], v[164:165], v[166:167] op_sel:[1,1,0] op_sel_hi:[1,0,1] neg_lo:[1,0,0]
    v_pk_fma_f32 v[230:231], v[228:229], v[228:229], v[230:231] op_sel:[1,1,0] op_sel_hi:[1,0,1] neg_lo:[1,0,0]
    v_pk_mul_f32 v[172:173], v[170:171], v[170:171] op_sel:[0,0] op_sel_hi:[0,1]
    v_pk_mul_f32 v[236:237], v[234:235], v[234:235] op_sel:[0,0] op_sel_hi:[0,1]
    v_pk_fma_f32 v[172:173], v[170:171], v[170:171], v[172:173] op_sel:[1,1,0] op_sel_hi:[1,0,1] neg_lo:[1,0,0]
    v_pk_fma_f32 v[236:237], v[234:235], v[234:235], v[236:237] op_sel:[1,1,0] op_sel_hi:[1,0,1] neg_lo:[1,0,0]
    v_cvt_pk_bf16_f32 v64, v120, -v121
    v_cvt_pk_bf16_f32 v68, v184, -v185
    ds_write_b32 v57, v64 offset:0
    ds_write_b32 v57, v68 offset:32768
    v_pk_mul_f32 v[122:123], v[120:121], v[164:165] op_sel:[0,0] op_sel_hi:[0,1]
    v_pk_mul_f32 v[186:187], v[184:185], v[228:229] op_sel:[0,0] op_sel_hi:[0,1]
    v_pk_fma_f32 v[122:123], v[120:121], v[164:165], v[122:123] op_sel:[1,1,0] op_sel_hi:[1,0,1] neg_lo:[1,0,0]
    v_pk_fma_f32 v[186:187], v[184:185], v[228:229], v[186:187] op_sel:[1,1,0] op_sel_hi:[1,0,1] neg_lo:[1,0,0]
    v_pk_mul_f32 v[168:169], v[166:167], v[166:167] op_sel:[0,0] op_sel_hi:[0,1]
    v_pk_mul_f32 v[232:233], v[230:231], v[230:231] op_sel:[0,0] op_sel_hi:[0,1]
    v_pk_fma_f32 v[168:169], v[166:167], v[166:167], v[168:169] op_sel:[1,1,0] op_sel_hi:[1,0,1] neg_lo:[1,0,0]
    v_pk_fma_f32 v[232:233], v[230:231], v[230:231], v[232:233] op_sel:[1,1,0] op_sel_hi:[1,0,1] neg_lo:[1,0,0]
    v_pk_mul_f32 v[174:175], v[172:173], v[172:173] op_sel:[0,0] op_sel_hi:[0,1]
    v_pk_mul_f32 v[238:239], v[236:237], v[236:237] op_sel:[0,0] op_sel_hi:[0,1]
    v_pk_fma_f32 v[174:175], v[172:173], v[172:173], v[174:175] op_sel:[1,1,0] op_sel_hi:[1,0,1] neg_lo:[1,0,0]
    v_pk_fma_f32 v[238:239], v[236:237], v[236:237], v[238:239] op_sel:[1,1,0] op_sel_hi:[1,0,1] neg_lo:[1,0,0]
    v_cvt_pk_bf16_f32 v65, v122, -v123
    v_cvt_pk_bf16_f32 v69, v186, -v187
    ds_write_b32 v57, v65 offset:528
    ds_write_b32 v57, v69 offset:33296
    v_pk_mul_f32 v[124:125], v[120:121], v[166:167] op_sel:[0,0] op_sel_hi:[0,1]
    v_pk_mul_f32 v[188:189], v[184:185], v[230:231] op_sel:[0,0] op_sel_hi:[0,1]
    v_pk_fma_f32 v[124:125], v[120:121], v[166:167], v[124:125] op_sel:[1,1,0] op_sel_hi:[1,0,1] neg_lo:[1,0,0]
    v_pk_fma_f32 v[188:189], v[184:185], v[230:231], v[188:189] op_sel:[1,1,0] op_sel_hi:[1,0,1] neg_lo:[1,0,0]
    v_cvt_pk_bf16_f32 v64, v124, -v125
    v_cvt_pk_bf16_f32 v68, v188, -v189
    ds_write_b32 v57, v64 offset:1056
    ds_write_b32 v57, v68 offset:33824
    v_pk_mul_f32 v[126:127], v[122:123], v[166:167] op_sel:[0,0] op_sel_hi:[0,1]
    v_pk_mul_f32 v[190:191], v[186:187], v[230:231] op_sel:[0,0] op_sel_hi:[0,1]
    v_pk_fma_f32 v[126:127], v[122:123], v[166:167], v[126:127] op_sel:[1,1,0] op_sel_hi:[1,0,1] neg_lo:[1,0,0]
    v_pk_fma_f32 v[190:191], v[186:187], v[230:231], v[190:191] op_sel:[1,1,0] op_sel_hi:[1,0,1] neg_lo:[1,0,0]
    v_cvt_pk_bf16_f32 v65, v126, -v127
    v_cvt_pk_bf16_f32 v69, v190, -v191
    ds_write_b32 v57, v65 offset:1584
    ds_write_b32 v57, v69 offset:34352
    v_pk_mul_f32 v[128:129], v[120:121], v[168:169] op_sel:[0,0] op_sel_hi:[0,1]
    v_pk_mul_f32 v[192:193], v[184:185], v[232:233] op_sel:[0,0] op_sel_hi:[0,1]
    v_pk_fma_f32 v[128:129], v[120:121], v[168:169], v[128:129] op_sel:[1,1,0] op_sel_hi:[1,0,1] neg_lo:[1,0,0]
    v_pk_fma_f32 v[192:193], v[184:185], v[232:233], v[192:193] op_sel:[1,1,0] op_sel_hi:[1,0,1] neg_lo:[1,0,0]
    v_cvt_pk_bf16_f32 v64, v128, -v129
    v_cvt_pk_bf16_f32 v68, v192, -v193
    ds_write_b32 v57, v64 offset:2112
    ds_write_b32 v57, v68 offset:34880
    v_pk_mul_f32 v[130:131], v[122:123], v[168:169] op_sel:[0,0] op_sel_hi:[0,1]
    v_pk_mul_f32 v[194:195], v[186:187], v[232:233] op_sel:[0,0] op_sel_hi:[0,1]
    v_pk_fma_f32 v[130:131], v[122:123], v[168:169], v[130:131] op_sel:[1,1,0] op_sel_hi:[1,0,1] neg_lo:[1,0,0]
    v_pk_fma_f32 v[194:195], v[186:187], v[232:233], v[194:195] op_sel:[1,1,0] op_sel_hi:[1,0,1] neg_lo:[1,0,0]
    v_cvt_pk_bf16_f32 v65, v130, -v131
    v_cvt_pk_bf16_f32 v69, v194, -v195
    ds_write_b32 v57, v65 offset:2640
    ds_write_b32 v57, v69 offset:35408
    v_pk_mul_f32 v[132:133], v[124:125], v[168:169] op_sel:[0,0] op_sel_hi:[0,1]
    v_pk_mul_f32 v[196:197], v[188:189], v[232:233] op_sel:[0,0] op_sel_hi:[0,1]
    v_pk_fma_f32 v[132:133], v[124:125], v[168:169], v[132:133] op_sel:[1,1,0] op_sel_hi:[1,0,1] neg_lo:[1,0,0]
    v_pk_fma_f32 v[196:197], v[188:189], v[232:233], v[196:197] op_sel:[1,1,0] op_sel_hi:[1,0,1] neg_lo:[1,0,0]
    v_cvt_pk_bf16_f32 v64, v132, -v133
    v_cvt_pk_bf16_f32 v68, v196, -v197
    ds_write_b32 v57, v64 offset:3168
    ds_write_b32 v57, v68 offset:35936
    v_pk_mul_f32 v[134:135], v[126:127], v[168:169] op_sel:[0,0] op_sel_hi:[0,1]
    v_pk_mul_f32 v[198:199], v[190:191], v[232:233] op_sel:[0,0] op_sel_hi:[0,1]
    v_pk_fma_f32 v[134:135], v[126:127], v[168:169], v[134:135] op_sel:[1,1,0] op_sel_hi:[1,0,1] neg_lo:[1,0,0]
    v_pk_fma_f32 v[198:199], v[190:191], v[232:233], v[198:199] op_sel:[1,1,0] op_sel_hi:[1,0,1] neg_lo:[1,0,0]
    v_cvt_pk_bf16_f32 v65, v134, -v135
    v_cvt_pk_bf16_f32 v69, v198, -v199
    ds_write_b32 v57, v65 offset:3696
    ds_write_b32 v57, v69 offset:36464
    v_pk_mul_f32 v[136:137], v[120:121], v[170:171] op_sel:[0,0] op_sel_hi:[0,1]
    v_pk_mul_f32 v[200:201], v[184:185], v[234:235] op_sel:[0,0] op_sel_hi:[0,1]
    v_pk_fma_f32 v[136:137], v[120:121], v[170:171], v[136:137] op_sel:[1,1,0] op_sel_hi:[1,0,1] neg_lo:[1,0,0]
    v_pk_fma_f32 v[200:201], v[184:185], v[234:235], v[200:201] op_sel:[1,1,0] op_sel_hi:[1,0,1] neg_lo:[1,0,0]
    v_cvt_pk_bf16_f32 v64, v136, -v137
    v_cvt_pk_bf16_f32 v68, v200, -v201
    ds_write_b32 v57, v64 offset:4224
    ds_write_b32 v57, v68 offset:36992
    v_pk_mul_f32 v[138:139], v[124:125], v[170:171] op_sel:[0,0] op_sel_hi:[0,1]
    v_pk_mul_f32 v[202:203], v[188:189], v[234:235] op_sel:[0,0] op_sel_hi:[0,1]
    v_pk_fma_f32 v[138:139], v[124:125], v[170:171], v[138:139] op_sel:[1,1,0] op_sel_hi:[1,0,1] neg_lo:[1,0,0]
    v_pk_fma_f32 v[202:203], v[188:189], v[234:235], v[202:203] op_sel:[1,1,0] op_sel_hi:[1,0,1] neg_lo:[1,0,0]
    v_cvt_pk_bf16_f32 v65, v138, -v139
    v_cvt_pk_bf16_f32 v69, v202, -v203
    ds_write_b32 v57, v65 offset:4752
    ds_write_b32 v57, v69 offset:37520
    v_lshlrev_b32 v251, 6, v62
    buffer_load_dword v250, v251, s[96:99], 0 offen sc1
    v_pk_mul_f32 v[140:141], v[128:129], v[170:171] op_sel:[0,0] op_sel_hi:[0,1]
    v_pk_mul_f32 v[204:205], v[192:193], v[234:235] op_sel:[0,0] op_sel_hi:[0,1]
    v_pk_fma_f32 v[140:141], v[128:129], v[170:171], v[140:141] op_sel:[1,1,0] op_sel_hi:[1,0,1] neg_lo:[1,0,0]
    v_pk_fma_f32 v[204:205], v[192:193], v[234:235], v[204:205] op_sel:[1,1,0] op_sel_hi:[1,0,1] neg_lo:[1,0,0]
    v_cvt_pk_bf16_f32 v64, v140, -v141
    v_cvt_pk_bf16_f32 v68, v204, -v205
    ds_write_b32 v57, v64 offset:5280
    ds_write_b32 v57, v68 offset:38048
    v_pk_mul_f32 v[142:143], v[132:133], v[170:171] op_sel:[0,0] op_sel_hi:[0,1]
    v_pk_mul_f32 v[206:207], v[196:197], v[234:235] op_sel:[0,0] op_sel_hi:[0,1]
    v_pk_fma_f32 v[142:143], v[132:133], v[170:171], v[142:143] op_sel:[1,1,0] op_sel_hi:[1,0,1] neg_lo:[1,0,0]
    v_pk_fma_f32 v[206:207], v[196:197], v[234:235], v[206:207] op_sel:[1,1,0] op_sel_hi:[1,0,1] neg_lo:[1,0,0]
    v_cvt_pk_bf16_f32 v65, v142, -v143
    v_cvt_pk_bf16_f32 v69, v206, -v207
    ds_write_b32 v57, v65 offset:5808
    ds_write_b32 v57, v69 offset:38576
    v_pk_mul_f32 v[144:145], v[120:121], v[172:173] op_sel:[0,0] op_sel_hi:[0,1]
    v_pk_mul_f32 v[208:209], v[184:185], v[236:237] op_sel:[0,0] op_sel_hi:[0,1]
    v_pk_fma_f32 v[144:145], v[120:121], v[172:173], v[144:145] op_sel:[1,1,0] op_sel_hi:[1,0,1] neg_lo:[1,0,0]
    v_pk_fma_f32 v[208:209], v[184:185], v[236:237], v[208:209] op_sel:[1,1,0] op_sel_hi:[1,0,1] neg_lo:[1,0,0]
    v_cvt_pk_bf16_f32 v64, v144, -v145
    v_cvt_pk_bf16_f32 v68, v208, -v209
    ds_write_b32 v57, v64 offset:6336
    ds_write_b32 v57, v68 offset:39104
    v_pk_mul_f32 v[146:147], v[128:129], v[172:173] op_sel:[0,0] op_sel_hi:[0,1]
    v_pk_mul_f32 v[210:211], v[192:193], v[236:237] op_sel:[0,0] op_sel_hi:[0,1]
    v_pk_fma_f32 v[146:147], v[128:129], v[172:173], v[146:147] op_sel:[1,1,0] op_sel_hi:[1,0,1] neg_lo:[1,0,0]
    v_pk_fma_f32 v[210:211], v[192:193], v[236:237], v[210:211] op_sel:[1,1,0] op_sel_hi:[1,0,1] neg_lo:[1,0,0]
    v_cvt_pk_bf16_f32 v65, v146, -v147
    v_cvt_pk_bf16_f32 v69, v210, -v211
    ds_write_b32 v57, v65 offset:6864
    ds_write_b32 v57, v69 offset:39632
    v_pk_mul_f32 v[148:149], v[136:137], v[172:173] op_sel:[0,0] op_sel_hi:[0,1]
    v_pk_mul_f32 v[212:213], v[200:201], v[236:237] op_sel:[0,0] op_sel_hi:[0,1]
    v_pk_fma_f32 v[148:149], v[136:137], v[172:173], v[148:149] op_sel:[1,1,0] op_sel_hi:[1,0,1] neg_lo:[1,0,0]
    v_pk_fma_f32 v[212:213], v[200:201], v[236:237], v[212:213] op_sel:[1,1,0] op_sel_hi:[1,0,1] neg_lo:[1,0,0]
    v_cvt_pk_bf16_f32 v64, v148, -v149
    v_cvt_pk_bf16_f32 v68, v212, -v213
    ds_write_b32 v57, v64 offset:7392
    ds_write_b32 v57, v68 offset:40160
    v_pk_mul_f32 v[150:151], v[140:141], v[172:173] op_sel:[0,0] op_sel_hi:[0,1]
    v_pk_mul_f32 v[214:215], v[204:205], v[236:237] op_sel:[0,0] op_sel_hi:[0,1]
    v_pk_fma_f32 v[150:151], v[140:141], v[172:173], v[150:151] op_sel:[1,1,0] op_sel_hi:[1,0,1] neg_lo:[1,0,0]
    v_pk_fma_f32 v[214:215], v[204:205], v[236:237], v[214:215] op_sel:[1,1,0] op_sel_hi:[1,0,1] neg_lo:[1,0,0]
    v_cvt_pk_bf16_f32 v65, v150, -v151
    v_cvt_pk_bf16_f32 v69, v214, -v215
    ds_write_b32 v57, v65 offset:7920
    ds_write_b32 v57, v69 offset:40688
    v_pk_mul_f32 v[152:153], v[120:121], v[174:175] op_sel:[0,0] op_sel_hi:[0,1]
    v_pk_mul_f32 v[216:217], v[184:185], v[238:239] op_sel:[0,0] op_sel_hi:[0,1]
    v_pk_fma_f32 v[152:153], v[120:121], v[174:175], v[152:153] op_sel:[1,1,0] op_sel_hi:[1,0,1] neg_lo:[1,0,0]
    v_pk_fma_f32 v[216:217], v[184:185], v[238:239], v[216:217] op_sel:[1,1,0] op_sel_hi:[1,0,1] neg_lo:[1,0,0]
    v_cvt_pk_bf16_f32 v64, v152, -v153
    v_cvt_pk_bf16_f32 v68, v216, -v217
    ds_write_b32 v57, v64 offset:8448
    ds_write_b32 v57, v68 offset:41216
    v_pk_mul_f32 v[154:155], v[136:137], v[174:175] op_sel:[0,0] op_sel_hi:[0,1]
    v_pk_mul_f32 v[218:219], v[200:201], v[238:239] op_sel:[0,0] op_sel_hi:[0,1]
    v_pk_fma_f32 v[154:155], v[136:137], v[174:175], v[154:155] op_sel:[1,1,0] op_sel_hi:[1,0,1] neg_lo:[1,0,0]
    v_pk_fma_f32 v[218:219], v[200:201], v[238:239], v[218:219] op_sel:[1,1,0] op_sel_hi:[1,0,1] neg_lo:[1,0,0]
    v_cvt_pk_bf16_f32 v65, v154, -v155
    v_cvt_pk_bf16_f32 v69, v218, -v219
    ds_write_b32 v57, v65 offset:8976
    ds_write_b32 v57, v69 offset:41744
    v_pk_mul_f32 v[156:157], v[144:145], v[174:175] op_sel:[0,0] op_sel_hi:[0,1]
    v_pk_mul_f32 v[220:221], v[208:209], v[238:239] op_sel:[0,0] op_sel_hi:[0,1]
    v_pk_fma_f32 v[156:157], v[144:145], v[174:175], v[156:157] op_sel:[1,1,0] op_sel_hi:[1,0,1] neg_lo:[1,0,0]
    v_pk_fma_f32 v[220:221], v[208:209], v[238:239], v[220:221] op_sel:[1,1,0] op_sel_hi:[1,0,1] neg_lo:[1,0,0]
    v_cvt_pk_bf16_f32 v64, v156, -v157
    v_cvt_pk_bf16_f32 v68, v220, -v221
    ds_write_b32 v57, v64 offset:9504
    ds_write_b32 v57, v68 offset:42272
    v_pk_mul_f32 v[158:159], v[148:149], v[174:175] op_sel:[0,0] op_sel_hi:[0,1]
    v_pk_mul_f32 v[222:223], v[212:213], v[238:239] op_sel:[0,0] op_sel_hi:[0,1]
    v_pk_fma_f32 v[158:159], v[148:149], v[174:175], v[158:159] op_sel:[1,1,0] op_sel_hi:[1,0,1] neg_lo:[1,0,0]
    v_pk_fma_f32 v[222:223], v[212:213], v[238:239], v[222:223] op_sel:[1,1,0] op_sel_hi:[1,0,1] neg_lo:[1,0,0]
    v_cvt_pk_bf16_f32 v65, v158, -v159
    v_cvt_pk_bf16_f32 v69, v222, -v223
    ds_write_b32 v57, v65 offset:10032
    ds_write_b32 v57, v69 offset:42800
    v_pk_mul_f32 v[160:161], v[152:153], v[174:175] op_sel:[0,0] op_sel_hi:[0,1]
    v_pk_mul_f32 v[224:225], v[216:217], v[238:239] op_sel:[0,0] op_sel_hi:[0,1]
    v_pk_fma_f32 v[160:161], v[152:153], v[174:175], v[160:161] op_sel:[1,1,0] op_sel_hi:[1,0,1] neg_lo:[1,0,0]
    v_pk_fma_f32 v[224:225], v[216:217], v[238:239], v[224:225] op_sel:[1,1,0] op_sel_hi:[1,0,1] neg_lo:[1,0,0]
    v_cvt_pk_bf16_f32 v64, v160, -v161
    v_cvt_pk_bf16_f32 v68, v224, -v225
    ds_write_b32 v57, v64 offset:10560
    ds_write_b32 v57, v68 offset:43328
    s_waitcnt vmcnt(0)
    v_cmp_gt_u32 vcc, 16, v250
    s_nop 1
    s_cbranch_vccz pok1
    s_mov_b32 s18, 40000
    s_nop 0
psp1:
    s_sleep 2
    buffer_load_dword v250, v251, s[96:99], 0 offen sc1
    s_waitcnt vmcnt(0)
    v_cmp_gt_u32 vcc, 16, v250
    s_nop 1
    s_cbranch_vccz pok1
    s_sub_u32 s18, s18, 1
    s_cbranch_scc0 psp1
    s_endpgm
pok1:
    s_waitcnt lgkmcnt(0)
kg_join:
    v_mul_u32_u24 v52, 528, v3
    v_lshl_add_u32 v52, v4, 4, v52
    s_mul_i32 s16, s13, 8448
    s_mul_i32 s17, s14, 8448
    v_add_u32 v53, s17, v52
    v_add_u32 v52, s16, v52
    v_cmp_eq_u32 vcc, 0, v0
    s_nop 1
    v_cndmask_b32 v61, 0, v61, vcc
    ds_write2_b32 v45, v80, v84 offset0:0 offset1:1
    ds_write2_b32 v45, v81, v85 offset0:2 offset1:3
    ds_write2_b32 v45, v82, v86 offset0:4 offset1:5
    ds_write2_b32 v45, v83, v87 offset0:6 offset1:7
    ds_write2_b32 v46, v88, v92 offset0:0 offset1:1
    ds_write2_b32 v46, v89, v93 offset0:2 offset1:3
    ds_write2_b32 v46, v90, v94 offset0:4 offset1:5
    ds_write2_b32 v46, v91, v95 offset0:6 offset1:7
    ds_write_b128 v59, v[96:99]
    ds_write_b128 v59, v[100:103] offset:4608
    s_waitcnt lgkmcnt(0)
    s_add_u32 s19, s8, 33226752
    s_barrier
    buffer_store_dword v32, v30, s[20:23], s19 offen sc1
    ds_read_b64_tr_b16 v[80:81], v58 offset:0
    ds_read_b64_tr_b16 v[82:83], v58 offset:5632
    ds_read_b64_tr_b16 v[84:85], v58 offset:128
    ds_read_b64_tr_b16 v[86:87], v58 offset:5760
    ds_read_b64_tr_b16 v[88:89], v58 offset:256
    ds_read_b64_tr_b16 v[90:91], v58 offset:5888
    ds_read_b64_tr_b16 v[92:93], v63 offset:0
    ds_read_b64_tr_b16 v[94:95], v63 offset:4608
    ds_read_b64_tr_b16 v[96:97], v63 offset:128
    ds_read_b64_tr_b16 v[98:99], v63 offset:4736
    ds_read_b128 v[120:123], v52 offset:0
    ds_read_b128 v[124:127], v53 offset:11088
    ds_read_b128 v[184:187], v52 offset:32768
    ds_read_b128 v[188:191], v53 offset:43856
    ds_read_b128 v[128:131], v52 offset:64
    ds_read_b128 v[132:135], v53 offset:11152
    s_waitcnt lgkmcnt(14)
    v_mfma_f32_16x16x32_bf16 v[64:67], v[80:83], v[72:75], 0
    ds_read_b128 v[192:195], v52 offset:32832
    buffer_store_dwordx4 v[80:83], v5, s[20:23], s6 offen sc1
    ds_read_b128 v[196:199], v53 offset:43920
    s_add_u32 s6, s6, 65536
    ds_read_b128 v[136:139], v52 offset:128
    s_waitcnt lgkmcnt(15)
    v_mfma_f32_16x16x32_bf16 v[68:71], v[84:87], v[72:75], 0
    ds_read_b128 v[140:143], v53 offset:11216
    buffer_store_dwordx4 v[84:87], v5, s[20:23], s6 offen sc1
    ds_read_b128 v[200:203], v52 offset:32896
    s_add_u32 s6, s6, 65536
    ds_read_b128 v[204:207], v53 offset:43984
    s_waitcnt lgkmcnt(15)
    v_mfma_f32_16x16x32_bf16 v[100:103], v[88:91], v[72:75], 0
    ds_read_b128 v[144:147], v52 offset:192
    buffer_store_dwordx4 v[88:91], v33, s[20:23], s6 offen sc1
    ds_read_b128 v[148:151], v53 offset:11280
    s_add_u32 s6, s6, 65536
    ds_read_b128 v[208:211], v52 offset:32960
    s_waitcnt lgkmcnt(15)
    buffer_store_dwordx4 v[92:95], v56, s[20:23], s63 offen sc1
    ds_read_b128 v[212:215], v53 offset:44048
    s_add_u32 s63, s63, 180224
    ds_read_b128 v[152:155], v52 offset:256
    buffer_store_dwordx4 v[96:99], v56, s[20:23], s63 offen sc1
    ds_read_b128 v[156:159], v53 offset:11344
    s_add_u32 s63, s63, 180224
    ds_read_b128 v[216:219], v52 offset:33024
    v_cndmask_b32 v64, v64, v68, s[52:53]
    ds_read_b128 v[220:223], v53 offset:44112
    v_cndmask_b32 v65, v65, v69, s[52:53]
    ds_read_b128 v[160:163], v52 offset:320
    v_cndmask_b32 v66, v66, v70, s[52:53]
    ds_read_b128 v[164:167], v53 offset:11408
    v_cndmask_b32 v67, v67, v71, s[52:53]
    ds_read_b128 v[224:227], v52 offset:33088
    v_cndmask_b32 v64, v64, v100, s[54:55]
    ds_read_b128 v[228:231], v53 offset:44176
    v_cndmask_b32 v65, v65, v101, s[54:55]
    ds_read_b128 v[168:171], v52 offset:384
    v_cndmask_b32 v66, v66, v102, s[54:55]
    ds_read_b128 v[172:175], v53 offset:11472
    v_cndmask_b32 v67, v67, v103, s[54:55]
    ds_read_b128 v[232:235], v52 offset:33152
    buffer_store_dwordx4 v[64:67], v55, s[20:23], s7 offen sc1
    ds_read_b128 v[236:239], v53 offset:44240
    ds_read_b128 v[176:179], v52 offset:448
    ds_read_b128 v[180:183], v53 offset:11536
    ds_read_b128 v[240:243], v52 offset:33216
    ds_read_b128 v[244:247], v53 offset:44304
    s_waitcnt lgkmcnt(15)
    v_mfma_f32_16x16x32_bf16 v[112:115], v[120:123], v[124:127], 0
    v_mfma_f32_16x16x32_bf16 v[116:119], v[184:187], v[188:191], 0
    v_mfma_f32_16x16x32_bf16 v[112:115], v[128:131], v[132:135], v[112:115]
    v_mfma_f32_16x16x32_bf16 v[116:119], v[192:195], v[196:199], v[116:119]
    v_mfma_f32_16x16x32_bf16 v[112:115], v[136:139], v[140:143], v[112:115]
    v_mfma_f32_16x16x32_bf16 v[116:119], v[200:203], v[204:207], v[116:119]
    v_mfma_f32_16x16x32_bf16 v[112:115], v[144:147], v[148:151], v[112:115]
    v_mfma_f32_16x16x32_bf16 v[116:119], v[208:211], v[212:215], v[116:119]
    s_waitcnt lgkmcnt(14)
    v_mfma_f32_16x16x32_bf16 v[112:115], v[152:155], v[156:159], v[112:115]
    s_waitcnt lgkmcnt(12)
    v_mfma_f32_16x16x32_bf16 v[116:119], v[216:219], v[220:223], v[116:119]
    s_waitcnt lgkmcnt(10)
    v_mfma_f32_16x16x32_bf16 v[112:115], v[160:163], v[164:167], v[112:115]
    s_waitcnt lgkmcnt(8)
    v_mfma_f32_16x16x32_bf16 v[116:119], v[224:227], v[228:231], v[116:119]
    s_waitcnt lgkmcnt(6)
    v_mfma_f32_16x16x32_bf16 v[112:115], v[168:171], v[172:175], v[112:115]
    s_waitcnt lgkmcnt(4)
    v_mfma_f32_16x16x32_bf16 v[116:119], v[232:235], v[236:239], v[116:119]
    s_waitcnt lgkmcnt(2)
    v_mfma_f32_16x16x32_bf16 v[112:115], v[176:179], v[180:183], v[112:115]
    s_waitcnt lgkmcnt(0)
    v_mfma_f32_16x16x32_bf16 v[116:119], v[240:243], v[244:247], v[116:119]
    v_lshl_add_u32 v52, s14, 4, v3
    v_lshlrev_b32 v1, 16, v61
    v_and_b32 v61, 0xffff0000, v61
    s_nop 2
    v_add_f32 v112, v112, v1
    s_nop 0
    v_add_f32 v116, v116, v61
    v_cvt_pk_bf16_f32 v112, v112, v113
    v_cvt_pk_bf16_f32 v114, v114, v115
    v_cvt_pk_bf16_f32 v116, v116, v117
    v_cvt_pk_bf16_f32 v118, v118, v119
    s_cmp_eq_u32 s13, 1
    s_cbranch_scc1 kg_mt1
    v_lshlrev_b32 v53, 3, v52
    v_lshl_add_u32 v53, v4, 2, v53
    v_lshlrev_b32 v56, 2, v52
    v_add_u32 v56, 256, v56
    v_cmp_eq_u32 vcc, 2, v4
    s_nop 1
    v_cndmask_b32 v53, v53, v56, vcc
    v_lshlrev_b32 v56, 1, v52
    v_add_u32 v56, 384, v56
    v_cmp_eq_u32 vcc, 3, v4
    s_nop 1
    v_cndmask_b32 v53, v53, v56, vcc
    v_cndmask_b32 v56, 2, 64, vcc
    v_add_u32 v56, v53, v56
    v_lshlrev_b32 v53, 1, v53
    v_lshlrev_b32 v56, 1, v56
    ds_write_b32 v53, v112 offset:28016
    ds_write_b32 v56, v114 offset:28016
    ds_write_b32 v53, v116 offset:60784
    ds_write_b32 v56, v118 offset:60784
    s_waitcnt lgkmcnt(0)
    s_branch kg_tab
kg_mt1:
    v_lshl_add_u32 v53, v4, 7, v52
    v_lshlrev_b32 v53, 1, v53
    ds_write_b16 v53, v112 offset:29040
    ds_write_b16_d16_hi v53, v112 offset:29104
    ds_write_b16 v53, v114 offset:29168
    ds_write_b16_d16_hi v53, v114 offset:29232
    ds_write_b16 v53, v116 offset:61808
    ds_write_b16_d16_hi v53, v116 offset:61872
    ds_write_b16 v53, v118 offset:61936
    ds_write_b16_d16_hi v53, v118 offset:62000
    s_waitcnt lgkmcnt(0)
kg_tab:
    s_barrier
    ds_read_u16 v120, v36 offset:28016
    ds_read_u16 v121, v37 offset:28016
    ds_read_u16 v122, v38 offset:28016
    ds_read_u16 v123, v39 offset:28016
    ds_read_u16 v124, v40 offset:28016
    ds_read_u16 v125, v41 offset:28016
    ds_read_u16 v126, v42 offset:28016
    ds_read_u16 v127, v43 offset:28016
    ds_read_u16 v128, v44 offset:28014
    ds_read_u16 v136, v36 offset:60784
    ds_read_u16 v137, v37 offset:60784
    ds_read_u16 v138, v38 offset:60784
    ds_read_u16 v139, v39 offset:60784
    ds_read_u16 v140, v40 offset:60784
    ds_read_u16 v141, v41 offset:60784
    ds_read_u16 v142, v42 offset:60784
    ds_read_u16 v143, v43 offset:60784
    ds_read_u16 v144, v44 offset:60782
    v_add_u32 v1, 141312, v6
    s_mov_b32 s19, 33226752
    buffer_load_dword v48, v29, s[20:23], s19 offen sc1
    s_waitcnt lgkmcnt(15)
    v_lshl_or_b32 v152, v121, 16, v120
    s_waitcnt lgkmcnt(14)
    v_lshl_or_b32 v153, v123, 16, v122
    s_waitcnt lgkmcnt(12)
    v_lshl_or_b32 v154, v125, 16, v124
    s_waitcnt lgkmcnt(10)
    v_lshl_or_b32 v155, v127, 16, v126
    ds_write_b128 v1, v[152:155] offset:0
    v_lshl_or_b32 v156, v122, 16, v121
    v_lshl_or_b32 v157, v124, 16, v123
    v_lshl_or_b32 v158, v126, 16, v125
    s_waitcnt lgkmcnt(10)
    v_lshl_or_b32 v159, v128, 16, v127
    ds_write_b128 v1, v[156:159] offset:4160
    s_waitcnt lgkmcnt(9)
    v_lshl_or_b32 v160, v137, 16, v136
    s_waitcnt lgkmcnt(7)
    v_lshl_or_b32 v161, v139, 16, v138
    s_waitcnt lgkmcnt(5)
    v_lshl_or_b32 v162, v141, 16, v140
    s_waitcnt lgkmcnt(3)
    v_lshl_or_b32 v163, v143, 16, v142
    ds_write_b128 v1, v[160:163] offset:8320
    v_lshl_or_b32 v164, v138, 16, v137
    v_lshl_or_b32 v165, v140, 16, v139
    v_lshl_or_b32 v166, v142, 16, v141
    s_waitcnt lgkmcnt(3)
    v_lshl_or_b32 v167, v144, 16, v143
    ds_write_b128 v1, v[164:167] offset:12480
    v_add_u32 v244, 1024, v9
    v_add_u32 v245, 2048, v9
    v_add_u32 v246, 3072, v9
    s_waitcnt lgkmcnt(0)
    s_add_u32 s19, s47, 33259520
    s_waitcnt vmcnt(1)
    s_barrier
    buffer_store_dword v32, v30, s[20:23], s19 offen sc1
    ds_read2_b32 a[192:193], v246 offset0:176 offset1:177
    ds_read2_b32 a[194:195], v246 offset0:178 offset1:179
    ds_read2_b32 a[196:197], v246 offset0:48 offset1:49
    ds_read2_b32 a[198:199], v246 offset0:50 offset1:51
    ds_read2_b32 a[200:201], v245 offset0:176 offset1:177
    ds_read2_b32 a[202:203], v245 offset0:178 offset1:179
    ds_read2_b32 a[204:205], v245 offset0:48 offset1:49
    ds_read2_b32 a[206:207], v245 offset0:50 offset1:51
    ds_read2_b32 a[208:209], v246 offset0:160 offset1:161
    ds_read2_b32 a[210:211], v246 offset0:162 offset1:163
    ds_read2_b32 a[212:213], v246 offset0:32 offset1:33
    ds_read2_b32 a[214:215], v246 offset0:34 offset1:35
    ds_read2_b32 a[216:217], v245 offset0:160 offset1:161
    ds_read2_b32 a[218:219], v245 offset0:162 offset1:163
    ds_read2_b32 a[220:221], v245 offset0:32 offset1:33
    ds_read2_b32 a[222:223], v245 offset0:34 offset1:35
    s_waitcnt vmcnt(1)
    v_cmp_gt_u32 vcc, 1, v48
    s_nop 1
    s_cbranch_vccz pok2
    s_mov_b32 s18, 40000
    s_mov_b32 s19, 33226752
psp2:
    s_sleep 2
    buffer_load_dword v48, v29, s[20:23], s19 offen sc1
    s_waitcnt vmcnt(0)
    v_cmp_gt_u32 vcc, 1, v48
    s_nop 1
    s_cbranch_vccz pok2
    s_sub_u32 s18, s18, 1
    s_cbranch_scc0 psp2
    s_endpgm
pok2:
    s_add_u32 s4, s35, 0
    s_add_u32 s5, s35, 8192
    s_add_u32 s6, s34, 4096
    buffer_load_dwordx4 v[216:219], v6, s[20:23], s4 offen sc1
    buffer_load_dwordx4 v[220:223], v6, s[20:23], s5 offen sc1
    buffer_load_dwordx2 v[224:225], v7, s[20:23], s34 offen offset:0 sc1
    buffer_load_dwordx2 v[226:227], v7, s[20:23], s6 offen offset:0 sc1
    s_add_u32 s4, s35, 4096
    s_add_u32 s5, s35, 12288
    s_add_u32 s6, s34, 4096
    buffer_load_dwordx4 v[184:187], v6, s[20:23], s4 offen sc1
    buffer_load_dwordx4 v[188:191], v6, s[20:23], s5 offen sc1
    buffer_load_dwordx2 v[192:193], v7, s[20:23], s34 offen offset:2048 sc1
    buffer_load_dwordx2 v[194:195], v7, s[20:23], s6 offen offset:2048 sc1
    ds_read2_b32 a[224:225], v246 offset0:144 offset1:145
    ds_read2_b32 a[226:227], v246 offset0:146 offset1:147
    ds_read2_b32 a[228:229], v246 offset0:16 offset1:17
    ds_read2_b32 a[230:231], v246 offset0:18 offset1:19
    ds_read2_b32 a[232:233], v245 offset0:144 offset1:145
    ds_read2_b32 a[234:235], v245 offset0:146 offset1:147
    ds_read2_b32 a[236:237], v245 offset0:16 offset1:17
    ds_read2_b32 a[238:239], v245 offset0:18 offset1:19
    ds_read2_b32 a[240:241], v246 offset0:128 offset1:129
    ds_read2_b32 a[242:243], v246 offset0:130 offset1:131
    ds_read2_b32 a[244:245], v246 offset0:0 offset1:1
    ds_read2_b32 a[246:247], v246 offset0:2 offset1:3
    ds_read2_b32 a[248:249], v245 offset0:128 offset1:129
    ds_read2_b32 a[250:251], v245 offset0:130 offset1:131
    ds_read2_b32 a[252:253], v245 offset0:0 offset1:1
    ds_read2_b32 a[254:255], v245 offset0:2 offset1:3
    ds_read2_b32 a[48:49], v244 offset0:176 offset1:177
    ds_read2_b32 a[50:51], v244 offset0:178 offset1:179
    ds_read2_b32 a[52:53], v244 offset0:48 offset1:49
    ds_read2_b32 a[54:55], v244 offset0:50 offset1:51
    ds_read2_b32 a[56:57], v9 offset0:176 offset1:177
    ds_read2_b32 a[58:59], v9 offset0:178 offset1:179
    ds_read2_b32 a[60:61], v9 offset0:48 offset1:49
    ds_read2_b32 a[62:63], v9 offset0:50 offset1:51
    ds_read2_b32 a[64:65], v244 offset0:160 offset1:161
    ds_read2_b32 a[66:67], v244 offset0:162 offset1:163
    ds_read2_b32 a[68:69], v244 offset0:32 offset1:33
    ds_read2_b32 a[70:71], v244 offset0:34 offset1:35
    ds_read2_b32 a[72:73], v9 offset0:160 offset1:161
    ds_read2_b32 a[74:75], v9 offset0:162 offset1:163
    ds_read2_b32 a[76:77], v9 offset0:32 offset1:33
    ds_read2_b32 a[78:79], v9 offset0:34 offset1:35
    ds_read2_b32 a[80:81], v244 offset0:144 offset1:145
    ds_read2_b32 a[82:83], v244 offset0:146 offset1:147
    ds_read2_b32 a[84:85], v244 offset0:16 offset1:17
    ds_read2_b32 a[86:87], v244 offset0:18 offset1:19
    ds_read2_b32 a[88:89], v9 offset0:144 offset1:145
    ds_read2_b32 a[90:91], v9 offset0:146 offset1:147
    ds_read2_b32 a[92:93], v9 offset0:16 offset1:17
    ds_read2_b32 a[94:95], v9 offset0:18 offset1:19
    ds_read2_b32 a[96:97], v244 offset0:128 offset1:129
    ds_read2_b32 a[98:99], v244 offset0:130 offset1:131
    ds_read2_b32 a[100:101], v244 offset0:0 offset1:1
    ds_read2_b32 a[102:103], v244 offset0:2 offset1:3
    ds_read2_b32 a[104:105], v9 offset0:128 offset1:129
    ds_read2_b32 a[106:107], v9 offset0:130 offset1:131
    ds_read2_b32 a[108:109], v9 offset0:0 offset1:1
    ds_read2_b32 a[110:111], v9 offset0:2 offset1:3
    s_mov_b32 s19, 33259520
    buffer_load_dword v48, v249, s[20:23], s19 offen sc1
    s_waitcnt vmcnt(8)
    v_mul_f32 v216, s49, v216
    v_mul_f32 v217, s49, v217
    v_mul_f32 v218, s49, v218
    v_mul_f32 v219, s49, v219
    s_waitcnt vmcnt(7)
    v_fma_f32 v220, v220, s49, v35
    v_fma_f32 v221, v221, s49, v35
    v_fma_f32 v222, v222, s49, v35
    v_fma_f32 v223, v223, s49, v35
    v_fma_f32 v220, -v216, v216, v220
    v_fma_f32 v221, -v217, v217, v221
    v_fma_f32 v222, -v218, v218, v222
    v_fma_f32 v223, -v219, v219, v223
    v_max_f32 v220, v35, v220
    v_max_f32 v221, v35, v221
    v_max_f32 v222, v35, v222
    v_max_f32 v223, v35, v223
    v_rsq_f32 v220, v220
    v_rsq_f32 v221, v221
    v_rsq_f32 v222, v222
    v_rsq_f32 v223, v223
    s_waitcnt vmcnt(6)
    ds_write_b64 v8, v[224:225] offset:0
    v_lshlrev_b32 v228, 16, v224
    v_and_b32 v229, 0xffff0000, v224
    v_lshlrev_b32 v230, 16, v225
    v_and_b32 v231, 0xffff0000, v225
    v_sub_f32 v228, v228, v216
    v_sub_f32 v229, v229, v217
    v_sub_f32 v230, v230, v218
    v_sub_f32 v231, v231, v219
    v_mul_f32 v228, v228, v220
    v_mul_f32 v229, v229, v221
    v_mul_f32 v230, v230, v222
    v_mul_f32 v231, v231, v223
    v_cvt_pk_bf16_f32 v236, v228, v229
    v_cvt_pk_bf16_f32 v237, v230, v231
    ds_write_b64 v8, v[236:237] offset:29184
    s_waitcnt vmcnt(5)
    ds_write_b64 v8, v[226:227] offset:4096
    v_lshlrev_b32 v232, 16, v226
    v_and_b32 v233, 0xffff0000, v226
    v_lshlrev_b32 v234, 16, v227
    v_and_b32 v235, 0xffff0000, v227
    v_sub_f32 v232, v232, v216
    v_sub_f32 v233, v233, v217
    v_sub_f32 v234, v234, v218
    v_sub_f32 v235, v235, v219
    v_mul_f32 v232, v232, v220
    v_mul_f32 v233, v233, v221
    v_mul_f32 v234, v234, v222
    v_mul_f32 v235, v235, v223
    v_cvt_pk_bf16_f32 v238, v232, v233
    v_cvt_pk_bf16_f32 v239, v234, v235
    ds_write_b64 v8, v[238:239] offset:33792
    s_waitcnt lgkmcnt(0)
    s_barrier
    ds_read_b128 v[84:87], v10 offset:192
    ds_read_b128 v[88:91], v10 offset:704
    ds_read_b128 v[92:95], v10 offset:1216
    ds_read_b128 v[96:99], v10 offset:1728
    s_waitcnt lgkmcnt(3)
    v_mfma_f32_16x16x32_bf16 v[52:55], a[192:195], v[84:87], 0
    ds_read_b128 v[100:103], v10 offset:128
    ds_read_b128 v[104:107], v10 offset:640
    v_mfma_f32_16x16x32_bf16 v[56:59], a[196:199], v[84:87], 0
    ds_read_b128 v[108:111], v10 offset:1152
    ds_read_b128 v[112:115], v10 offset:1664
    v_mfma_f32_16x16x32_bf16 v[60:63], a[200:203], v[84:87], 0
    ds_read_b128 v[116:119], v10 offset:64
    ds_read_b128 v[120:123], v10 offset:576
    v_mfma_f32_16x16x32_bf16 v[64:67], a[204:207], v[84:87], 0
    ds_read_b128 v[124:127], v10 offset:1088
    ds_read_b128 v[128:131], v10 offset:1600
    s_waitcnt vmcnt(0)
    v_cmp_gt_u32 vcc, 1, v48
    s_nop 1
    s_cbranch_vccz pok3
    s_mov_b32 s18, 40000
    s_mov_b32 s19, 33259520
psp3:
    s_sleep 2
    buffer_load_dword v48, v249, s[20:23], s19 offen sc1
    s_waitcnt vmcnt(0)
    v_cmp_gt_u32 vcc, 1, v48
    s_nop 1
    s_cbranch_vccz pok3
    s_sub_u32 s18, s18, 1
    s_cbranch_scc0 psp3
    s_endpgm
pok3:
    s_waitcnt lgkmcnt(10)
    v_mfma_f32_16x16x32_bf16 v[56:59], a[192:195], v[88:91], v[56:59]
    ds_read_b128 v[132:135], v10 offset:0
    ds_read_b128 v[136:139], v10 offset:512
    ds_read_b128 v[140:143], v10 offset:1024
    v_mfma_f32_16x16x32_bf16 v[60:63], a[196:199], v[88:91], v[60:63]
    ds_read_b128 v[144:147], v10 offset:1536
    v_mul_f32 v184, s49, v184
    v_mul_f32 v185, s49, v185
    v_mfma_f32_16x16x32_bf16 v[64:67], a[200:203], v[88:91], v[64:67]
    s_add_u32 s8, s40, 0
    s_add_u32 s9, s40, 16384
    s_add_u32 s10, s40, 32768
    buffer_load_dwordx4 a[0:3], v5, s[20:23], s8 offen offset:0 sc1
    s_waitcnt lgkmcnt(13)
    v_mfma_f32_16x16x32_bf16 v[60:63], a[192:195], v[92:95], v[60:63]
    v_mul_f32 v186, s49, v186
    v_mul_f32 v187, s49, v187
    v_fma_f32 v188, v188, s49, v35
    v_mfma_f32_16x16x32_bf16 v[64:67], a[196:199], v[92:95], v[64:67]
    v_fma_f32 v189, v189, s49, v35
    v_fma_f32 v190, v190, s49, v35
    v_fma_f32 v191, v191, s49, v35
    s_waitcnt lgkmcnt(12)
    v_mfma_f32_16x16x32_bf16 v[64:67], a[192:195], v[96:99], v[64:67]
    buffer_load_dwordx4 a[4:7], v5, s[20:23], s9 offen offset:0 sc1
    s_waitcnt lgkmcnt(11)
    v_mfma_f32_16x16x32_bf16 v[52:55], a[208:211], v[100:103], v[52:55]
    v_fma_f32 v188, -v184, v184, v188
    v_fma_f32 v189, -v185, v185, v189
    v_fma_f32 v190, -v186, v186, v190
    v_mfma_f32_16x16x32_bf16 v[56:59], a[212:215], v[100:103], v[56:59]
    v_fma_f32 v191, -v187, v187, v191
    v_max_f32 v188, v35, v188
    v_max_f32 v189, v35, v189
    v_mfma_f32_16x16x32_bf16 v[60:63], a[216:219], v[100:103], v[60:63]
    buffer_load_dwordx4 a[8:11], v33, s[20:23], s10 offen offset:0 sc1
    v_mfma_f32_16x16x32_bf16 v[64:67], a[220:223], v[100:103], v[64:67]
    v_max_f32 v190, v35, v190
    v_max_f32 v191, v35, v191
    v_rsq_f32 v188, v188
    s_waitcnt lgkmcnt(10)
    v_mfma_f32_16x16x32_bf16 v[56:59], a[208:211], v[104:107], v[56:59]
    v_rsq_f32 v189, v189
    v_rsq_f32 v190, v190
    v_rsq_f32 v191, v191
    v_mfma_f32_16x16x32_bf16 v[60:63], a[212:215], v[104:107], v[60:63]
    buffer_load_dwordx4 a[12:15], v5, s[20:23], s8 offen offset:1024 sc1
    v_mfma_f32_16x16x32_bf16 v[64:67], a[216:219], v[104:107], v[64:67]
    ds_write_b64 v8, v[192:193] offset:2048
    v_lshlrev_b32 v196, 16, v192
    v_and_b32 v197, 0xffff0000, v192
    s_waitcnt lgkmcnt(10)
    v_mfma_f32_16x16x32_bf16 v[60:63], a[208:211], v[108:111], v[60:63]
    v_lshlrev_b32 v198, 16, v193
    v_and_b32 v199, 0xffff0000, v193
    v_sub_f32 v196, v196, v184
    v_mfma_f32_16x16x32_bf16 v[64:67], a[212:215], v[108:111], v[64:67]
    buffer_load_dwordx4 a[16:19], v5, s[20:23], s9 offen offset:1024 sc1
    s_waitcnt lgkmcnt(9)
    v_mfma_f32_16x16x32_bf16 v[64:67], a[208:211], v[112:115], v[64:67]
    v_sub_f32 v197, v197, v185
    v_sub_f32 v198, v198, v186
    v_sub_f32 v199, v199, v187
    s_waitcnt lgkmcnt(8)
    v_mfma_f32_16x16x32_bf16 v[52:55], a[224:227], v[116:119], v[52:55]
    v_mul_f32 v196, v196, v188
    v_mul_f32 v197, v197, v189
    v_mul_f32 v198, v198, v190
    v_mfma_f32_16x16x32_bf16 v[56:59], a[228:231], v[116:119], v[56:59]
    buffer_load_dwordx4 a[20:23], v33, s[20:23], s10 offen offset:1024 sc1
    v_mfma_f32_16x16x32_bf16 v[60:63], a[232:235], v[116:119], v[60:63]
    v_mul_f32 v199, v199, v191
    v_cvt_pk_bf16_f32 v204, v196, v197
    v_cvt_pk_bf16_f32 v205, v198, v199
    v_mfma_f32_16x16x32_bf16 v[64:67], a[236:239], v[116:119], v[64:67]
    ds_write_b64 v8, v[204:205] offset:31232
    ds_write_b64 v8, v[194:195] offset:6144
    v_lshlrev_b32 v200, 16, v194
    s_waitcnt lgkmcnt(9)
    v_mfma_f32_16x16x32_bf16 v[56:59], a[224:227], v[120:123], v[56:59]
    buffer_load_dwordx4 a[24:27], v5, s[20:23], s8 offen offset:2048 sc1
    v_mfma_f32_16x16x32_bf16 v[60:63], a[228:231], v[120:123], v[60:63]
    v_and_b32 v201, 0xffff0000, v194
    v_lshlrev_b32 v202, 16, v195
    v_and_b32 v203, 0xffff0000, v195
    v_mfma_f32_16x16x32_bf16 v[64:67], a[232:235], v[120:123], v[64:67]
    v_sub_f32 v200, v200, v184
    v_sub_f32 v201, v201, v185
    v_sub_f32 v202, v202, v186
    s_waitcnt lgkmcnt(8)
    v_mfma_f32_16x16x32_bf16 v[60:63], a[224:227], v[124:127], v[60:63]
    buffer_load_dwordx4 a[28:31], v5, s[20:23], s9 offen offset:2048 sc1
    v_mfma_f32_16x16x32_bf16 v[64:67], a[228:231], v[124:127], v[64:67]
    v_sub_f32 v203, v203, v187
    v_mul_f32 v200, v200, v188
    v_mul_f32 v201, v201, v189
    s_waitcnt lgkmcnt(7)
    v_mfma_f32_16x16x32_bf16 v[64:67], a[224:227], v[128:131], v[64:67]
    v_mul_f32 v202, v202, v190
    v_mul_f32 v203, v203, v191
    v_cvt_pk_bf16_f32 v206, v200, v201
    s_waitcnt lgkmcnt(6)
    v_mfma_f32_16x16x32_bf16 v[52:55], a[240:243], v[132:135], v[52:55]
    buffer_load_dwordx4 a[32:35], v33, s[20:23], s10 offen offset:2048 sc1
    v_mfma_f32_16x16x32_bf16 v[56:59], a[244:247], v[132:135], v[56:59]
    v_cvt_pk_bf16_f32 v207, v202, v203
    ds_write_b64 v8, v[206:207] offset:35840
    v_mfma_f32_16x16x32_bf16 v[60:63], a[248:251], v[132:135], v[60:63]
    v_mfma_f32_16x16x32_bf16 v[64:67], a[252:255], v[132:135], v[64:67]
    buffer_load_dwordx4 a[36:39], v5, s[20:23], s8 offen offset:3072 sc1
    s_waitcnt lgkmcnt(6)
    v_mfma_f32_16x16x32_bf16 v[56:59], a[240:243], v[136:139], v[56:59]
    v_mfma_f32_16x16x32_bf16 v[60:63], a[244:247], v[136:139], v[60:63]
    v_mfma_f32_16x16x32_bf16 v[64:67], a[248:251], v[136:139], v[64:67]
    buffer_load_dwordx4 a[40:43], v5, s[20:23], s9 offen offset:3072 sc1
    s_waitcnt lgkmcnt(5)
    v_mfma_f32_16x16x32_bf16 v[60:63], a[240:243], v[140:143], v[60:63]
    v_mfma_f32_16x16x32_bf16 v[64:67], a[244:247], v[140:143], v[64:67]
    s_waitcnt lgkmcnt(4)
    v_mfma_f32_16x16x32_bf16 v[64:67], a[240:243], v[144:147], v[64:67]
    buffer_load_dwordx4 a[44:47], v33, s[20:23], s10 offen offset:3072 sc1
    v_mfma_f32_16x16x32_bf16 v[68:71], a[48:51], v[84:87], 0
    ds_write_b128 v11, v[52:55] offset:0
    v_mfma_f32_16x16x32_bf16 v[72:75], a[52:55], v[84:87], 0
    ds_write_b128 v11, v[56:59] offset:1152
    v_mfma_f32_16x16x32_bf16 v[76:79], a[56:59], v[84:87], 0
    ds_write_b128 v11, v[60:63] offset:2304
    v_mfma_f32_16x16x32_bf16 v[80:83], a[60:63], v[84:87], 0
    buffer_load_dwordx4 v[36:39], v248, s[20:23], s50 offen offset:0 sc1
    v_mfma_f32_16x16x32_bf16 v[68:71], a[204:207], v[88:91], v[68:71]
    ds_write_b128 v11, v[64:67] offset:3456
    v_mfma_f32_16x16x32_bf16 v[72:75], a[48:51], v[88:91], v[72:75]
    ds_read_b128 v[164:167], v13 offset:0
    v_mfma_f32_16x16x32_bf16 v[76:79], a[52:55], v[88:91], v[76:79]
    s_waitcnt lgkmcnt(0)
    v_mfma_f32_16x16x32_bf16 v[80:83], a[56:59], v[88:91], v[80:83]
    buffer_load_dwordx4 v[40:43], v248, s[20:23], s50 offen offset:64 sc1
    v_mfma_f32_16x16x32_bf16 v[68:71], a[200:203], v[92:95], v[68:71]
    s_barrier
    v_mfma_f32_16x16x32_bf16 v[72:75], a[204:207], v[92:95], v[72:75]
    ds_read_b128 v[148:151], v12 offset:0
    ds_read_b128 v[156:159], v12 offset:4608
    ds_read_b128 v[152:155], v12 offset:256
    v_mfma_f32_16x16x32_bf16 v[76:79], a[48:51], v[92:95], v[76:79]
    ds_read_b128 v[160:163], v12 offset:4864
    v_lshlrev_b32 v168, 16, v164
    v_and_b32 v169, 0xffff0000, v164
    v_mfma_f32_16x16x32_bf16 v[80:83], a[52:55], v[92:95], v[80:83]
    v_lshlrev_b32 v170, 16, v165
    v_and_b32 v171, 0xffff0000, v165
    v_lshlrev_b32 v172, 16, v166
    v_mfma_f32_16x16x32_bf16 v[68:71], a[196:199], v[96:99], v[68:71]
    v_and_b32 v173, 0xffff0000, v166
    v_lshlrev_b32 v174, 16, v167
    v_and_b32 v175, 0xffff0000, v167
    v_mfma_f32_16x16x32_bf16 v[72:75], a[200:203], v[96:99], v[72:75]
    buffer_load_dwordx4 v[44:47], v248, s[20:23], s50 offen offset:128 sc1
    v_mfma_f32_16x16x32_bf16 v[76:79], a[204:207], v[96:99], v[76:79]
    s_waitcnt lgkmcnt(3)
    v_add_f32 v168, v168, v148
    v_add_f32 v169, v169, v149
    v_add_f32 v170, v170, v150
    v_mfma_f32_16x16x32_bf16 v[80:83], a[48:51], v[96:99], v[80:83]
    v_add_f32 v171, v171, v151
    s_waitcnt lgkmcnt(1)
    v_add_f32 v172, v172, v152
    v_add_f32 v173, v173, v153
    v_mfma_f32_16x16x32_bf16 v[68:71], a[64:67], v[100:103], v[68:71]
    v_add_f32 v174, v174, v154
    v_add_f32 v175, v175, v155
    v_add_f32 v168, v168, v156
    v_mfma_f32_16x16x32_bf16 v[72:75], a[68:71], v[100:103], v[72:75]
    v_add_f32 v169, v169, v157
    v_add_f32 v170, v170, v158
    v_add_f32 v171, v171, v159
    v_mfma_f32_16x16x32_bf16 v[76:79], a[72:75], v[100:103], v[76:79]
    s_add_u32 s8, s40, 8192
    s_add_u32 s9, s40, 24576
    s_add_u32 s10, s40, 40960
    buffer_load_dwordx4 a[120:123], v5, s[20:23], s8 offen offset:2048 sc1
    v_mfma_f32_16x16x32_bf16 v[80:83], a[76:79], v[100:103], v[80:83]
    s_waitcnt lgkmcnt(0)
    v_add_f32 v172, v172, v160
    v_add_f32 v173, v173, v161
    v_add_f32 v174, v174, v162
    v_mfma_f32_16x16x32_bf16 v[68:71], a[220:223], v[104:107], v[68:71]
    v_add_f32 v175, v175, v163
    v_cvt_pk_bf16_f32 v176, v168, v169
    v_cvt_pk_bf16_f32 v177, v170, v171
    v_mfma_f32_16x16x32_bf16 v[72:75], a[64:67], v[104:107], v[72:75]
    v_cvt_pk_bf16_f32 v178, v172, v173
    v_cvt_pk_bf16_f32 v179, v174, v175
    buffer_store_dwordx4 v[176:179], v5, s[20:23], s36 offen offset:0 sc1
    v_mfma_f32_16x16x32_bf16 v[76:79], a[68:71], v[104:107], v[76:79]
    v_mfma_f32_16x16x32_bf16 v[80:83], a[72:75], v[104:107], v[80:83]
    v_mfma_f32_16x16x32_bf16 v[68:71], a[216:219], v[108:111], v[68:71]
    buffer_load_dwordx4 a[124:127], v5, s[20:23], s9 offen offset:2048 sc1
    v_mfma_f32_16x16x32_bf16 v[72:75], a[220:223], v[108:111], v[72:75]
    v_mfma_f32_16x16x32_bf16 v[76:79], a[64:67], v[108:111], v[76:79]
    v_mfma_f32_16x16x32_bf16 v[80:83], a[68:71], v[108:111], v[80:83]
    buffer_load_dwordx4 a[128:131], v33, s[20:23], s10 offen offset:2048 sc1
    v_mfma_f32_16x16x32_bf16 v[68:71], a[212:215], v[112:115], v[68:71]
    v_mfma_f32_16x16x32_bf16 v[72:75], a[216:219], v[112:115], v[72:75]
    v_mfma_f32_16x16x32_bf16 v[76:79], a[220:223], v[112:115], v[76:79]
    buffer_load_dwordx4 a[132:135], v5, s[20:23], s8 offen offset:3072 sc1
    v_mfma_f32_16x16x32_bf16 v[80:83], a[64:67], v[112:115], v[80:83]
    v_mfma_f32_16x16x32_bf16 v[68:71], a[80:83], v[116:119], v[68:71]
    ds_read_b128 v[84:87], v10 offset:2240
    v_mfma_f32_16x16x32_bf16 v[72:75], a[84:87], v[116:119], v[72:75]
    ds_read_b128 v[88:91], v10 offset:2752
    v_mfma_f32_16x16x32_bf16 v[76:79], a[88:91], v[116:119], v[76:79]
    buffer_load_dwordx4 a[136:139], v5, s[20:23], s9 offen offset:3072 sc1
    v_mfma_f32_16x16x32_bf16 v[80:83], a[92:95], v[116:119], v[80:83]
    ds_read_b128 v[92:95], v10 offset:3264
    v_mfma_f32_16x16x32_bf16 v[68:71], a[236:239], v[120:123], v[68:71]
    ds_read_b128 v[96:99], v10 offset:3776
    v_mfma_f32_16x16x32_bf16 v[72:75], a[80:83], v[120:123], v[72:75]
    buffer_load_dwordx4 a[140:143], v33, s[20:23], s10 offen offset:3072 sc1
    v_mfma_f32_16x16x32_bf16 v[76:79], a[84:87], v[120:123], v[76:79]
    ds_read_b128 v[100:103], v10 offset:2176
    v_mfma_f32_16x16x32_bf16 v[80:83], a[88:91], v[120:123], v[80:83]
    ds_read_b128 v[104:107], v10 offset:2688
    v_mfma_f32_16x16x32_bf16 v[68:71], a[232:235], v[124:127], v[68:71]
    s_add_u32 s8, s40, 12288
    s_add_u32 s9, s40, 28672
    s_add_u32 s10, s40, 45056
    buffer_load_dwordx4 a[144:147], v5, s[20:23], s8 offen offset:0 sc1
    v_mfma_f32_16x16x32_bf16 v[72:75], a[236:239], v[124:127], v[72:75]
    ds_read_b128 v[108:111], v10 offset:3200
    v_mfma_f32_16x16x32_bf16 v[76:79], a[80:83], v[124:127], v[76:79]
    ds_read_b128 v[112:115], v10 offset:3712
    v_mfma_f32_16x16x32_bf16 v[80:83], a[84:87], v[124:127], v[80:83]
    buffer_load_dwordx4 a[148:151], v5, s[20:23], s9 offen offset:0 sc1
    v_mfma_f32_16x16x32_bf16 v[68:71], a[228:231], v[128:131], v[68:71]
    v_mfma_f32_16x16x32_bf16 v[72:75], a[232:235], v[128:131], v[72:75]
    v_mfma_f32_16x16x32_bf16 v[76:79], a[236:239], v[128:131], v[76:79]
    buffer_load_dwordx4 a[152:155], v33, s[20:23], s10 offen offset:0 sc1
    v_mfma_f32_16x16x32_bf16 v[80:83], a[80:83], v[128:131], v[80:83]
    v_mfma_f32_16x16x32_bf16 v[68:71], a[96:99], v[132:135], v[68:71]
    ds_read_b128 v[116:119], v10 offset:2112
    v_mfma_f32_16x16x32_bf16 v[72:75], a[100:103], v[132:135], v[72:75]
    ds_read_b128 v[120:123], v10 offset:2624
    v_mfma_f32_16x16x32_bf16 v[76:79], a[104:107], v[132:135], v[76:79]
    buffer_load_dwordx4 a[156:159], v5, s[20:23], s8 offen offset:1024 sc1
    v_mfma_f32_16x16x32_bf16 v[80:83], a[108:111], v[132:135], v[80:83]
    ds_read_b128 v[124:127], v10 offset:3136
    v_mfma_f32_16x16x32_bf16 v[68:71], a[252:255], v[136:139], v[68:71]
    s_add_u32 s19, s46, 33030144
    v_mfma_f32_16x16x32_bf16 v[72:75], a[96:99], v[136:139], v[72:75]
    s_waitcnt vmcnt(9)
    s_barrier
    v_mfma_f32_16x16x32_bf16 v[76:79], a[100:103], v[136:139], v[76:79]
    buffer_load_dwordx4 a[160:163], v5, s[20:23], s9 offen offset:1024 sc1
    v_mfma_f32_16x16x32_bf16 v[80:83], a[104:107], v[136:139], v[80:83]
    buffer_store_dword v32, v30, s[20:23], s19 offen sc1
    v_mfma_f32_16x16x32_bf16 v[68:71], a[248:251], v[140:143], v[68:71]
    ds_read_b128 v[128:131], v10 offset:3648
    v_mfma_f32_16x16x32_bf16 v[72:75], a[252:255], v[140:143], v[72:75]
    buffer_load_dwordx4 a[164:167], v33, s[20:23], s10 offen offset:1024 sc1
    v_mfma_f32_16x16x32_bf16 v[76:79], a[96:99], v[140:143], v[76:79]
    v_mfma_f32_16x16x32_bf16 v[80:83], a[100:103], v[140:143], v[80:83]
    v_mfma_f32_16x16x32_bf16 v[68:71], a[244:247], v[144:147], v[68:71]
    buffer_load_dwordx4 a[168:171], v5, s[20:23], s8 offen offset:2048 sc1
    v_mfma_f32_16x16x32_bf16 v[72:75], a[248:251], v[144:147], v[72:75]
    v_mfma_f32_16x16x32_bf16 v[76:79], a[252:255], v[144:147], v[76:79]
    v_mfma_f32_16x16x32_bf16 v[80:83], a[96:99], v[144:147], v[80:83]
    buffer_load_dwordx4 a[172:175], v5, s[20:23], s9 offen offset:2048 sc1
    s_waitcnt lgkmcnt(11)
    v_mfma_f32_16x16x32_bf16 v[68:71], a[192:195], v[84:87], v[68:71]
    ds_read_b128 v[132:135], v10 offset:2048
    ds_read_b128 v[136:139], v10 offset:2560
    v_mfma_f32_16x16x32_bf16 v[72:75], a[196:199], v[84:87], v[72:75]
    ds_read_b128 v[140:143], v10 offset:3072
    ds_read_b128 v[144:147], v10 offset:3584
    v_mfma_f32_16x16x32_bf16 v[76:79], a[200:203], v[84:87], v[76:79]
    buffer_load_dwordx4 a[176:179], v33, s[20:23], s10 offen offset:2048 sc1
    v_mfma_f32_16x16x32_bf16 v[80:83], a[204:207], v[84:87], v[80:83]
    s_and_b32 s4, s2, 3
    s_lshl_b32 s4, s4, 2
    s_waitcnt lgkmcnt(14)
    v_mfma_f32_16x16x32_bf16 v[72:75], a[192:195], v[88:91], v[72:75]
    s_bfe_u32 s5, s2, 0x20003
    s_add_u32 s5, s5, s4
    v_mfma_f32_16x16x32_bf16 v[76:79], a[196:199], v[88:91], v[76:79]
    buffer_load_dwordx4 a[180:183], v5, s[20:23], s8 offen offset:3072 sc1
    v_mfma_f32_16x16x32_bf16 v[80:83], a[200:203], v[88:91], v[80:83]
    s_bfe_u32 s4, s2, 0x10002
    s_lshl_b32 s4, s4, 3
    s_waitcnt lgkmcnt(13)
    v_mfma_f32_16x16x32_bf16 v[76:79], a[192:195], v[92:95], v[76:79]
    s_lshr_b32 s6, s2, 5
    s_add_u32 s4, s4, s6
    v_mfma_f32_16x16x32_bf16 v[80:83], a[196:199], v[92:95], v[80:83]
    buffer_load_dwordx4 a[184:187], v5, s[20:23], s9 offen offset:3072 sc1
    s_waitcnt lgkmcnt(12)
    v_mfma_f32_16x16x32_bf16 v[80:83], a[192:195], v[96:99], v[80:83]
    s_and_b32 s6, s2, 7
    s_lshl_b32 s6, s6, 2
    s_waitcnt lgkmcnt(11)
    v_mfma_f32_16x16x32_bf16 v[68:71], a[208:211], v[100:103], v[68:71]
    s_lshr_b32 s7, s2, 6
    s_add_u32 s6, s6, s7
    v_mfma_f32_16x16x32_bf16 v[72:75], a[212:215], v[100:103], v[72:75]
    buffer_load_dwordx4 a[188:191], v33, s[20:23], s10 offen offset:3072 sc1
    v_mfma_f32_16x16x32_bf16 v[76:79], a[216:219], v[100:103], v[76:79]
    s_bfe_u32 s7, s2, 0x30003
    s_mov_b32 s37, 1073741824
    v_mfma_f32_16x16x32_bf16 v[80:83], a[220:223], v[100:103], v[80:83]
    s_lshl_b32 s15, s3, 15
    s_lshl_b32 s16, s4, 7
    s_waitcnt lgkmcnt(10)
    v_mfma_f32_16x16x32_bf16 v[72:75], a[208:211], v[104:107], v[72:75]
    s_add_u32 s8, s40, 4096
    s_add_u32 s9, s40, 20480
    s_add_u32 s10, s40, 36864
    buffer_load_dwordx4 a[48:51], v5, s[20:23], s8 offen offset:0 sc1
    v_mfma_f32_16x16x32_bf16 v[76:79], a[212:215], v[104:107], v[76:79]
    s_add_u32 s15, s15, s16
    s_add_u32 s38, s15, 2097152
    v_mfma_f32_16x16x32_bf16 v[80:83], a[216:219], v[104:107], v[80:83]
    s_mul_i32 s15, s5, 11
    s_mul_i32 s16, s3, 3
    s_waitcnt lgkmcnt(9)
    v_mfma_f32_16x16x32_bf16 v[76:79], a[208:211], v[108:111], v[76:79]
    buffer_load_dwordx4 a[52:55], v5, s[20:23], s9 offen offset:0 sc1
    v_mfma_f32_16x16x32_bf16 v[80:83], a[212:215], v[108:111], v[80:83]
    s_add_u32 s15, s15, s16
    s_lshl_b32 s15, s15, 15
    s_waitcnt lgkmcnt(8)
    v_mfma_f32_16x16x32_bf16 v[80:83], a[208:211], v[112:115], v[80:83]
    s_lshl_b32 s16, s4, 10
    s_add_u32 s15, s15, s16
    s_waitcnt lgkmcnt(7)
    v_mfma_f32_16x16x32_bf16 v[68:71], a[224:227], v[116:119], v[68:71]
    buffer_load_dwordx4 a[56:59], v33, s[20:23], s10 offen offset:0 sc1
    v_mfma_f32_16x16x32_bf16 v[72:75], a[228:231], v[116:119], v[72:75]
    s_add_u32 s41, s15, 8388608
    s_mul_i32 s15, s3, 1441792
    v_mfma_f32_16x16x32_bf16 v[76:79], a[232:235], v[116:119], v[76:79]
    s_lshl_b32 s16, s6, 9
    s_add_u32 s15, s15, s16
    v_mfma_f32_16x16x32_bf16 v[80:83], a[236:239], v[116:119], v[80:83]
    buffer_load_dwordx4 a[60:63], v5, s[20:23], s8 offen offset:1024 sc1
    s_waitcnt lgkmcnt(6)
    v_mfma_f32_16x16x32_bf16 v[72:75], a[224:227], v[120:123], v[72:75]
    s_add_u32 s42, s15, 8388608
    s_mul_i32 s15, s7, 44
    v_mfma_f32_16x16x32_bf16 v[76:79], a[228:231], v[120:123], v[76:79]
    s_mul_i32 s16, s3, 11
    s_add_u32 s15, s15, s16
    v_mfma_f32_16x16x32_bf16 v[80:83], a[232:235], v[120:123], v[80:83]
    buffer_load_dwordx4 a[64:67], v5, s[20:23], s9 offen offset:1024 sc1
    s_waitcnt lgkmcnt(5)
    v_mfma_f32_16x16x32_bf16 v[76:79], a[224:227], v[124:127], v[76:79]
    s_lshl_b32 s15, s15, 12
    s_add_u32 s43, s15, 29360128
    v_mfma_f32_16x16x32_bf16 v[80:83], a[228:231], v[124:127], v[80:83]
    s_lshl_b32 s15, s7, 18
    s_lshl_b32 s16, s3, 16
    s_waitcnt lgkmcnt(4)
    v_mfma_f32_16x16x32_bf16 v[80:83], a[224:227], v[128:131], v[80:83]
    buffer_load_dwordx4 a[68:71], v33, s[20:23], s10 offen offset:1024 sc1
    s_waitcnt lgkmcnt(3)
    v_mfma_f32_16x16x32_bf16 v[68:71], a[240:243], v[132:135], v[68:71]
    s_add_u32 s15, s15, s16
    s_lshl_b32 s16, s6, 6
    v_mfma_f32_16x16x32_bf16 v[72:75], a[244:247], v[132:135], v[72:75]
    s_add_u32 s15, s15, s16
    s_add_u32 s44, s15, 2097152
    v_mfma_f32_16x16x32_bf16 v[76:79], a[248:251], v[132:135], v[76:79]
    buffer_load_dwordx4 a[72:75], v5, s[20:23], s8 offen offset:2048 sc1
    v_mfma_f32_16x16x32_bf16 v[80:83], a[252:255], v[132:135], v[80:83]
    s_lshl_b32 s15, s6, 7
    s_add_u32 s45, s15, 32522240
    s_waitcnt lgkmcnt(2)
    v_mfma_f32_16x16x32_bf16 v[72:75], a[240:243], v[136:139], v[72:75]
    s_lshl_b32 s15, s4, 4
    s_add_u32 s15, s15, s5
    v_mfma_f32_16x16x32_bf16 v[76:79], a[244:247], v[136:139], v[76:79]
    buffer_load_dwordx4 a[76:79], v5, s[20:23], s9 offen offset:2048 sc1
    v_mfma_f32_16x16x32_bf16 v[80:83], a[248:251], v[136:139], v[80:83]
    s_lshr_b32 s16, s15, 2
    s_lshl_b32 s16, s16, 7
    s_waitcnt lgkmcnt(1)
    v_mfma_f32_16x16x32_bf16 v[76:79], a[240:243], v[140:143], v[76:79]
    s_and_b32 s15, s15, 3
    s_lshl_b32 s15, s15, 2
    v_mfma_f32_16x16x32_bf16 v[80:83], a[244:247], v[140:143], v[80:83]
    buffer_load_dwordx4 a[80:83], v33, s[20:23], s10 offen offset:2048 sc1
    s_waitcnt lgkmcnt(0)
    v_mfma_f32_16x16x32_bf16 v[80:83], a[240:243], v[144:147], v[80:83]
    s_add_u32 s47, s15, s16
    s_lshl_b32 s15, s6, 3
    s_add_u32 s15, s15, s7
    s_lshr_b32 s16, s15, 3
    s_lshl_b32 s16, s16, 7
    s_and_b32 s17, s15, 7
    s_lshl_b32 s17, s17, 2
    s_add_u32 s48, s16, s17
    s_lshl_b32 s15, s6, 15
    s_lshl_b32 s16, s7, 7
    s_add_u32 s15, s15, s16
    s_lshl_b32 s16, s3, 5
    s_add_u32 s51, s15, s16
    s_mov_b64 s[62:63], -1
    s_mov_b32 s58, 0x00f0000f
    s_mov_b32 s59, 0xf0000f00
    s_mov_b32 s60, 0
    s_mov_b32 s61, 0xffff0000
    s_mul_i32 s4, s3, 1280
    s_add_u32 s4, s4, 112640
    s_lshr_b32 s15, s6, 1
    s_lshl_b32 s15, s15, 2
    s_add_u32 s15, s15, s3
    s_lshl_b32 s15, s15, 7
    ds_write_b128 v11, v[68:71] offset:18432
    ds_write_b128 v11, v[72:75] offset:19584
    ds_write_b128 v11, v[76:79] offset:20736
    buffer_load_dwordx4 a[84:87], v5, s[20:23], s8 offen offset:3072 sc1
    ds_write_b128 v11, v[80:83] offset:21888
    ds_read_b128 v[164:167], v13 offset:2048
    s_waitcnt lgkmcnt(0)
    buffer_load_dwordx4 a[88:91], v5, s[20:23], s9 offen offset:3072 sc1
    s_barrier
    ds_read_b128 v[148:151], v12 offset:18432
    ds_read_b128 v[156:159], v12 offset:23040
    buffer_load_dwordx4 a[92:95], v33, s[20:23], s10 offen offset:3072 sc1
    ds_read_b128 v[152:155], v12 offset:18688
    ds_read_b128 v[160:163], v12 offset:23296
    v_lshlrev_b32 v168, 16, v164
    s_add_u32 s8, s40, 8192
    s_add_u32 s9, s40, 24576
    s_add_u32 s10, s40, 40960
    buffer_load_dwordx4 a[96:99], v5, s[20:23], s8 offen offset:0 sc1
    v_and_b32 v169, 0xffff0000, v164
    v_lshlrev_b32 v170, 16, v165
    v_and_b32 v171, 0xffff0000, v165
    buffer_load_dwordx4 a[100:103], v5, s[20:23], s9 offen offset:0 sc1
    v_lshlrev_b32 v172, 16, v166
    v_and_b32 v173, 0xffff0000, v166
    v_lshlrev_b32 v174, 16, v167
    buffer_load_dwordx4 a[104:107], v33, s[20:23], s10 offen offset:0 sc1
    v_and_b32 v175, 0xffff0000, v167
    s_waitcnt lgkmcnt(3)
    v_add_f32 v168, v168, v148
    v_add_f32 v169, v169, v149
    buffer_load_dwordx4 a[108:111], v5, s[20:23], s8 offen offset:1024 sc1
    v_add_f32 v170, v170, v150
    v_add_f32 v171, v171, v151
    s_waitcnt lgkmcnt(1)
    v_add_f32 v172, v172, v152
    buffer_load_dwordx4 a[112:115], v5, s[20:23], s9 offen offset:1024 sc1
    v_add_f32 v173, v173, v153
    v_add_f32 v174, v174, v154
    v_add_f32 v175, v175, v155
    buffer_load_dwordx4 a[116:119], v33, s[20:23], s10 offen offset:1024 sc1
    v_add_f32 v168, v168, v156
    v_add_f32 v169, v169, v157
    v_add_f32 v170, v170, v158
    v_add_f32 v171, v171, v159
    s_waitcnt lgkmcnt(0)
    v_add_f32 v172, v172, v160
    v_add_f32 v173, v173, v161
    v_add_f32 v174, v174, v162
    v_add_f32 v175, v175, v163
    v_cvt_pk_bf16_f32 v176, v168, v169
    v_cvt_pk_bf16_f32 v177, v170, v171
    v_cvt_pk_bf16_f32 v178, v172, v173
    v_cvt_pk_bf16_f32 v179, v174, v175
    buffer_store_dwordx4 v[176:179], v5, s[20:23], s36 offen offset:2048 sc1
    s_mov_b32 s19, 33030144
    buffer_load_dword v48, v29, s[20:23], s19 offen sc1
    v_lshlrev_b32 v1, 1, v4
    v_xor_b32 v1, v1, v2
    v_and_b32 v1, 7, v1
    v_lshlrev_b32 v1, 4, v1
    v_lshrrev_b32 v14, 3, v2
    v_lshl_add_u32 v14, v14, 12, v1
    v_lshrrev_b32 v1, 2, v2
    v_lshlrev_b32 v1, 7, v1
    v_and_b32 v84, 3, v2
    v_lshl_add_u32 v1, v84, 3, v1
    v_bfe_u32 v85, v2, 3, 2
    v_xor_b32 v86, 0, v85
    v_lshl_add_u32 v15, v86, 5, v1
    v_xor_b32 v86, 1, v85
    v_lshl_add_u32 v16, v86, 5, v1
    v_xor_b32 v86, 2, v85
    v_lshl_add_u32 v17, v86, 5, v1
    v_xor_b32 v86, 3, v85
    v_lshl_add_u32 v18, v86, 5, v1
    v_lshlrev_b32 v1, 4, v3
    v_add_u32 v19, 140288, v1
    v_lshl_add_u32 v21, v4, 15, v1
    v_and_b32 v20, 0x23, v2
    v_lshl_add_u32 v20, v85, 2, v20
    v_bfe_u32 v1, v2, 2, 1
    v_lshl_add_u32 v20, v1, 4, v20
    v_lshlrev_b32 v20, 4, v20
    v_lshl_add_u32 v22, s3, 13, v5
    v_lshlrev_b32 v1, 4, v4
    v_and_b32 v87, 7, v3
    v_lshrrev_b32 v86, 3, v3
    v_lshl_add_u32 v87, v87, 1, v86
    v_lshl_add_u32 v23, v87, 12, v1
    v_mul_u32_u24 v86, 80, v87
    v_add3_u32 v25, v86, v1, s4
    v_lshrrev_b32 v1, 5, v2
    v_bfe_u32 v86, v2, 2, 2
    v_lshl_add_u32 v26, v1, 3, v86
    v_mul_u32_u24 v26, 80, v26
    v_and_b32 v86, 1, v4
    v_lshl_add_u32 v26, v86, 5, v26
    v_lshl_add_u32 v26, v84, 3, v26
    v_add_u32 v26, s4, v26
    v_and_b32 v86, 31, v2
    v_lshlrev_b32 v86, 10, v86
    v_lshl_add_u32 v27, v1, 4, v86
    v_and_b32 v1, 7, v2
    v_lshl_add_u32 v1, v4, 3, v1
    v_lshlrev_b32 v1, 2, v1
    v_bfe_u32 v24, v2, 3, 1
    s_waitcnt vmcnt(0)
    v_cmp_gt_u32 vcc, s33, v48
    s_nop 1
    s_cbranch_vccz pok4
    s_mov_b32 s18, 40000
    s_mov_b32 s19, 33030144
psp4:
    s_sleep 2
    buffer_load_dword v48, v29, s[20:23], s19 offen sc1
    s_waitcnt vmcnt(0)
    v_cmp_gt_u32 vcc, s33, v48
    s_nop 1
    s_cbranch_vccz pok4
    s_sub_u32 s18, s18, 1
    s_cbranch_scc0 psp4
    s_endpgm
pok4:
    v_lshl_add_u32 v24, v24, 13, v1
    v_mov_b32 v86, 1073741824
    v_cmp_gt_u32 vcc, 64, v0
    s_nop 1
    v_cndmask_b32 v24, v86, v24, vcc
    s_add_u32 m0, s39, 0
    s_add_u32 s12, s38, 0
    buffer_load_dwordx4 v14, s[20:23], s12 offen sc1 lds
    v_add_u32 v253, 110592, v5
    v_lshl_add_u32 v252, s3, 2, v253
    v_lshl_add_u32 v28, v84, 2, s15
    s_add_u32 m0, s39, 4096
    s_add_u32 s12, s38, 131072
    buffer_load_dwordx4 v14, s[20:23], s12 offen sc1 lds
    v_add_f32_dpp v36, v36, v36 row_ror:8 row_mask:0xf bank_mask:0xf
    v_add_f32_dpp v37, v37, v37 row_ror:8 row_mask:0xf bank_mask:0xf
    v_add_f32_dpp v38, v38, v38 row_ror:8 row_mask:0xf bank_mask:0xf
    s_add_u32 m0, s39, 8192
    s_add_u32 s12, s38, 262144
    buffer_load_dwordx4 v14, s[20:23], s12 offen sc1 lds
    v_add_f32_dpp v39, v39, v39 row_ror:8 row_mask:0xf bank_mask:0xf
    v_add_f32_dpp v40, v40, v40 row_ror:8 row_mask:0xf bank_mask:0xf
    v_add_f32_dpp v41, v41, v41 row_ror:8 row_mask:0xf bank_mask:0xf
    s_add_u32 m0, s39, 12288
    s_add_u32 s12, s38, 393216
    buffer_load_dwordx4 v14, s[20:23], s12 offen sc1 lds
    v_add_f32_dpp v42, v42, v42 row_ror:8 row_mask:0xf bank_mask:0xf
    v_add_f32_dpp v43, v43, v43 row_ror:8 row_mask:0xf bank_mask:0xf
    v_add_f32_dpp v44, v44, v44 row_ror:8 row_mask:0xf bank_mask:0xf
    s_add_u32 m0, s39, 16384
    s_add_u32 s12, s38, 524288
    buffer_load_dwordx4 v14, s[20:23], s12 offen sc1 lds
    v_add_f32_dpp v45, v45, v45 row_ror:8 row_mask:0xf bank_mask:0xf
    v_add_f32_dpp v46, v46, v46 row_ror:8 row_mask:0xf bank_mask:0xf
    v_add_f32_dpp v47, v47, v47 row_ror:8 row_mask:0xf bank_mask:0xf
    s_add_u32 m0, s39, 20480
    s_add_u32 s12, s38, 655360
    buffer_load_dwordx4 v14, s[20:23], s12 offen sc1 lds
    v_add_f32_dpp v36, v36, v36 row_ror:4 row_mask:0xf bank_mask:0xf
    v_add_f32_dpp v37, v37, v37 row_ror:4 row_mask:0xf bank_mask:0xf
    v_add_f32_dpp v38, v38, v38 row_ror:4 row_mask:0xf bank_mask:0xf
    s_add_u32 m0, s39, 24576
    s_add_u32 s12, s38, 786432
    buffer_load_dwordx4 v14, s[20:23], s12 offen sc1 lds
    v_add_f32_dpp v39, v39, v39 row_ror:4 row_mask:0xf bank_mask:0xf
    v_add_f32_dpp v40, v40, v40 row_ror:4 row_mask:0xf bank_mask:0xf
    v_add_f32_dpp v41, v41, v41 row_ror:4 row_mask:0xf bank_mask:0xf
    s_add_u32 m0, s39, 28672
    s_add_u32 s12, s38, 917504
    buffer_load_dwordx4 v14, s[20:23], s12 offen sc1 lds
    v_add_f32_dpp v42, v42, v42 row_ror:4 row_mask:0xf bank_mask:0xf
    v_add_f32_dpp v43, v43, v43 row_ror:4 row_mask:0xf bank_mask:0xf
    v_add_f32_dpp v44, v44, v44 row_ror:4 row_mask:0xf bank_mask:0xf
    s_add_u32 m0, s39, 32768
    s_add_u32 s12, s38, 1048576
    buffer_load_dwordx4 v14, s[20:23], s12 offen sc1 lds
    v_add_f32_dpp v45, v45, v45 row_ror:4 row_mask:0xf bank_mask:0xf
    v_add_f32_dpp v46, v46, v46 row_ror:4 row_mask:0xf bank_mask:0xf
    v_add_f32_dpp v47, v47, v47 row_ror:4 row_mask:0xf bank_mask:0xf
    s_add_u32 m0, s39, 36864
    s_add_u32 s12, s38, 1179648
    buffer_load_dwordx4 v14, s[20:23], s12 offen sc1 lds
    v_add_f32_dpp v36, v36, v36 row_ror:2 row_mask:0xf bank_mask:0xf
    v_add_f32_dpp v37, v37, v37 row_ror:2 row_mask:0xf bank_mask:0xf
    v_add_f32_dpp v38, v38, v38 row_ror:2 row_mask:0xf bank_mask:0xf
    s_add_u32 m0, s39, 40960
    s_add_u32 s12, s38, 1310720
    buffer_load_dwordx4 v14, s[20:23], s12 offen sc1 lds
    v_add_f32_dpp v39, v39, v39 row_ror:2 row_mask:0xf bank_mask:0xf
    v_add_f32_dpp v40, v40, v40 row_ror:2 row_mask:0xf bank_mask:0xf
    v_add_f32_dpp v41, v41, v41 row_ror:2 row_mask:0xf bank_mask:0xf
    s_add_u32 m0, s39, 45056
    s_add_u32 s12, s38, 1441792
    buffer_load_dwordx4 v14, s[20:23], s12 offen sc1 lds
    v_add_f32_dpp v42, v42, v42 row_ror:2 row_mask:0xf bank_mask:0xf
    v_add_f32_dpp v43, v43, v43 row_ror:2 row_mask:0xf bank_mask:0xf
    v_add_f32_dpp v44, v44, v44 row_ror:2 row_mask:0xf bank_mask:0xf
    s_add_u32 m0, s39, 49152
    s_add_u32 s12, s38, 1572864
    buffer_load_dwordx4 v14, s[20:23], s12 offen sc1 lds
    v_add_f32_dpp v45, v45, v45 row_ror:2 row_mask:0xf bank_mask:0xf
    v_add_f32_dpp v46, v46, v46 row_ror:2 row_mask:0xf bank_mask:0xf
    v_add_f32_dpp v47, v47, v47 row_ror:2 row_mask:0xf bank_mask:0xf
    s_add_u32 m0, s39, 53248
    s_add_u32 s12, s38, 1703936
    buffer_load_dwordx4 v14, s[20:23], s12 offen sc1 lds
    v_add_f32_dpp v36, v36, v36 row_ror:1 row_mask:0xf bank_mask:0xf
    v_add_f32_dpp v37, v37, v37 row_ror:1 row_mask:0xf bank_mask:0xf
    v_add_f32_dpp v38, v38, v38 row_ror:1 row_mask:0xf bank_mask:0xf
    s_add_u32 m0, s39, 57344
    s_add_u32 s12, s38, 1835008
    buffer_load_dwordx4 v14, s[20:23], s12 offen sc1 lds
    v_add_f32_dpp v39, v39, v39 row_ror:1 row_mask:0xf bank_mask:0xf
    v_add_f32_dpp v40, v40, v40 row_ror:1 row_mask:0xf bank_mask:0xf
    v_add_f32_dpp v41, v41, v41 row_ror:1 row_mask:0xf bank_mask:0xf
    s_add_u32 m0, s39, 61440
    s_add_u32 s12, s38, 1966080
    buffer_load_dwordx4 v14, s[20:23], s12 offen sc1 lds
    v_add_f32_dpp v42, v42, v42 row_ror:1 row_mask:0xf bank_mask:0xf
    v_add_f32_dpp v43, v43, v43 row_ror:1 row_mask:0xf bank_mask:0xf
    v_add_f32_dpp v44, v44, v44 row_ror:1 row_mask:0xf bank_mask:0xf
    v_add_f32_dpp v45, v45, v45 row_ror:1 row_mask:0xf bank_mask:0xf
    v_add_f32_dpp v46, v46, v46 row_ror:1 row_mask:0xf bank_mask:0xf
    v_add_f32_dpp v47, v47, v47 row_ror:1 row_mask:0xf bank_mask:0xf
    s_add_u32 s19, s46, 33062912
    s_barrier
    buffer_store_dword v32, v30, s[20:23], s19 offen sc1
layer:
    s_cmp_eq_u32 s3, 3
    s_cbranch_scc1 g1w3
    s_waitcnt vmcnt(15)
    s_barrier
    ds_read_b64_tr_b16 v[148:149], v15 offset:0
    ds_read_b64_tr_b16 v[150:151], v15 offset:2048
    ds_read_b64_tr_b16 v[152:153], v16 offset:0
    ds_read_b64_tr_b16 v[154:155], v16 offset:2048
    ds_read_b64_tr_b16 v[156:157], v17 offset:0
    ds_read_b64_tr_b16 v[158:159], v17 offset:2048
    ds_read_b64_tr_b16 v[160:161], v18 offset:0
    ds_read_b64_tr_b16 v[162:163], v18 offset:2048
    s_waitcnt lgkmcnt(6)
    v_mfma_f32_16x16x32_bf16 v[52:55], a[0:3], v[148:151], 0
    v_mfma_f32_16x16x32_bf16 v[68:71], a[4:7], v[148:151], 0
    ds_read_b64_tr_b16 v[164:165], v15 offset:4096
    v_mfma_f32_16x16x32_bf16 v[84:87], a[8:11], v[148:151], 0
    ds_read_b64_tr_b16 v[166:167], v15 offset:6144
    s_waitcnt lgkmcnt(6)
    v_mfma_f32_16x16x32_bf16 v[56:59], a[0:3], v[152:155], 0
    v_mfma_f32_16x16x32_bf16 v[72:75], a[4:7], v[152:155], 0
    ds_read_b64_tr_b16 v[168:169], v16 offset:4096
    v_mfma_f32_16x16x32_bf16 v[88:91], a[8:11], v[152:155], 0
    ds_read_b64_tr_b16 v[170:171], v16 offset:6144
    s_waitcnt lgkmcnt(6)
    v_mfma_f32_16x16x32_bf16 v[60:63], a[0:3], v[156:159], 0
    v_mfma_f32_16x16x32_bf16 v[76:79], a[4:7], v[156:159], 0
    ds_read_b64_tr_b16 v[172:173], v17 offset:4096
    v_mfma_f32_16x16x32_bf16 v[92:95], a[8:11], v[156:159], 0
    ds_read_b64_tr_b16 v[174:175], v17 offset:6144
    s_waitcnt lgkmcnt(6)
    v_mfma_f32_16x16x32_bf16 v[64:67], a[0:3], v[160:163], 0
    v_mfma_f32_16x16x32_bf16 v[80:83], a[4:7], v[160:163], 0
    ds_read_b64_tr_b16 v[176:177], v18 offset:4096
    v_mfma_f32_16x16x32_bf16 v[96:99], a[8:11], v[160:163], 0
    ds_read_b64_tr_b16 v[178:179], v18 offset:6144
    s_waitcnt vmcnt(11)
    s_barrier
    s_waitcnt lgkmcnt(6)
    v_mfma_f32_16x16x32_bf16 v[52:55], a[12:15], v[164:167], v[52:55]
    s_add_u32 s11, s43, 0
    buffer_load_dwordx4 a[192:195], v5, s[20:23], s11 offen offset:0 sc1
    v_mfma_f32_16x16x32_bf16 v[68:71], a[16:19], v[164:167], v[68:71]
    ds_read_b64_tr_b16 v[148:149], v15 offset:8192
    v_mfma_f32_16x16x32_bf16 v[84:87], a[20:23], v[164:167], v[84:87]
    ds_read_b64_tr_b16 v[150:151], v15 offset:10240
    s_waitcnt lgkmcnt(6)
    v_mfma_f32_16x16x32_bf16 v[56:59], a[12:15], v[168:171], v[56:59]
    v_mfma_f32_16x16x32_bf16 v[72:75], a[16:19], v[168:171], v[72:75]
    ds_read_b64_tr_b16 v[152:153], v16 offset:8192
    buffer_load_dwordx4 a[196:199], v5, s[20:23], s11 offen offset:1024 sc1
    v_mfma_f32_16x16x32_bf16 v[88:91], a[20:23], v[168:171], v[88:91]
    ds_read_b64_tr_b16 v[154:155], v16 offset:10240
    s_waitcnt lgkmcnt(6)
    v_mfma_f32_16x16x32_bf16 v[60:63], a[12:15], v[172:175], v[60:63]
    v_mfma_f32_16x16x32_bf16 v[76:79], a[16:19], v[172:175], v[76:79]
    ds_read_b64_tr_b16 v[156:157], v17 offset:8192
    v_mfma_f32_16x16x32_bf16 v[92:95], a[20:23], v[172:175], v[92:95]
    ds_read_b64_tr_b16 v[158:159], v17 offset:10240
    buffer_load_dwordx4 a[200:203], v5, s[20:23], s11 offen offset:2048 sc1
    s_waitcnt lgkmcnt(6)
    v_mfma_f32_16x16x32_bf16 v[64:67], a[12:15], v[176:179], v[64:67]
    v_mfma_f32_16x16x32_bf16 v[80:83], a[16:19], v[176:179], v[80:83]
    ds_read_b64_tr_b16 v[160:161], v18 offset:8192
    v_mfma_f32_16x16x32_bf16 v[96:99], a[20:23], v[176:179], v[96:99]
    ds_read_b64_tr_b16 v[162:163], v18 offset:10240
    s_waitcnt lgkmcnt(6)
    v_mfma_f32_16x16x32_bf16 v[52:55], a[24:27], v[148:151], v[52:55]
    v_mfma_f32_16x16x32_bf16 v[68:71], a[28:31], v[148:151], v[68:71]
    ds_read_b64_tr_b16 v[164:165], v15 offset:12288
    s_add_u32 s19, s46, 33062912
    v_mfma_f32_16x16x32_bf16 v[84:87], a[32:35], v[148:151], v[84:87]
    ds_read_b64_tr_b16 v[166:167], v15 offset:14336
    s_waitcnt vmcnt(3)
    s_barrier
    s_waitcnt lgkmcnt(6)
    v_mfma_f32_16x16x32_bf16 v[56:59], a[24:27], v[152:155], v[56:59]
    buffer_store_dword v32, v30, s[20:23], s19 offen sc1
    v_mfma_f32_16x16x32_bf16 v[72:75], a[28:31], v[152:155], v[72:75]
    ds_read_b64_tr_b16 v[168:169], v16 offset:12288
    v_mfma_f32_16x16x32_bf16 v[88:91], a[32:35], v[152:155], v[88:91]
    ds_read_b64_tr_b16 v[170:171], v16 offset:14336
    s_waitcnt lgkmcnt(6)
    v_mfma_f32_16x16x32_bf16 v[60:63], a[24:27], v[156:159], v[60:63]
    v_mfma_f32_16x16x32_bf16 v[76:79], a[28:31], v[156:159], v[76:79]
    ds_read_b64_tr_b16 v[172:173], v17 offset:12288
    v_mfma_f32_16x16x32_bf16 v[92:95], a[32:35], v[156:159], v[92:95]
    ds_read_b64_tr_b16 v[174:175], v17 offset:14336
    buffer_load_dwordx4 a[204:207], v5, s[20:23], s11 offen offset:3072 sc1
    s_waitcnt lgkmcnt(6)
    v_mfma_f32_16x16x32_bf16 v[64:67], a[24:27], v[160:163], v[64:67]
    v_mfma_f32_16x16x32_bf16 v[80:83], a[28:31], v[160:163], v[80:83]
    ds_read_b64_tr_b16 v[176:177], v18 offset:12288
    v_mfma_f32_16x16x32_bf16 v[96:99], a[32:35], v[160:163], v[96:99]
    ds_read_b64_tr_b16 v[178:179], v18 offset:14336
    s_waitcnt lgkmcnt(6)
    v_mfma_f32_16x16x32_bf16 v[52:55], a[36:39], v[164:167], v[52:55]
    s_add_u32 s11, s43, 4096
    buffer_load_dwordx4 a[208:211], v5, s[20:23], s11 offen offset:0 sc1
    v_mfma_f32_16x16x32_bf16 v[68:71], a[40:43], v[164:167], v[68:71]
    ds_read_b64_tr_b16 v[148:149], v15 offset:16384
    v_mfma_f32_16x16x32_bf16 v[84:87], a[44:47], v[164:167], v[84:87]
    ds_read_b64_tr_b16 v[150:151], v15 offset:18432
    s_waitcnt lgkmcnt(6)
    v_mfma_f32_16x16x32_bf16 v[56:59], a[36:39], v[168:171], v[56:59]
    v_mfma_f32_16x16x32_bf16 v[72:75], a[40:43], v[168:171], v[72:75]
    ds_read_b64_tr_b16 v[152:153], v16 offset:16384
    buffer_load_dwordx4 a[212:215], v5, s[20:23], s11 offen offset:1024 sc1
    v_mfma_f32_16x16x32_bf16 v[88:91], a[44:47], v[168:171], v[88:91]
    ds_read_b64_tr_b16 v[154:155], v16 offset:18432
    s_waitcnt lgkmcnt(6)
    v_mfma_f32_16x16x32_bf16 v[60:63], a[36:39], v[172:175], v[60:63]
    v_mfma_f32_16x16x32_bf16 v[76:79], a[40:43], v[172:175], v[76:79]
    ds_read_b64_tr_b16 v[156:157], v17 offset:16384
    v_mfma_f32_16x16x32_bf16 v[92:95], a[44:47], v[172:175], v[92:95]
    ds_read_b64_tr_b16 v[158:159], v17 offset:18432
    buffer_load_dwordx4 a[216:219], v5, s[20:23], s11 offen offset:2048 sc1
    s_waitcnt lgkmcnt(6)
    v_mfma_f32_16x16x32_bf16 v[64:67], a[36:39], v[176:179], v[64:67]
    v_mfma_f32_16x16x32_bf16 v[80:83], a[40:43], v[176:179], v[80:83]
    ds_read_b64_tr_b16 v[160:161], v18 offset:16384
    v_mfma_f32_16x16x32_bf16 v[96:99], a[44:47], v[176:179], v[96:99]
    ds_read_b64_tr_b16 v[162:163], v18 offset:18432
    s_waitcnt lgkmcnt(6)
    v_mfma_f32_16x16x32_bf16 v[52:55], a[48:51], v[148:151], v[52:55]
    buffer_load_dwordx4 a[220:223], v5, s[20:23], s11 offen offset:3072 sc1
    v_mfma_f32_16x16x32_bf16 v[68:71], a[52:55], v[148:151], v[68:71]
    ds_read_b64_tr_b16 v[164:165], v15 offset:20480
    v_mfma_f32_16x16x32_bf16 v[84:87], a[56:59], v[148:151], v[84:87]
    ds_read_b64_tr_b16 v[166:167], v15 offset:22528
    s_waitcnt lgkmcnt(6)
    v_mfma_f32_16x16x32_bf16 v[56:59], a[48:51], v[152:155], v[56:59]
    v_mfma_f32_16x16x32_bf16 v[72:75], a[52:55], v[152:155], v[72:75]
    ds_read_b64_tr_b16 v[168:169], v16 offset:20480
    s_add_u32 s11, s43, 8192
    buffer_load_dwordx4 a[224:227], v5, s[20:23], s11 offen offset:0 sc1
    v_mfma_f32_16x16x32_bf16 v[88:91], a[56:59], v[152:155], v[88:91]
    ds_read_b64_tr_b16 v[170:171], v16 offset:22528
    s_waitcnt lgkmcnt(6)
    v_mfma_f32_16x16x32_bf16 v[60:63], a[48:51], v[156:159], v[60:63]
    v_mfma_f32_16x16x32_bf16 v[76:79], a[52:55], v[156:159], v[76:79]
    ds_read_b64_tr_b16 v[172:173], v17 offset:20480
    v_mfma_f32_16x16x32_bf16 v[92:95], a[56:59], v[156:159], v[92:95]
    ds_read_b64_tr_b16 v[174:175], v17 offset:22528
    buffer_load_dwordx4 a[228:231], v5, s[20:23], s11 offen offset:1024 sc1
    s_waitcnt lgkmcnt(6)
    v_mfma_f32_16x16x32_bf16 v[64:67], a[48:51], v[160:163], v[64:67]
    v_mfma_f32_16x16x32_bf16 v[80:83], a[52:55], v[160:163], v[80:83]
    ds_read_b64_tr_b16 v[176:177], v18 offset:20480
    v_mfma_f32_16x16x32_bf16 v[96:99], a[56:59], v[160:163], v[96:99]
    ds_read_b64_tr_b16 v[178:179], v18 offset:22528
    s_barrier
    s_waitcnt lgkmcnt(6)
    v_mfma_f32_16x16x32_bf16 v[52:55], a[60:63], v[164:167], v[52:55]
    buffer_load_dwordx4 a[232:235], v5, s[20:23], s11 offen offset:2048 sc1
    v_mfma_f32_16x16x32_bf16 v[68:71], a[64:67], v[164:167], v[68:71]
    ds_read_b64_tr_b16 v[148:149], v15 offset:24576
    v_mfma_f32_16x16x32_bf16 v[84:87], a[68:71], v[164:167], v[84:87]
    ds_read_b64_tr_b16 v[150:151], v15 offset:26624
    s_waitcnt lgkmcnt(6)
    v_mfma_f32_16x16x32_bf16 v[56:59], a[60:63], v[168:171], v[56:59]
    v_mfma_f32_16x16x32_bf16 v[72:75], a[64:67], v[168:171], v[72:75]
    ds_read_b64_tr_b16 v[152:153], v16 offset:24576
    buffer_load_dwordx4 a[236:239], v5, s[20:23], s11 offen offset:3072 sc1
    v_mfma_f32_16x16x32_bf16 v[88:91], a[68:71], v[168:171], v[88:91]
    ds_read_b64_tr_b16 v[154:155], v16 offset:26624
    s_waitcnt lgkmcnt(6)
    v_mfma_f32_16x16x32_bf16 v[60:63], a[60:63], v[172:175], v[60:63]
    v_mfma_f32_16x16x32_bf16 v[76:79], a[64:67], v[172:175], v[76:79]
    ds_read_b64_tr_b16 v[156:157], v17 offset:24576
    v_mfma_f32_16x16x32_bf16 v[92:95], a[68:71], v[172:175], v[92:95]
    ds_read_b64_tr_b16 v[158:159], v17 offset:26624
    s_add_u32 s11, s43, 12288
    buffer_load_dwordx4 a[240:243], v5, s[20:23], s11 offen offset:0 sc1
    s_waitcnt lgkmcnt(6)
    v_mfma_f32_16x16x32_bf16 v[64:67], a[60:63], v[176:179], v[64:67]
    v_mfma_f32_16x16x32_bf16 v[80:83], a[64:67], v[176:179], v[80:83]
    ds_read_b64_tr_b16 v[160:161], v18 offset:24576
    v_mfma_f32_16x16x32_bf16 v[96:99], a[68:71], v[176:179], v[96:99]
    ds_read_b64_tr_b16 v[162:163], v18 offset:26624
    s_waitcnt lgkmcnt(6)
    v_mfma_f32_16x16x32_bf16 v[52:55], a[72:75], v[148:151], v[52:55]
    buffer_load_dwordx4 a[244:247], v5, s[20:23], s11 offen offset:1024 sc1
    v_mfma_f32_16x16x32_bf16 v[68:71], a[76:79], v[148:151], v[68:71]
    ds_read_b64_tr_b16 v[164:165], v15 offset:28672
    v_mfma_f32_16x16x32_bf16 v[84:87], a[80:83], v[148:151], v[84:87]
    ds_read_b64_tr_b16 v[166:167], v15 offset:30720
    s_waitcnt lgkmcnt(6)
    v_mfma_f32_16x16x32_bf16 v[56:59], a[72:75], v[152:155], v[56:59]
    v_mfma_f32_16x16x32_bf16 v[72:75], a[76:79], v[152:155], v[72:75]
    ds_read_b64_tr_b16 v[168:169], v16 offset:28672
    buffer_load_dwordx4 a[248:251], v5, s[20:23], s11 offen offset:2048 sc1
    v_mfma_f32_16x16x32_bf16 v[88:91], a[80:83], v[152:155], v[88:91]
    ds_read_b64_tr_b16 v[170:171], v16 offset:30720
    s_waitcnt lgkmcnt(6)
    v_mfma_f32_16x16x32_bf16 v[60:63], a[72:75], v[156:159], v[60:63]
    v_mfma_f32_16x16x32_bf16 v[76:79], a[76:79], v[156:159], v[76:79]
    ds_read_b64_tr_b16 v[172:173], v17 offset:28672
    v_mfma_f32_16x16x32_bf16 v[92:95], a[80:83], v[156:159], v[92:95]
    ds_read_b64_tr_b16 v[174:175], v17 offset:30720
    buffer_load_dwordx4 a[252:255], v5, s[20:23], s11 offen offset:3072 sc1
    s_waitcnt lgkmcnt(6)
    v_mfma_f32_16x16x32_bf16 v[64:67], a[72:75], v[160:163], v[64:67]
    v_mfma_f32_16x16x32_bf16 v[80:83], a[76:79], v[160:163], v[80:83]
    ds_read_b64_tr_b16 v[176:177], v18 offset:28672
    v_mfma_f32_16x16x32_bf16 v[96:99], a[80:83], v[160:163], v[96:99]
    ds_read_b64_tr_b16 v[178:179], v18 offset:30720
    s_waitcnt lgkmcnt(6)
    v_mfma_f32_16x16x32_bf16 v[52:55], a[84:87], v[164:167], v[52:55]
    v_mfma_f32_16x16x32_bf16 v[68:71], a[88:91], v[164:167], v[68:71]
    ds_read_b64_tr_b16 v[148:149], v15 offset:32768
    v_mfma_f32_16x16x32_bf16 v[84:87], a[92:95], v[164:167], v[84:87]
    ds_read_b64_tr_b16 v[150:151], v15 offset:34816
    s_waitcnt lgkmcnt(6)
    v_mfma_f32_16x16x32_bf16 v[56:59], a[84:87], v[168:171], v[56:59]
    v_mfma_f32_16x16x32_bf16 v[72:75], a[88:91], v[168:171], v[72:75]
    ds_read_b64_tr_b16 v[152:153], v16 offset:32768
    v_mfma_f32_16x16x32_bf16 v[88:91], a[92:95], v[168:171], v[88:91]
    ds_read_b64_tr_b16 v[154:155], v16 offset:34816
    s_waitcnt lgkmcnt(6)
    v_mfma_f32_16x16x32_bf16 v[60:63], a[84:87], v[172:175], v[60:63]
    v_mfma_f32_16x16x32_bf16 v[76:79], a[88:91], v[172:175], v[76:79]
    ds_read_b64_tr_b16 v[156:157], v17 offset:32768
    v_mfma_f32_16x16x32_bf16 v[92:95], a[92:95], v[172:175], v[92:95]
    ds_read_b64_tr_b16 v[158:159], v17 offset:34816
    s_waitcnt lgkmcnt(6)
    v_mfma_f32_16x16x32_bf16 v[64:67], a[84:87], v[176:179], v[64:67]
    v_mfma_f32_16x16x32_bf16 v[80:83], a[88:91], v[176:179], v[80:83]
    ds_read_b64_tr_b16 v[160:161], v18 offset:32768
    v_mfma_f32_16x16x32_bf16 v[96:99], a[92:95], v[176:179], v[96:99]
    ds_read_b64_tr_b16 v[162:163], v18 offset:34816
    s_waitcnt lgkmcnt(6)
    v_mfma_f32_16x16x32_bf16 v[52:55], a[96:99], v[148:151], v[52:55]
    s_mov_b32 s19, 33062912
    v_mfma_f32_16x16x32_bf16 v[68:71], a[100:103], v[148:151], v[68:71]
    ds_read_b64_tr_b16 v[164:165], v15 offset:36864
    buffer_load_dword v48, v29, s[20:23], s19 offen sc1
    v_mfma_f32_16x16x32_bf16 v[84:87], a[104:107], v[148:151], v[84:87]
    ds_read_b64_tr_b16 v[166:167], v15 offset:38912
    s_waitcnt lgkmcnt(6)
    v_mfma_f32_16x16x32_bf16 v[56:59], a[96:99], v[152:155], v[56:59]
    v_mfma_f32_16x16x32_bf16 v[72:75], a[100:103], v[152:155], v[72:75]
    ds_read_b64_tr_b16 v[168:169], v16 offset:36864
    v_mfma_f32_16x16x32_bf16 v[88:91], a[104:107], v[152:155], v[88:91]
    ds_read_b64_tr_b16 v[170:171], v16 offset:38912
    s_waitcnt lgkmcnt(6)
    v_mfma_f32_16x16x32_bf16 v[60:63], a[96:99], v[156:159], v[60:63]
    v_mfma_f32_16x16x32_bf16 v[76:79], a[100:103], v[156:159], v[76:79]
    ds_read_b64_tr_b16 v[172:173], v17 offset:36864
    v_mfma_f32_16x16x32_bf16 v[92:95], a[104:107], v[156:159], v[92:95]
    ds_read_b64_tr_b16 v[174:175], v17 offset:38912
    s_waitcnt lgkmcnt(6)
    v_mfma_f32_16x16x32_bf16 v[64:67], a[96:99], v[160:163], v[64:67]
    v_mfma_f32_16x16x32_bf16 v[80:83], a[100:103], v[160:163], v[80:83]
    ds_read_b64_tr_b16 v[176:177], v18 offset:36864
    v_mfma_f32_16x16x32_bf16 v[96:99], a[104:107], v[160:163], v[96:99]
    ds_read_b64_tr_b16 v[178:179], v18 offset:38912
    s_waitcnt lgkmcnt(6)
    v_mfma_f32_16x16x32_bf16 v[52:55], a[108:111], v[164:167], v[52:55]
    v_mfma_f32_16x16x32_bf16 v[68:71], a[112:115], v[164:167], v[68:71]
    ds_read_b64_tr_b16 v[148:149], v15 offset:40960
    v_mfma_f32_16x16x32_bf16 v[84:87], a[116:119], v[164:167], v[84:87]
    ds_read_b64_tr_b16 v[150:151], v15 offset:43008
    s_waitcnt lgkmcnt(6)
    v_mfma_f32_16x16x32_bf16 v[56:59], a[108:111], v[168:171], v[56:59]
    v_mfma_f32_16x16x32_bf16 v[72:75], a[112:115], v[168:171], v[72:75]
    ds_read_b64_tr_b16 v[152:153], v16 offset:40960
    v_mfma_f32_16x16x32_bf16 v[88:91], a[116:119], v[168:171], v[88:91]
    ds_read_b64_tr_b16 v[154:155], v16 offset:43008
    s_waitcnt lgkmcnt(6)
    v_mfma_f32_16x16x32_bf16 v[60:63], a[108:111], v[172:175], v[60:63]
    v_mfma_f32_16x16x32_bf16 v[76:79], a[112:115], v[172:175], v[76:79]
    ds_read_b64_tr_b16 v[156:157], v17 offset:40960
    v_mfma_f32_16x16x32_bf16 v[92:95], a[116:119], v[172:175], v[92:95]
    ds_read_b64_tr_b16 v[158:159], v17 offset:43008
    s_waitcnt lgkmcnt(6)
    v_mfma_f32_16x16x32_bf16 v[64:67], a[108:111], v[176:179], v[64:67]
    v_mfma_f32_16x16x32_bf16 v[80:83], a[112:115], v[176:179], v[80:83]
    ds_read_b64_tr_b16 v[160:161], v18 offset:40960
    v_mfma_f32_16x16x32_bf16 v[96:99], a[116:119], v[176:179], v[96:99]
    ds_read_b64_tr_b16 v[162:163], v18 offset:43008
    s_waitcnt lgkmcnt(6)
    v_mfma_f32_16x16x32_bf16 v[52:55], a[120:123], v[148:151], v[52:55]
    s_waitcnt vmcnt(0)
    v_cmp_gt_u32 vcc, s33, v48
    s_nop 1
    s_cbranch_vccz pok5
    s_mov_b32 s18, 40000
    s_mov_b32 s19, 33062912
psp5:
    s_sleep 2
    buffer_load_dword v48, v29, s[20:23], s19 offen sc1
    s_waitcnt vmcnt(0)
    v_cmp_gt_u32 vcc, s33, v48
    s_nop 1
    s_cbranch_vccz pok5
    s_sub_u32 s18, s18, 1
    s_cbranch_scc0 psp5
    s_endpgm
pok5:
    s_add_u32 m0, s39, 65536
    s_add_u32 s12, s38, 2048
    buffer_load_dwordx4 v14, s[20:23], s12 offen sc1 lds
    v_mfma_f32_16x16x32_bf16 v[68:71], a[124:127], v[148:151], v[68:71]
    ds_read_b64_tr_b16 v[164:165], v15 offset:45056
    v_mfma_f32_16x16x32_bf16 v[84:87], a[128:131], v[148:151], v[84:87]
    ds_read_b64_tr_b16 v[166:167], v15 offset:47104
    s_waitcnt lgkmcnt(6)
    v_mfma_f32_16x16x32_bf16 v[56:59], a[120:123], v[152:155], v[56:59]
    s_add_u32 m0, s39, 69632
    s_add_u32 s12, s38, 133120
    buffer_load_dwordx4 v14, s[20:23], s12 offen sc1 lds
    v_mfma_f32_16x16x32_bf16 v[72:75], a[124:127], v[152:155], v[72:75]
    ds_read_b64_tr_b16 v[168:169], v16 offset:45056
    v_mfma_f32_16x16x32_bf16 v[88:91], a[128:131], v[152:155], v[88:91]
    ds_read_b64_tr_b16 v[170:171], v16 offset:47104
    s_waitcnt lgkmcnt(6)
    v_mfma_f32_16x16x32_bf16 v[60:63], a[120:123], v[156:159], v[60:63]
    s_add_u32 m0, s39, 73728
    s_add_u32 s12, s38, 264192
    buffer_load_dwordx4 v14, s[20:23], s12 offen sc1 lds
    v_mfma_f32_16x16x32_bf16 v[76:79], a[124:127], v[156:159], v[76:79]
    ds_read_b64_tr_b16 v[172:173], v17 offset:45056
    v_mfma_f32_16x16x32_bf16 v[92:95], a[128:131], v[156:159], v[92:95]
    ds_read_b64_tr_b16 v[174:175], v17 offset:47104
    s_waitcnt lgkmcnt(6)
    v_mfma_f32_16x16x32_bf16 v[64:67], a[120:123], v[160:163], v[64:67]
    s_add_u32 m0, s39, 77824
    s_add_u32 s12, s38, 395264
    buffer_load_dwordx4 v14, s[20:23], s12 offen sc1 lds
    v_mfma_f32_16x16x32_bf16 v[80:83], a[124:127], v[160:163], v[80:83]
    ds_read_b64_tr_b16 v[176:177], v18 offset:45056
    v_mfma_f32_16x16x32_bf16 v[96:99], a[128:131], v[160:163], v[96:99]
    ds_read_b64_tr_b16 v[178:179], v18 offset:47104
    s_waitcnt lgkmcnt(6)
    v_mfma_f32_16x16x32_bf16 v[52:55], a[132:135], v[164:167], v[52:55]
    s_add_u32 m0, s39, 81920
    s_add_u32 s12, s38, 526336
    buffer_load_dwordx4 v14, s[20:23], s12 offen sc1 lds
    v_mfma_f32_16x16x32_bf16 v[68:71], a[136:139], v[164:167], v[68:71]
    ds_read_b64_tr_b16 v[148:149], v15 offset:49152
    v_mfma_f32_16x16x32_bf16 v[84:87], a[140:143], v[164:167], v[84:87]
    ds_read_b64_tr_b16 v[150:151], v15 offset:51200
    s_waitcnt lgkmcnt(6)
    v_mfma_f32_16x16x32_bf16 v[56:59], a[132:135], v[168:171], v[56:59]
    s_add_u32 m0, s39, 86016
    s_add_u32 s12, s38, 657408
    buffer_load_dwordx4 v14, s[20:23], s12 offen sc1 lds
    v_mfma_f32_16x16x32_bf16 v[72:75], a[136:139], v[168:171], v[72:75]
    ds_read_b64_tr_b16 v[152:153], v16 offset:49152
    v_mfma_f32_16x16x32_bf16 v[88:91], a[140:143], v[168:171], v[88:91]
    ds_read_b64_tr_b16 v[154:155], v16 offset:51200
    s_waitcnt lgkmcnt(6)
    v_mfma_f32_16x16x32_bf16 v[60:63], a[132:135], v[172:175], v[60:63]
    s_add_u32 m0, s39, 90112
    s_add_u32 s12, s38, 788480
    buffer_load_dwordx4 v14, s[20:23], s12 offen sc1 lds
    v_mfma_f32_16x16x32_bf16 v[76:79], a[136:139], v[172:175], v[76:79]
    ds_read_b64_tr_b16 v[156:157], v17 offset:49152
    v_mfma_f32_16x16x32_bf16 v[92:95], a[140:143], v[172:175], v[92:95]
    ds_read_b64_tr_b16 v[158:159], v17 offset:51200
    s_waitcnt lgkmcnt(6)
    v_mfma_f32_16x16x32_bf16 v[64:67], a[132:135], v[176:179], v[64:67]
    s_add_u32 m0, s39, 94208
    s_add_u32 s12, s38, 919552
    buffer_load_dwordx4 v14, s[20:23], s12 offen sc1 lds
    v_mfma_f32_16x16x32_bf16 v[80:83], a[136:139], v[176:179], v[80:83]
    ds_read_b64_tr_b16 v[160:161], v18 offset:49152
    v_mfma_f32_16x16x32_bf16 v[96:99], a[140:143], v[176:179], v[96:99]
    ds_read_b64_tr_b16 v[162:163], v18 offset:51200
    s_waitcnt lgkmcnt(6)
    v_mfma_f32_16x16x32_bf16 v[52:55], a[144:147], v[148:151], v[52:55]
    s_add_u32 m0, s39, 98304
    s_add_u32 s12, s38, 1050624
    buffer_load_dwordx4 v14, s[20:23], s12 offen sc1 lds
    v_mfma_f32_16x16x32_bf16 v[68:71], a[148:151], v[148:151], v[68:71]
    ds_read_b64_tr_b16 v[164:165], v15 offset:53248
    v_mfma_f32_16x16x32_bf16 v[84:87], a[152:155], v[148:151], v[84:87]
    ds_read_b64_tr_b16 v[166:167], v15 offset:55296
    s_waitcnt lgkmcnt(6)
    v_mfma_f32_16x16x32_bf16 v[56:59], a[144:147], v[152:155], v[56:59]
    s_add_u32 m0, s39, 102400
    s_add_u32 s12, s38, 1181696
    buffer_load_dwordx4 v14, s[20:23], s12 offen sc1 lds
    v_mfma_f32_16x16x32_bf16 v[72:75], a[148:151], v[152:155], v[72:75]
    ds_read_b64_tr_b16 v[168:169], v16 offset:53248
    v_mfma_f32_16x16x32_bf16 v[88:91], a[152:155], v[152:155], v[88:91]
    ds_read_b64_tr_b16 v[170:171], v16 offset:55296
    s_waitcnt lgkmcnt(6)
    v_mfma_f32_16x16x32_bf16 v[60:63], a[144:147], v[156:159], v[60:63]
    s_add_u32 m0, s39, 106496
    s_add_u32 s12, s38, 1312768
    buffer_load_dwordx4 v14, s[20:23], s12 offen sc1 lds
    v_mfma_f32_16x16x32_bf16 v[76:79], a[148:151], v[156:159], v[76:79]
    ds_read_b64_tr_b16 v[172:173], v17 offset:53248
    v_mfma_f32_16x16x32_bf16 v[92:95], a[152:155], v[156:159], v[92:95]
    ds_read_b64_tr_b16 v[174:175], v17 offset:55296
    s_waitcnt lgkmcnt(6)
    v_mfma_f32_16x16x32_bf16 v[64:67], a[144:147], v[160:163], v[64:67]
    s_add_u32 m0, s39, 110592
    s_add_u32 s12, s38, 1443840
    buffer_load_dwordx4 v14, s[20:23], s12 offen sc1 lds
    v_mfma_f32_16x16x32_bf16 v[80:83], a[148:151], v[160:163], v[80:83]
    ds_read_b64_tr_b16 v[176:177], v18 offset:53248
    v_mfma_f32_16x16x32_bf16 v[96:99], a[152:155], v[160:163], v[96:99]
    ds_read_b64_tr_b16 v[178:179], v18 offset:55296
    s_waitcnt lgkmcnt(6)
    v_mfma_f32_16x16x32_bf16 v[52:55], a[156:159], v[164:167], v[52:55]
    s_add_u32 m0, s39, 114688
    s_add_u32 s12, s38, 1574912
    buffer_load_dwordx4 v14, s[20:23], s12 offen sc1 lds
    v_mfma_f32_16x16x32_bf16 v[68:71], a[160:163], v[164:167], v[68:71]
    ds_read_b64_tr_b16 v[148:149], v15 offset:57344
    v_mfma_f32_16x16x32_bf16 v[84:87], a[164:167], v[164:167], v[84:87]
    ds_read_b64_tr_b16 v[150:151], v15 offset:59392
    s_waitcnt lgkmcnt(6)
    v_mfma_f32_16x16x32_bf16 v[56:59], a[156:159], v[168:171], v[56:59]
    s_add_u32 m0, s39, 118784
    s_add_u32 s12, s38, 1705984
    buffer_load_dwordx4 v14, s[20:23], s12 offen sc1 lds
    v_mfma_f32_16x16x32_bf16 v[72:75], a[160:163], v[168:171], v[72:75]
    ds_read_b64_tr_b16 v[152:153], v16 offset:57344
    v_mfma_f32_16x16x32_bf16 v[88:91], a[164:167], v[168:171], v[88:91]
    ds_read_b64_tr_b16 v[154:155], v16 offset:59392
    s_waitcnt lgkmcnt(6)
    v_mfma_f32_16x16x32_bf16 v[60:63], a[156:159], v[172:175], v[60:63]
    s_add_u32 m0, s39, 122880
    s_add_u32 s12, s38, 1837056
    buffer_load_dwordx4 v14, s[20:23], s12 offen sc1 lds
    v_mfma_f32_16x16x32_bf16 v[76:79], a[160:163], v[172:175], v[76:79]
    ds_read_b64_tr_b16 v[156:157], v17 offset:57344
    v_mfma_f32_16x16x32_bf16 v[92:95], a[164:167], v[172:175], v[92:95]
    ds_read_b64_tr_b16 v[158:159], v17 offset:59392
    s_waitcnt lgkmcnt(6)
    v_mfma_f32_16x16x32_bf16 v[64:67], a[156:159], v[176:179], v[64:67]
    s_add_u32 m0, s39, 126976
    s_add_u32 s12, s38, 1968128
    buffer_load_dwordx4 v14, s[20:23], s12 offen sc1 lds
    v_mfma_f32_16x16x32_bf16 v[80:83], a[160:163], v[176:179], v[80:83]
    ds_read_b64_tr_b16 v[160:161], v18 offset:57344
    v_mfma_f32_16x16x32_bf16 v[96:99], a[164:167], v[176:179], v[96:99]
    ds_read_b64_tr_b16 v[162:163], v18 offset:59392
    s_waitcnt lgkmcnt(6)
    v_mfma_f32_16x16x32_bf16 v[52:55], a[168:171], v[148:151], v[52:55]
    v_mfma_f32_16x16x32_bf16 v[68:71], a[172:175], v[148:151], v[68:71]
    ds_read_b64_tr_b16 v[164:165], v15 offset:61440
    v_mfma_f32_16x16x32_bf16 v[84:87], a[176:179], v[148:151], v[84:87]
    ds_read_b64_tr_b16 v[166:167], v15 offset:63488
    s_waitcnt lgkmcnt(6)
    v_mfma_f32_16x16x32_bf16 v[56:59], a[168:171], v[152:155], v[56:59]
    v_mfma_f32_16x16x32_bf16 v[72:75], a[172:175], v[152:155], v[72:75]
    ds_read_b64_tr_b16 v[168:169], v16 offset:61440
    v_mfma_f32_16x16x32_bf16 v[88:91], a[176:179], v[152:155], v[88:91]
    ds_read_b64_tr_b16 v[170:171], v16 offset:63488
    s_waitcnt lgkmcnt(6)
    v_mfma_f32_16x16x32_bf16 v[60:63], a[168:171], v[156:159], v[60:63]
    v_mfma_f32_16x16x32_bf16 v[76:79], a[172:175], v[156:159], v[76:79]
    ds_read_b64_tr_b16 v[172:173], v17 offset:61440
    v_mfma_f32_16x16x32_bf16 v[92:95], a[176:179], v[156:159], v[92:95]
    ds_read_b64_tr_b16 v[174:175], v17 offset:63488
    s_waitcnt lgkmcnt(6)
    v_mfma_f32_16x16x32_bf16 v[64:67], a[168:171], v[160:163], v[64:67]
    v_mfma_f32_16x16x32_bf16 v[80:83], a[172:175], v[160:163], v[80:83]
    ds_read_b64_tr_b16 v[176:177], v18 offset:61440
    v_mfma_f32_16x16x32_bf16 v[96:99], a[176:179], v[160:163], v[96:99]
    ds_read_b64_tr_b16 v[178:179], v18 offset:63488
    s_waitcnt vmcnt(14)
    s_barrier
    s_waitcnt lgkmcnt(6)
    v_mfma_f32_16x16x32_bf16 v[52:55], a[180:183], v[164:167], v[52:55]
    v_xor_b32 v15, 0x10000, v15
    v_mfma_f32_16x16x32_bf16 v[68:71], a[184:187], v[164:167], v[68:71]
    ds_read_b64_tr_b16 v[148:149], v15 offset:0
    v_mfma_f32_16x16x32_bf16 v[84:87], a[188:191], v[164:167], v[84:87]
    ds_read_b64_tr_b16 v[150:151], v15 offset:2048
    s_waitcnt lgkmcnt(6)
    v_mfma_f32_16x16x32_bf16 v[56:59], a[180:183], v[168:171], v[56:59]
    v_xor_b32 v16, 0x10000, v16
    v_mfma_f32_16x16x32_bf16 v[72:75], a[184:187], v[168:171], v[72:75]
    ds_read_b64_tr_b16 v[152:153], v16 offset:0
    v_mfma_f32_16x16x32_bf16 v[88:91], a[188:191], v[168:171], v[88:91]
    ds_read_b64_tr_b16 v[154:155], v16 offset:2048
    s_waitcnt lgkmcnt(6)
    v_mfma_f32_16x16x32_bf16 v[60:63], a[180:183], v[172:175], v[60:63]
    v_xor_b32 v17, 0x10000, v17
    v_mfma_f32_16x16x32_bf16 v[76:79], a[184:187], v[172:175], v[76:79]
    ds_read_b64_tr_b16 v[156:157], v17 offset:0
    v_mfma_f32_16x16x32_bf16 v[92:95], a[188:191], v[172:175], v[92:95]
    ds_read_b64_tr_b16 v[158:159], v17 offset:2048
    s_waitcnt lgkmcnt(6)
    v_mfma_f32_16x16x32_bf16 v[64:67], a[180:183], v[176:179], v[64:67]
    v_xor_b32 v18, 0x10000, v18
    v_mfma_f32_16x16x32_bf16 v[80:83], a[184:187], v[176:179], v[80:83]
    ds_read_b64_tr_b16 v[160:161], v18 offset:0
    v_mfma_f32_16x16x32_bf16 v[96:99], a[188:191], v[176:179], v[96:99]
    ds_read_b64_tr_b16 v[162:163], v18 offset:2048
    s_waitcnt lgkmcnt(6)
    v_mfma_f32_16x16x32_bf16 v[100:103], a[0:3], v[148:151], 0
    v_mfma_f32_16x16x32_bf16 v[116:119], a[4:7], v[148:151], 0
    ds_read_b64_tr_b16 v[164:165], v15 offset:4096
    v_mfma_f32_16x16x32_bf16 v[132:135], a[8:11], v[148:151], 0
    ds_read_b64_tr_b16 v[166:167], v15 offset:6144
    s_waitcnt lgkmcnt(6)
    v_mfma_f32_16x16x32_bf16 v[104:107], a[0:3], v[152:155], 0
    v_mfma_f32_16x16x32_bf16 v[120:123], a[4:7], v[152:155], 0
    ds_read_b64_tr_b16 v[168:169], v16 offset:4096
    v_mfma_f32_16x16x32_bf16 v[136:139], a[8:11], v[152:155], 0
    ds_read_b64_tr_b16 v[170:171], v16 offset:6144
    s_waitcnt lgkmcnt(6)
    v_mfma_f32_16x16x32_bf16 v[108:111], a[0:3], v[156:159], 0
    v_mfma_f32_16x16x32_bf16 v[124:127], a[4:7], v[156:159], 0
    ds_read_b64_tr_b16 v[172:173], v17 offset:4096
    v_mfma_f32_16x16x32_bf16 v[140:143], a[8:11], v[156:159], 0
    ds_read_b64_tr_b16 v[174:175], v17 offset:6144
    s_waitcnt lgkmcnt(6)
    v_mfma_f32_16x16x32_bf16 v[112:115], a[0:3], v[160:163], 0
    v_mfma_f32_16x16x32_bf16 v[128:131], a[4:7], v[160:163], 0
    ds_read_b64_tr_b16 v[176:177], v18 offset:4096
    v_mfma_f32_16x16x32_bf16 v[144:147], a[8:11], v[160:163], 0
    ds_read_b64_tr_b16 v[178:179], v18 offset:6144
    s_waitcnt vmcnt(10)
    s_barrier
    s_waitcnt lgkmcnt(6)
    v_mfma_f32_16x16x32_bf16 v[100:103], a[12:15], v[164:167], v[100:103]
    ds_read_b128 v[180:183], v19 offset:0
    ds_read_b128 v[192:195], v19 offset:256
    s_waitcnt lgkmcnt(1)
    v_mul_f32 v180, 0xbb000000, v180
    v_mul_f32 v181, 0xbb000000, v181
    v_mfma_f32_16x16x32_bf16 v[116:119], a[16:19], v[164:167], v[116:119]
    ds_read_b64_tr_b16 v[148:149], v15 offset:8192
    v_mul_f32 v182, 0xbb000000, v182
    v_mul_f32 v183, 0xbb000000, v183
    s_waitcnt lgkmcnt(1)
    v_fma_f32 v192, v192, s49, v35
    v_mfma_f32_16x16x32_bf16 v[132:135], a[20:23], v[164:167], v[132:135]
    ds_read_b64_tr_b16 v[150:151], v15 offset:10240
    v_fma_f32 v193, v193, s49, v35
    v_fma_f32 v194, v194, s49, v35
    v_fma_f32 v195, v195, s49, v35
    v_mfma_f32_16x16x32_bf16 v[104:107], a[12:15], v[168:171], v[104:107]
    v_fma_f32 v192, -v180, v180, v192
    v_fma_f32 v193, -v181, v181, v193
    v_fma_f32 v194, -v182, v182, v194
    v_fma_f32 v195, -v183, v183, v195
    v_mfma_f32_16x16x32_bf16 v[120:123], a[16:19], v[168:171], v[120:123]
    ds_read_b64_tr_b16 v[152:153], v16 offset:8192
    v_max_f32 v192, v35, v192
    v_max_f32 v193, v35, v193
    v_max_f32 v194, v35, v194
    v_mfma_f32_16x16x32_bf16 v[136:139], a[20:23], v[168:171], v[136:139]
    ds_read_b64_tr_b16 v[154:155], v16 offset:10240
    v_max_f32 v195, v35, v195
    v_rsq_f32 v184, v192
    v_rsq_f32 v185, v193
    v_mfma_f32_16x16x32_bf16 v[108:111], a[12:15], v[172:175], v[108:111]
    v_rsq_f32 v186, v194
    v_rsq_f32 v187, v195
    v_mul_f32 v188, v184, v184
    v_mul_f32 v189, v185, v185
    v_mfma_f32_16x16x32_bf16 v[124:127], a[16:19], v[172:175], v[124:127]
    ds_read_b64_tr_b16 v[156:157], v17 offset:8192
    v_mul_f32 v190, v186, v186
    v_mul_f32 v191, v187, v187
    v_mul_f32 v188, v188, v184
    v_mfma_f32_16x16x32_bf16 v[140:143], a[20:23], v[172:175], v[140:143]
    ds_read_b64_tr_b16 v[158:159], v17 offset:10240
    v_mul_f32 v189, v189, v185
    v_mul_f32 v190, v190, v186
    v_mul_f32 v191, v191, v187
    v_mfma_f32_16x16x32_bf16 v[112:115], a[12:15], v[176:179], v[112:115]
    v_mul_f32 v184, 0xc0135761, v184
    v_mul_f32 v185, 0xc0135761, v185
    v_mul_f32 v186, 0xc0135761, v186
    v_mul_f32 v187, 0xc0135761, v187
    v_mfma_f32_16x16x32_bf16 v[128:131], a[16:19], v[176:179], v[128:131]
    ds_read_b64_tr_b16 v[160:161], v18 offset:8192
    v_mul_f32 v188, 0xbdd2d3e8, v188
    v_mul_f32 v189, 0xbdd2d3e8, v189
    v_mul_f32 v190, 0xbdd2d3e8, v190
    v_mfma_f32_16x16x32_bf16 v[144:147], a[20:23], v[176:179], v[144:147]
    ds_read_b64_tr_b16 v[162:163], v18 offset:10240
    v_mul_f32 v191, 0xbdd2d3e8, v191
    v_fmac_f32 v52, v36, v180
    v_fmac_f32 v53, v37, v180
    s_waitcnt lgkmcnt(6)
    v_mfma_f32_16x16x32_bf16 v[100:103], a[24:27], v[148:151], v[100:103]
    v_fmac_f32 v54, v38, v180
    v_fmac_f32 v55, v39, v180
    v_mul_f32 v196, v52, v52
    v_mul_f32 v197, v53, v53
    v_mfma_f32_16x16x32_bf16 v[116:119], a[28:31], v[148:151], v[116:119]
    ds_read_b64_tr_b16 v[164:165], v15 offset:12288
    v_fma_f32 v196, v196, v188, v184
    v_fma_f32 v197, v197, v188, v184
    v_mul_f32 v196, v196, v52
    v_mfma_f32_16x16x32_bf16 v[132:135], a[32:35], v[148:151], v[132:135]
    ds_read_b64_tr_b16 v[166:167], v15 offset:14336
    v_mul_f32 v197, v197, v53
    v_exp_f32 v196, v196
    v_exp_f32 v197, v197
    s_waitcnt lgkmcnt(6)
    v_mfma_f32_16x16x32_bf16 v[104:107], a[24:27], v[152:155], v[104:107]
    v_mul_f32 v52, v52, v54
    v_mul_f32 v53, v53, v55
    v_fma_f32 v196, v196, v192, v192
    v_fma_f32 v197, v197, v192, v192
    v_mfma_f32_16x16x32_bf16 v[120:123], a[28:31], v[152:155], v[120:123]
    ds_read_b64_tr_b16 v[168:169], v16 offset:12288
    s_add_u32 s11, s43, 16384
    buffer_load_dwordx4 a[0:3], v5, s[20:23], s11 offen offset:0 sc1
    v_rcp_f32 v196, v196
    v_rcp_f32 v197, v197
    v_fmac_f32 v56, v36, v181
    v_mfma_f32_16x16x32_bf16 v[136:139], a[32:35], v[152:155], v[136:139]
    ds_read_b64_tr_b16 v[170:171], v16 offset:14336
    v_fmac_f32 v57, v37, v181
    v_mul_f32 v52, v52, v196
    v_mul_f32 v53, v53, v197
    s_waitcnt lgkmcnt(6)
    v_mfma_f32_16x16x32_bf16 v[108:111], a[24:27], v[156:159], v[108:111]
    v_cvt_pk_bf16_f32 v200, v52, v53
    v_fmac_f32 v58, v38, v181
    v_fmac_f32 v59, v39, v181
    v_mul_f32 v198, v56, v56
    v_mfma_f32_16x16x32_bf16 v[124:127], a[28:31], v[156:159], v[124:127]
    ds_read_b64_tr_b16 v[172:173], v17 offset:12288
    v_mul_f32 v199, v57, v57
    v_fma_f32 v198, v198, v189, v185
    v_fma_f32 v199, v199, v189, v185
    v_mfma_f32_16x16x32_bf16 v[140:143], a[32:35], v[156:159], v[140:143]
    ds_read_b64_tr_b16 v[174:175], v17 offset:14336
    v_mul_f32 v198, v198, v56
    v_mul_f32 v199, v199, v57
    v_exp_f32 v198, v198
    s_waitcnt lgkmcnt(6)
    v_mfma_f32_16x16x32_bf16 v[112:115], a[24:27], v[160:163], v[112:115]
    buffer_load_dwordx4 a[4:7], v5, s[20:23], s11 offen offset:1024 sc1
    v_exp_f32 v199, v199
    v_mul_f32 v56, v56, v58
    v_mul_f32 v57, v57, v59
    v_fma_f32 v198, v198, v193, v193
    v_mfma_f32_16x16x32_bf16 v[128:131], a[28:31], v[160:163], v[128:131]
    ds_read_b64_tr_b16 v[176:177], v18 offset:12288
    v_fma_f32 v199, v199, v193, v193
    v_rcp_f32 v198, v198
    v_rcp_f32 v199, v199
    v_mfma_f32_16x16x32_bf16 v[144:147], a[32:35], v[160:163], v[144:147]
    ds_read_b64_tr_b16 v[178:179], v18 offset:14336
    v_fmac_f32 v60, v36, v182
    v_fmac_f32 v61, v37, v182
    v_mul_f32 v56, v56, v198
    s_waitcnt lgkmcnt(6)
    v_mfma_f32_16x16x32_bf16 v[100:103], a[36:39], v[164:167], v[100:103]
    v_mul_f32 v57, v57, v199
    v_cvt_pk_bf16_f32 v201, v56, v57
    v_fmac_f32 v62, v38, v182
    v_fmac_f32 v63, v39, v182
    v_mfma_f32_16x16x32_bf16 v[116:119], a[40:43], v[164:167], v[116:119]
    ds_read_b64_tr_b16 v[148:149], v15 offset:16384
    v_mul_f32 v196, v60, v60
    v_mul_f32 v197, v61, v61
    v_fma_f32 v196, v196, v190, v186
    v_mfma_f32_16x16x32_bf16 v[132:135], a[44:47], v[164:167], v[132:135]
    ds_read_b64_tr_b16 v[150:151], v15 offset:18432
    buffer_load_dwordx4 a[8:11], v5, s[20:23], s11 offen offset:2048 sc1
    v_fma_f32 v197, v197, v190, v186
    v_mul_f32 v196, v196, v60
    v_mul_f32 v197, v197, v61
    s_waitcnt lgkmcnt(6)
    v_mfma_f32_16x16x32_bf16 v[104:107], a[36:39], v[168:171], v[104:107]
    v_exp_f32 v196, v196
    v_exp_f32 v197, v197
    v_mul_f32 v60, v60, v62
    v_mul_f32 v61, v61, v63
    v_mfma_f32_16x16x32_bf16 v[120:123], a[40:43], v[168:171], v[120:123]
    ds_read_b64_tr_b16 v[152:153], v16 offset:16384
    v_fma_f32 v196, v196, v194, v194
    v_fma_f32 v197, v197, v194, v194
    v_rcp_f32 v196, v196
    v_mfma_f32_16x16x32_bf16 v[136:139], a[44:47], v[168:171], v[136:139]
    ds_read_b64_tr_b16 v[154:155], v16 offset:18432
    v_rcp_f32 v197, v197
    v_fmac_f32 v64, v36, v183
    v_fmac_f32 v65, v37, v183
    s_waitcnt lgkmcnt(6)
    v_mfma_f32_16x16x32_bf16 v[108:111], a[36:39], v[172:175], v[108:111]
    v_mul_f32 v60, v60, v196
    v_mul_f32 v61, v61, v197
    v_cvt_pk_bf16_f32 v202, v60, v61
    v_fmac_f32 v66, v38, v183
    v_mfma_f32_16x16x32_bf16 v[124:127], a[40:43], v[172:175], v[124:127]
    ds_read_b64_tr_b16 v[156:157], v17 offset:16384
    buffer_load_dwordx4 a[12:15], v5, s[20:23], s11 offen offset:3072 sc1
    v_fmac_f32 v67, v39, v183
    v_mul_f32 v198, v64, v64
    v_mul_f32 v199, v65, v65
    v_mfma_f32_16x16x32_bf16 v[140:143], a[44:47], v[172:175], v[140:143]
    ds_read_b64_tr_b16 v[158:159], v17 offset:18432
    v_fma_f32 v198, v198, v191, v187
    v_fma_f32 v199, v199, v191, v187
    v_mul_f32 v198, v198, v64
    s_waitcnt lgkmcnt(6)
    v_mfma_f32_16x16x32_bf16 v[112:115], a[36:39], v[176:179], v[112:115]
    v_mul_f32 v199, v199, v65
    v_exp_f32 v198, v198
    v_exp_f32 v199, v199
    v_mul_f32 v64, v64, v66
    v_mfma_f32_16x16x32_bf16 v[128:131], a[40:43], v[176:179], v[128:131]
    ds_read_b64_tr_b16 v[160:161], v18 offset:16384
    v_mul_f32 v65, v65, v67
    v_fma_f32 v198, v198, v195, v195
    v_fma_f32 v199, v199, v195, v195
    v_mfma_f32_16x16x32_bf16 v[144:147], a[44:47], v[176:179], v[144:147]
    ds_read_b64_tr_b16 v[162:163], v18 offset:18432
    v_rcp_f32 v198, v198
    v_rcp_f32 v199, v199
    v_mul_f32 v64, v64, v198
    s_waitcnt lgkmcnt(6)
    v_mfma_f32_16x16x32_bf16 v[100:103], a[48:51], v[148:151], v[100:103]
    s_add_u32 s11, s43, 20480
    buffer_load_dwordx4 a[16:19], v5, s[20:23], s11 offen offset:0 sc1
    v_mul_f32 v65, v65, v199
    v_cvt_pk_bf16_f32 v203, v64, v65
    v_permlane32_swap_b32 v200, v202
    s_nop 0
    v_permlane32_swap_b32 v201, v203
    v_mfma_f32_16x16x32_bf16 v[116:119], a[52:55], v[148:151], v[116:119]
    ds_read_b64_tr_b16 v[164:165], v15 offset:20480
    s_add_u32 s13, s41, 0
    v_permlane16_swap_b32 v200, v201
    v_permlane16_swap_b32 v202, v203
    v_mfma_f32_16x16x32_bf16 v[132:135], a[56:59], v[148:151], v[132:135]
    ds_read_b64_tr_b16 v[166:167], v15 offset:22528
    buffer_store_dwordx4 v[200:203], v20, s[20:23], s13 offen sc1
    v_fmac_f32 v68, v40, v180
    v_fmac_f32 v69, v41, v180
    s_waitcnt lgkmcnt(6)
    v_mfma_f32_16x16x32_bf16 v[104:107], a[48:51], v[152:155], v[104:107]
    v_fmac_f32 v70, v42, v180
    v_fmac_f32 v71, v43, v180
    v_mul_f32 v196, v68, v68
    v_mul_f32 v197, v69, v69
    v_mfma_f32_16x16x32_bf16 v[120:123], a[52:55], v[152:155], v[120:123]
    ds_read_b64_tr_b16 v[168:169], v16 offset:20480
    v_fma_f32 v196, v196, v188, v184
    v_fma_f32 v197, v197, v188, v184
    v_mul_f32 v196, v196, v68
    v_mfma_f32_16x16x32_bf16 v[136:139], a[56:59], v[152:155], v[136:139]
    ds_read_b64_tr_b16 v[170:171], v16 offset:22528
    buffer_load_dwordx4 a[20:23], v5, s[20:23], s11 offen offset:1024 sc1
    v_mul_f32 v197, v197, v69
    v_exp_f32 v196, v196
    v_exp_f32 v197, v197
    s_waitcnt lgkmcnt(6)
    v_mfma_f32_16x16x32_bf16 v[108:111], a[48:51], v[156:159], v[108:111]
    v_mul_f32 v68, v68, v70
    v_mul_f32 v69, v69, v71
    v_fma_f32 v196, v196, v192, v192
    v_fma_f32 v197, v197, v192, v192
    v_mfma_f32_16x16x32_bf16 v[124:127], a[52:55], v[156:159], v[124:127]
    ds_read_b64_tr_b16 v[172:173], v17 offset:20480
    v_rcp_f32 v196, v196
    v_rcp_f32 v197, v197
    v_fmac_f32 v72, v40, v181
    v_mfma_f32_16x16x32_bf16 v[140:143], a[56:59], v[156:159], v[140:143]
    ds_read_b64_tr_b16 v[174:175], v17 offset:22528
    v_fmac_f32 v73, v41, v181
    v_mul_f32 v68, v68, v196
    v_mul_f32 v69, v69, v197
    s_waitcnt lgkmcnt(6)
    v_mfma_f32_16x16x32_bf16 v[112:115], a[48:51], v[160:163], v[112:115]
    v_cvt_pk_bf16_f32 v204, v68, v69
    v_fmac_f32 v74, v42, v181
    v_fmac_f32 v75, v43, v181
    v_mul_f32 v198, v72, v72
    v_mfma_f32_16x16x32_bf16 v[128:131], a[52:55], v[160:163], v[128:131]
    ds_read_b64_tr_b16 v[176:177], v18 offset:20480
    buffer_load_dwordx4 a[24:27], v5, s[20:23], s11 offen offset:2048 sc1
    v_mul_f32 v199, v73, v73
    v_fma_f32 v198, v198, v189, v185
    v_fma_f32 v199, v199, v189, v185
    v_mfma_f32_16x16x32_bf16 v[144:147], a[56:59], v[160:163], v[144:147]
    ds_read_b64_tr_b16 v[178:179], v18 offset:22528
    v_mul_f32 v198, v198, v72
    v_mul_f32 v199, v199, v73
    v_exp_f32 v198, v198
    s_waitcnt vmcnt(8)
    s_barrier
    s_waitcnt lgkmcnt(6)
    v_mfma_f32_16x16x32_bf16 v[100:103], a[60:63], v[164:167], v[100:103]
    v_exp_f32 v199, v199
    v_mul_f32 v72, v72, v74
    v_mul_f32 v73, v73, v75
    v_fma_f32 v198, v198, v193, v193
    v_mfma_f32_16x16x32_bf16 v[116:119], a[64:67], v[164:167], v[116:119]
    ds_read_b64_tr_b16 v[148:149], v15 offset:24576
    v_fma_f32 v199, v199, v193, v193
    v_rcp_f32 v198, v198
    v_rcp_f32 v199, v199
    v_mfma_f32_16x16x32_bf16 v[132:135], a[68:71], v[164:167], v[132:135]
    ds_read_b64_tr_b16 v[150:151], v15 offset:26624
    v_fmac_f32 v76, v40, v182
    v_fmac_f32 v77, v41, v182
    v_mul_f32 v72, v72, v198
    s_waitcnt lgkmcnt(6)
    v_mfma_f32_16x16x32_bf16 v[104:107], a[60:63], v[168:171], v[104:107]
    buffer_load_dwordx4 a[28:31], v5, s[20:23], s11 offen offset:3072 sc1
    v_mul_f32 v73, v73, v199
    v_cvt_pk_bf16_f32 v205, v72, v73
    v_fmac_f32 v78, v42, v182
    v_fmac_f32 v79, v43, v182
    v_mfma_f32_16x16x32_bf16 v[120:123], a[64:67], v[168:171], v[120:123]
    ds_read_b64_tr_b16 v[152:153], v16 offset:24576
    v_mul_f32 v196, v76, v76
    v_mul_f32 v197, v77, v77
    v_fma_f32 v196, v196, v190, v186
    v_mfma_f32_16x16x32_bf16 v[136:139], a[68:71], v[168:171], v[136:139]
    ds_read_b64_tr_b16 v[154:155], v16 offset:26624
    v_fma_f32 v197, v197, v190, v186
    v_mul_f32 v196, v196, v76
    v_mul_f32 v197, v197, v77
    s_waitcnt lgkmcnt(6)
    v_mfma_f32_16x16x32_bf16 v[108:111], a[60:63], v[172:175], v[108:111]
    v_exp_f32 v196, v196
    v_exp_f32 v197, v197
    v_mul_f32 v76, v76, v78
    v_mul_f32 v77, v77, v79
    v_mfma_f32_16x16x32_bf16 v[124:127], a[64:67], v[172:175], v[124:127]
    ds_read_b64_tr_b16 v[156:157], v17 offset:24576
    v_fma_f32 v196, v196, v194, v194
    v_fma_f32 v197, v197, v194, v194
    v_rcp_f32 v196, v196
    v_mfma_f32_16x16x32_bf16 v[140:143], a[68:71], v[172:175], v[140:143]
    ds_read_b64_tr_b16 v[158:159], v17 offset:26624
    s_add_u32 s11, s43, 24576
    buffer_load_dwordx4 a[32:35], v5, s[20:23], s11 offen offset:0 sc1
    v_rcp_f32 v197, v197
    v_fmac_f32 v80, v40, v183
    v_fmac_f32 v81, v41, v183
    s_waitcnt lgkmcnt(6)
    v_mfma_f32_16x16x32_bf16 v[112:115], a[60:63], v[176:179], v[112:115]
    v_mul_f32 v76, v76, v196
    v_mul_f32 v77, v77, v197
    v_cvt_pk_bf16_f32 v206, v76, v77
    v_fmac_f32 v82, v42, v183
    v_mfma_f32_16x16x32_bf16 v[128:131], a[64:67], v[176:179], v[128:131]
    ds_read_b64_tr_b16 v[160:161], v18 offset:24576
    v_fmac_f32 v83, v43, v183
    v_mul_f32 v198, v80, v80
    v_mul_f32 v199, v81, v81
    v_mfma_f32_16x16x32_bf16 v[144:147], a[68:71], v[176:179], v[144:147]
    ds_read_b64_tr_b16 v[162:163], v18 offset:26624
    v_fma_f32 v198, v198, v191, v187
    v_fma_f32 v199, v199, v191, v187
    v_mul_f32 v198, v198, v80
    s_waitcnt lgkmcnt(6)
    v_mfma_f32_16x16x32_bf16 v[100:103], a[72:75], v[148:151], v[100:103]
    v_mul_f32 v199, v199, v81
    v_exp_f32 v198, v198
    v_exp_f32 v199, v199
    v_mul_f32 v80, v80, v82
    v_mfma_f32_16x16x32_bf16 v[116:119], a[76:79], v[148:151], v[116:119]
    ds_read_b64_tr_b16 v[164:165], v15 offset:28672
    buffer_load_dwordx4 a[36:39], v5, s[20:23], s11 offen offset:1024 sc1
    v_mul_f32 v81, v81, v83
    v_fma_f32 v198, v198, v195, v195
    v_fma_f32 v199, v199, v195, v195
    v_mfma_f32_16x16x32_bf16 v[132:135], a[80:83], v[148:151], v[132:135]
    ds_read_b64_tr_b16 v[166:167], v15 offset:30720
    v_rcp_f32 v198, v198
    v_rcp_f32 v199, v199
    v_mul_f32 v80, v80, v198
    s_waitcnt lgkmcnt(6)
    v_mfma_f32_16x16x32_bf16 v[104:107], a[72:75], v[152:155], v[104:107]
    v_mul_f32 v81, v81, v199
    v_cvt_pk_bf16_f32 v207, v80, v81
    v_permlane32_swap_b32 v204, v206
    s_nop 0
    v_permlane32_swap_b32 v205, v207
    v_mfma_f32_16x16x32_bf16 v[120:123], a[76:79], v[152:155], v[120:123]
    ds_read_b64_tr_b16 v[168:169], v16 offset:28672
    s_add_u32 s13, s41, 32768
    v_permlane16_swap_b32 v204, v205
    v_permlane16_swap_b32 v206, v207
    v_mfma_f32_16x16x32_bf16 v[136:139], a[80:83], v[152:155], v[136:139]
    ds_read_b64_tr_b16 v[170:171], v16 offset:30720
    buffer_store_dwordx4 v[204:207], v20, s[20:23], s13 offen sc1
    v_fmac_f32 v84, v44, v180
    v_fmac_f32 v85, v45, v180
    s_waitcnt lgkmcnt(6)
    v_mfma_f32_16x16x32_bf16 v[108:111], a[72:75], v[156:159], v[108:111]
    buffer_load_dwordx4 a[40:43], v5, s[20:23], s11 offen offset:2048 sc1
    v_fmac_f32 v86, v46, v180
    v_fmac_f32 v87, v47, v180
    v_mul_f32 v196, v84, v84
    v_mul_f32 v197, v85, v85
    v_mfma_f32_16x16x32_bf16 v[124:127], a[76:79], v[156:159], v[124:127]
    ds_read_b64_tr_b16 v[172:173], v17 offset:28672
    v_fma_f32 v196, v196, v188, v184
    v_fma_f32 v197, v197, v188, v184
    v_mul_f32 v196, v196, v84
    v_mfma_f32_16x16x32_bf16 v[140:143], a[80:83], v[156:159], v[140:143]
    ds_read_b64_tr_b16 v[174:175], v17 offset:30720
    v_mul_f32 v197, v197, v85
    v_exp_f32 v196, v196
    v_exp_f32 v197, v197
    s_waitcnt lgkmcnt(6)
    v_mfma_f32_16x16x32_bf16 v[112:115], a[72:75], v[160:163], v[112:115]
    v_mul_f32 v84, v84, v86
    v_mul_f32 v85, v85, v87
    v_fma_f32 v196, v196, v192, v192
    v_fma_f32 v197, v197, v192, v192
    v_mfma_f32_16x16x32_bf16 v[128:131], a[76:79], v[160:163], v[128:131]
    ds_read_b64_tr_b16 v[176:177], v18 offset:28672
    v_rcp_f32 v196, v196
    v_rcp_f32 v197, v197
    v_fmac_f32 v88, v44, v181
    v_mfma_f32_16x16x32_bf16 v[144:147], a[80:83], v[160:163], v[144:147]
    ds_read_b64_tr_b16 v[178:179], v18 offset:30720
    buffer_load_dwordx4 a[44:47], v5, s[20:23], s11 offen offset:3072 sc1
    v_fmac_f32 v89, v45, v181
    v_mul_f32 v84, v84, v196
    v_mul_f32 v85, v85, v197
    s_waitcnt lgkmcnt(6)
    v_mfma_f32_16x16x32_bf16 v[100:103], a[84:87], v[164:167], v[100:103]
    v_cvt_pk_bf16_f32 v208, v84, v85
    v_fmac_f32 v90, v46, v181
    v_fmac_f32 v91, v47, v181
    v_mul_f32 v198, v88, v88
    v_mfma_f32_16x16x32_bf16 v[116:119], a[88:91], v[164:167], v[116:119]
    ds_read_b64_tr_b16 v[148:149], v15 offset:32768
    v_mul_f32 v199, v89, v89
    v_fma_f32 v198, v198, v189, v185
    v_fma_f32 v199, v199, v189, v185
    v_mfma_f32_16x16x32_bf16 v[132:135], a[92:95], v[164:167], v[132:135]
    ds_read_b64_tr_b16 v[150:151], v15 offset:34816
    v_mul_f32 v198, v198, v88
    v_mul_f32 v199, v199, v89
    v_exp_f32 v198, v198
    s_waitcnt lgkmcnt(6)
    v_mfma_f32_16x16x32_bf16 v[104:107], a[84:87], v[168:171], v[104:107]
    v_exp_f32 v199, v199
    v_mul_f32 v88, v88, v90
    v_mul_f32 v89, v89, v91
    v_fma_f32 v198, v198, v193, v193
    v_mfma_f32_16x16x32_bf16 v[120:123], a[88:91], v[168:171], v[120:123]
    ds_read_b64_tr_b16 v[152:153], v16 offset:32768
    s_add_u32 s11, s43, 28672
    buffer_load_dwordx4 a[48:51], v5, s[20:23], s11 offen offset:0 sc1
    v_fma_f32 v199, v199, v193, v193
    v_rcp_f32 v198, v198
    v_rcp_f32 v199, v199
    v_mfma_f32_16x16x32_bf16 v[136:139], a[92:95], v[168:171], v[136:139]
    ds_read_b64_tr_b16 v[154:155], v16 offset:34816
    v_fmac_f32 v92, v44, v182
    v_fmac_f32 v93, v45, v182
    v_mul_f32 v88, v88, v198
    s_waitcnt lgkmcnt(6)
    v_mfma_f32_16x16x32_bf16 v[108:111], a[84:87], v[172:175], v[108:111]
    v_mul_f32 v89, v89, v199
    v_cvt_pk_bf16_f32 v209, v88, v89
    v_fmac_f32 v94, v46, v182
    v_fmac_f32 v95, v47, v182
    v_mfma_f32_16x16x32_bf16 v[124:127], a[88:91], v[172:175], v[124:127]
    ds_read_b64_tr_b16 v[156:157], v17 offset:32768
    v_mul_f32 v196, v92, v92
    v_mul_f32 v197, v93, v93
    v_fma_f32 v196, v196, v190, v186
    v_mfma_f32_16x16x32_bf16 v[140:143], a[92:95], v[172:175], v[140:143]
    ds_read_b64_tr_b16 v[158:159], v17 offset:34816
    v_fma_f32 v197, v197, v190, v186
    v_mul_f32 v196, v196, v92
    v_mul_f32 v197, v197, v93
    s_waitcnt lgkmcnt(6)
    v_mfma_f32_16x16x32_bf16 v[112:115], a[84:87], v[176:179], v[112:115]
    buffer_load_dwordx4 a[52:55], v5, s[20:23], s11 offen offset:1024 sc1
    v_exp_f32 v196, v196
    v_exp_f32 v197, v197
    v_mul_f32 v92, v92, v94
    v_mul_f32 v93, v93, v95
    v_mfma_f32_16x16x32_bf16 v[128:131], a[88:91], v[176:179], v[128:131]
    ds_read_b64_tr_b16 v[160:161], v18 offset:32768
    v_fma_f32 v196, v196, v194, v194
    v_fma_f32 v197, v197, v194, v194
    v_rcp_f32 v196, v196
    v_mfma_f32_16x16x32_bf16 v[144:147], a[92:95], v[176:179], v[144:147]
    ds_read_b64_tr_b16 v[162:163], v18 offset:34816
    v_rcp_f32 v197, v197
    v_fmac_f32 v96, v44, v183
    v_fmac_f32 v97, v45, v183
    s_waitcnt lgkmcnt(6)
    v_mfma_f32_16x16x32_bf16 v[100:103], a[96:99], v[148:151], v[100:103]
    v_mul_f32 v92, v92, v196
    v_mul_f32 v93, v93, v197
    v_cvt_pk_bf16_f32 v210, v92, v93
    v_fmac_f32 v98, v46, v183
    v_mfma_f32_16x16x32_bf16 v[116:119], a[100:103], v[148:151], v[116:119]
    ds_read_b64_tr_b16 v[164:165], v15 offset:36864
    v_fmac_f32 v99, v47, v183
    v_mul_f32 v198, v96, v96
    v_mul_f32 v199, v97, v97
    v_mfma_f32_16x16x32_bf16 v[132:135], a[104:107], v[148:151], v[132:135]
    ds_read_b64_tr_b16 v[166:167], v15 offset:38912
    buffer_load_dwordx4 a[56:59], v5, s[20:23], s11 offen offset:2048 sc1
    v_fma_f32 v198, v198, v191, v187
    v_fma_f32 v199, v199, v191, v187
    v_mul_f32 v198, v198, v96
    s_waitcnt lgkmcnt(6)
    v_mfma_f32_16x16x32_bf16 v[104:107], a[96:99], v[152:155], v[104:107]
    v_mul_f32 v199, v199, v97
    v_exp_f32 v198, v198
    v_exp_f32 v199, v199
    v_mul_f32 v96, v96, v98
    v_mfma_f32_16x16x32_bf16 v[120:123], a[100:103], v[152:155], v[120:123]
    ds_read_b64_tr_b16 v[168:169], v16 offset:36864
    v_mul_f32 v97, v97, v99
    v_fma_f32 v198, v198, v195, v195
    v_fma_f32 v199, v199, v195, v195
    v_mfma_f32_16x16x32_bf16 v[136:139], a[104:107], v[152:155], v[136:139]
    ds_read_b64_tr_b16 v[170:171], v16 offset:38912
    v_rcp_f32 v198, v198
    v_rcp_f32 v199, v199
    v_mul_f32 v96, v96, v198
    s_waitcnt lgkmcnt(6)
    v_mfma_f32_16x16x32_bf16 v[108:111], a[96:99], v[156:159], v[108:111]
    v_mul_f32 v97, v97, v199
    v_cvt_pk_bf16_f32 v211, v96, v97
    v_permlane32_swap_b32 v208, v210
    s_nop 0
    v_permlane32_swap_b32 v209, v211
    v_mfma_f32_16x16x32_bf16 v[124:127], a[100:103], v[156:159], v[124:127]
    ds_read_b64_tr_b16 v[172:173], v17 offset:36864
    buffer_load_dwordx4 a[60:63], v5, s[20:23], s11 offen offset:3072 sc1
    s_add_u32 s13, s41, 65536
    v_permlane16_swap_b32 v208, v209
    v_permlane16_swap_b32 v210, v211
    v_mfma_f32_16x16x32_bf16 v[140:143], a[104:107], v[156:159], v[140:143]
    ds_read_b64_tr_b16 v[174:175], v17 offset:38912
    buffer_store_dwordx4 v[208:211], v20, s[20:23], s13 offen sc1
    s_waitcnt lgkmcnt(6)
    v_mfma_f32_16x16x32_bf16 v[112:115], a[96:99], v[160:163], v[112:115]
    v_mfma_f32_16x16x32_bf16 v[128:131], a[100:103], v[160:163], v[128:131]
    ds_read_b64_tr_b16 v[176:177], v18 offset:36864
    v_mfma_f32_16x16x32_bf16 v[144:147], a[104:107], v[160:163], v[144:147]
    ds_read_b64_tr_b16 v[178:179], v18 offset:38912
    s_waitcnt lgkmcnt(6)
    v_mfma_f32_16x16x32_bf16 v[100:103], a[108:111], v[164:167], v[100:103]
    s_add_u32 s11, s43, 32768
    buffer_load_dwordx4 a[64:67], v5, s[20:23], s11 offen offset:0 sc1
    v_mfma_f32_16x16x32_bf16 v[116:119], a[112:115], v[164:167], v[116:119]
    ds_read_b64_tr_b16 v[148:149], v15 offset:40960
    v_mfma_f32_16x16x32_bf16 v[132:135], a[116:119], v[164:167], v[132:135]
    ds_read_b64_tr_b16 v[150:151], v15 offset:43008
    s_waitcnt lgkmcnt(6)
    v_mfma_f32_16x16x32_bf16 v[104:107], a[108:111], v[168:171], v[104:107]
    v_mfma_f32_16x16x32_bf16 v[120:123], a[112:115], v[168:171], v[120:123]
    ds_read_b64_tr_b16 v[152:153], v16 offset:40960
    v_mfma_f32_16x16x32_bf16 v[136:139], a[116:119], v[168:171], v[136:139]
    ds_read_b64_tr_b16 v[154:155], v16 offset:43008
    buffer_load_dwordx4 a[68:71], v5, s[20:23], s11 offen offset:1024 sc1
    s_waitcnt lgkmcnt(6)
    v_mfma_f32_16x16x32_bf16 v[108:111], a[108:111], v[172:175], v[108:111]
    v_mfma_f32_16x16x32_bf16 v[124:127], a[112:115], v[172:175], v[124:127]
    ds_read_b64_tr_b16 v[156:157], v17 offset:40960
    v_mfma_f32_16x16x32_bf16 v[140:143], a[116:119], v[172:175], v[140:143]
    ds_read_b64_tr_b16 v[158:159], v17 offset:43008
    s_waitcnt lgkmcnt(6)
    v_mfma_f32_16x16x32_bf16 v[112:115], a[108:111], v[176:179], v[112:115]
    v_mfma_f32_16x16x32_bf16 v[128:131], a[112:115], v[176:179], v[128:131]
    ds_read_b64_tr_b16 v[160:161], v18 offset:40960
    buffer_load_dwordx4 a[72:75], v5, s[20:23], s11 offen offset:2048 sc1
    v_mfma_f32_16x16x32_bf16 v[144:147], a[116:119], v[176:179], v[144:147]
    ds_read_b64_tr_b16 v[162:163], v18 offset:43008
    s_waitcnt lgkmcnt(6)
    v_mfma_f32_16x16x32_bf16 v[100:103], a[120:123], v[148:151], v[100:103]
    v_mfma_f32_16x16x32_bf16 v[116:119], a[124:127], v[148:151], v[116:119]
    ds_read_b64_tr_b16 v[164:165], v15 offset:45056
    v_mfma_f32_16x16x32_bf16 v[132:135], a[128:131], v[148:151], v[132:135]
    ds_read_b64_tr_b16 v[166:167], v15 offset:47104
    s_waitcnt lgkmcnt(6)
    v_mfma_f32_16x16x32_bf16 v[104:107], a[120:123], v[152:155], v[104:107]
    buffer_load_dwordx4 a[76:79], v5, s[20:23], s11 offen offset:3072 sc1
    v_mfma_f32_16x16x32_bf16 v[120:123], a[124:127], v[152:155], v[120:123]
    ds_read_b64_tr_b16 v[168:169], v16 offset:45056
    v_mfma_f32_16x16x32_bf16 v[136:139], a[128:131], v[152:155], v[136:139]
    ds_read_b64_tr_b16 v[170:171], v16 offset:47104
    s_waitcnt lgkmcnt(6)
    v_mfma_f32_16x16x32_bf16 v[108:111], a[120:123], v[156:159], v[108:111]
    v_mfma_f32_16x16x32_bf16 v[124:127], a[124:127], v[156:159], v[124:127]
    ds_read_b64_tr_b16 v[172:173], v17 offset:45056
    v_mfma_f32_16x16x32_bf16 v[140:143], a[128:131], v[156:159], v[140:143]
    ds_read_b64_tr_b16 v[174:175], v17 offset:47104
    s_add_u32 s11, s43, 36864
    buffer_load_dwordx4 a[80:83], v5, s[20:23], s11 offen offset:0 sc1
    s_waitcnt lgkmcnt(6)
    v_mfma_f32_16x16x32_bf16 v[112:115], a[120:123], v[160:163], v[112:115]
    v_mfma_f32_16x16x32_bf16 v[128:131], a[124:127], v[160:163], v[128:131]
    ds_read_b64_tr_b16 v[176:177], v18 offset:45056
    v_mfma_f32_16x16x32_bf16 v[144:147], a[128:131], v[160:163], v[144:147]
    ds_read_b64_tr_b16 v[178:179], v18 offset:47104
    s_waitcnt lgkmcnt(6)
    v_mfma_f32_16x16x32_bf16 v[100:103], a[132:135], v[164:167], v[100:103]
    v_mfma_f32_16x16x32_bf16 v[116:119], a[136:139], v[164:167], v[116:119]
    ds_read_b64_tr_b16 v[148:149], v15 offset:49152
    s_add_u32 s19, s47, 33095680
    v_mfma_f32_16x16x32_bf16 v[132:135], a[140:143], v[164:167], v[132:135]
    ds_read_b64_tr_b16 v[150:151], v15 offset:51200
    s_waitcnt vmcnt(5)
    s_barrier
    s_waitcnt lgkmcnt(6)
    v_mfma_f32_16x16x32_bf16 v[104:107], a[132:135], v[168:171], v[104:107]
    buffer_store_dword v32, v31, s[20:23], s19 offen sc1
    v_mfma_f32_16x16x32_bf16 v[120:123], a[136:139], v[168:171], v[120:123]
    ds_read_b64_tr_b16 v[152:153], v16 offset:49152
    v_mfma_f32_16x16x32_bf16 v[136:139], a[140:143], v[168:171], v[136:139]
    ds_read_b64_tr_b16 v[154:155], v16 offset:51200
    s_waitcnt lgkmcnt(6)
    v_mfma_f32_16x16x32_bf16 v[108:111], a[132:135], v[172:175], v[108:111]
    buffer_load_dwordx4 a[84:87], v5, s[20:23], s11 offen offset:1024 sc1
    v_mfma_f32_16x16x32_bf16 v[124:127], a[136:139], v[172:175], v[124:127]
    ds_read_b64_tr_b16 v[156:157], v17 offset:49152
    v_mfma_f32_16x16x32_bf16 v[140:143], a[140:143], v[172:175], v[140:143]
    ds_read_b64_tr_b16 v[158:159], v17 offset:51200
    s_waitcnt lgkmcnt(6)
    v_mfma_f32_16x16x32_bf16 v[112:115], a[132:135], v[176:179], v[112:115]
    v_mfma_f32_16x16x32_bf16 v[128:131], a[136:139], v[176:179], v[128:131]
    ds_read_b64_tr_b16 v[160:161], v18 offset:49152
    v_mfma_f32_16x16x32_bf16 v[144:147], a[140:143], v[176:179], v[144:147]
    ds_read_b64_tr_b16 v[162:163], v18 offset:51200
    buffer_load_dwordx4 a[88:91], v5, s[20:23], s11 offen offset:2048 sc1
    s_waitcnt lgkmcnt(6)
    v_mfma_f32_16x16x32_bf16 v[100:103], a[144:147], v[148:151], v[100:103]
    v_mfma_f32_16x16x32_bf16 v[116:119], a[148:151], v[148:151], v[116:119]
    ds_read_b64_tr_b16 v[164:165], v15 offset:53248
    v_mfma_f32_16x16x32_bf16 v[132:135], a[152:155], v[148:151], v[132:135]
    ds_read_b64_tr_b16 v[166:167], v15 offset:55296
    s_waitcnt lgkmcnt(6)
    v_mfma_f32_16x16x32_bf16 v[104:107], a[144:147], v[152:155], v[104:107]
    v_mfma_f32_16x16x32_bf16 v[120:123], a[148:151], v[152:155], v[120:123]
    ds_read_b64_tr_b16 v[168:169], v16 offset:53248
    buffer_load_dwordx4 a[92:95], v5, s[20:23], s11 offen offset:3072 sc1
    v_mfma_f32_16x16x32_bf16 v[136:139], a[152:155], v[152:155], v[136:139]
    ds_read_b64_tr_b16 v[170:171], v16 offset:55296
    s_waitcnt lgkmcnt(6)
    v_mfma_f32_16x16x32_bf16 v[108:111], a[144:147], v[156:159], v[108:111]
    v_mfma_f32_16x16x32_bf16 v[124:127], a[148:151], v[156:159], v[124:127]
    ds_read_b64_tr_b16 v[172:173], v17 offset:53248
    v_mfma_f32_16x16x32_bf16 v[140:143], a[152:155], v[156:159], v[140:143]
    ds_read_b64_tr_b16 v[174:175], v17 offset:55296
    s_waitcnt lgkmcnt(6)
    v_mfma_f32_16x16x32_bf16 v[112:115], a[144:147], v[160:163], v[112:115]
    s_add_u32 s11, s43, 40960
    buffer_load_dwordx4 a[96:99], v5, s[20:23], s11 offen offset:0 sc1
    v_mfma_f32_16x16x32_bf16 v[128:131], a[148:151], v[160:163], v[128:131]
    ds_read_b64_tr_b16 v[176:177], v18 offset:53248
    v_mfma_f32_16x16x32_bf16 v[144:147], a[152:155], v[160:163], v[144:147]
    ds_read_b64_tr_b16 v[178:179], v18 offset:55296
    s_waitcnt lgkmcnt(6)
    v_mfma_f32_16x16x32_bf16 v[100:103], a[156:159], v[164:167], v[100:103]
    v_mfma_f32_16x16x32_bf16 v[116:119], a[160:163], v[164:167], v[116:119]
    ds_read_b64_tr_b16 v[148:149], v15 offset:57344
    v_mfma_f32_16x16x32_bf16 v[132:135], a[164:167], v[164:167], v[132:135]
    ds_read_b64_tr_b16 v[150:151], v15 offset:59392
    buffer_load_dwordx4 a[100:103], v5, s[20:23], s11 offen offset:1024 sc1
    s_waitcnt lgkmcnt(6)
    v_mfma_f32_16x16x32_bf16 v[104:107], a[156:159], v[168:171], v[104:107]
    v_mfma_f32_16x16x32_bf16 v[120:123], a[160:163], v[168:171], v[120:123]
    ds_read_b64_tr_b16 v[152:153], v16 offset:57344
    v_mfma_f32_16x16x32_bf16 v[136:139], a[164:167], v[168:171], v[136:139]
    ds_read_b64_tr_b16 v[154:155], v16 offset:59392
    s_waitcnt lgkmcnt(6)
    v_mfma_f32_16x16x32_bf16 v[108:111], a[156:159], v[172:175], v[108:111]
    v_mfma_f32_16x16x32_bf16 v[124:127], a[160:163], v[172:175], v[124:127]
    ds_read_b64_tr_b16 v[156:157], v17 offset:57344
    buffer_load_dwordx4 a[104:107], v5, s[20:23], s11 offen offset:2048 sc1
    v_mfma_f32_16x16x32_bf16 v[140:143], a[164:167], v[172:175], v[140:143]
    ds_read_b64_tr_b16 v[158:159], v17 offset:59392
    s_waitcnt lgkmcnt(6)
    v_mfma_f32_16x16x32_bf16 v[112:115], a[156:159], v[176:179], v[112:115]
    v_mfma_f32_16x16x32_bf16 v[128:131], a[160:163], v[176:179], v[128:131]
    ds_read_b64_tr_b16 v[160:161], v18 offset:57344
    v_mfma_f32_16x16x32_bf16 v[144:147], a[164:167], v[176:179], v[144:147]
    ds_read_b64_tr_b16 v[162:163], v18 offset:59392
    s_waitcnt lgkmcnt(6)
    v_mfma_f32_16x16x32_bf16 v[100:103], a[168:171], v[148:151], v[100:103]
    buffer_load_dwordx4 a[108:111], v5, s[20:23], s11 offen offset:3072 sc1
    v_mfma_f32_16x16x32_bf16 v[116:119], a[172:175], v[148:151], v[116:119]
    ds_read_b64_tr_b16 v[164:165], v15 offset:61440
    v_mfma_f32_16x16x32_bf16 v[132:135], a[176:179], v[148:151], v[132:135]
    ds_read_b64_tr_b16 v[166:167], v15 offset:63488
    s_waitcnt lgkmcnt(6)
    v_mfma_f32_16x16x32_bf16 v[104:107], a[168:171], v[152:155], v[104:107]
    v_mfma_f32_16x16x32_bf16 v[120:123], a[172:175], v[152:155], v[120:123]
    ds_read_b64_tr_b16 v[168:169], v16 offset:61440
    v_mfma_f32_16x16x32_bf16 v[136:139], a[176:179], v[152:155], v[136:139]
    ds_read_b64_tr_b16 v[170:171], v16 offset:63488
    s_waitcnt lgkmcnt(6)
    v_mfma_f32_16x16x32_bf16 v[108:111], a[168:171], v[156:159], v[108:111]
    v_mfma_f32_16x16x32_bf16 v[124:127], a[172:175], v[156:159], v[124:127]
    ds_read_b64_tr_b16 v[172:173], v17 offset:61440
    v_mfma_f32_16x16x32_bf16 v[140:143], a[176:179], v[156:159], v[140:143]
    ds_read_b64_tr_b16 v[174:175], v17 offset:63488
    s_waitcnt lgkmcnt(6)
    v_mfma_f32_16x16x32_bf16 v[112:115], a[168:171], v[160:163], v[112:115]
    v_mfma_f32_16x16x32_bf16 v[128:131], a[172:175], v[160:163], v[128:131]
    ds_read_b64_tr_b16 v[176:177], v18 offset:61440
    v_mfma_f32_16x16x32_bf16 v[144:147], a[176:179], v[160:163], v[144:147]
    ds_read_b64_tr_b16 v[178:179], v18 offset:63488
    s_waitcnt lgkmcnt(6)
    v_mfma_f32_16x16x32_bf16 v[100:103], a[180:183], v[164:167], v[100:103]
    v_xor_b32 v15, 0x10000, v15
    s_mov_b32 s19, 33095680
    v_mfma_f32_16x16x32_bf16 v[116:119], a[184:187], v[164:167], v[116:119]
    buffer_load_dword v48, v28, s[20:23], s19 offen sc1
    v_mfma_f32_16x16x32_bf16 v[132:135], a[188:191], v[164:167], v[132:135]
    s_waitcnt lgkmcnt(4)
    v_mfma_f32_16x16x32_bf16 v[104:107], a[180:183], v[168:171], v[104:107]
    v_xor_b32 v16, 0x10000, v16
    v_mfma_f32_16x16x32_bf16 v[120:123], a[184:187], v[168:171], v[120:123]
    v_mfma_f32_16x16x32_bf16 v[136:139], a[188:191], v[168:171], v[136:139]
    s_waitcnt lgkmcnt(2)
    v_mfma_f32_16x16x32_bf16 v[108:111], a[180:183], v[172:175], v[108:111]
    v_xor_b32 v17, 0x10000, v17
    v_mfma_f32_16x16x32_bf16 v[124:127], a[184:187], v[172:175], v[124:127]
    v_mfma_f32_16x16x32_bf16 v[140:143], a[188:191], v[172:175], v[140:143]
    s_waitcnt lgkmcnt(0)
    v_mfma_f32_16x16x32_bf16 v[112:115], a[180:183], v[176:179], v[112:115]
    v_xor_b32 v18, 0x10000, v18
    v_mfma_f32_16x16x32_bf16 v[128:131], a[184:187], v[176:179], v[128:131]
    v_mfma_f32_16x16x32_bf16 v[144:147], a[188:191], v[176:179], v[144:147]
    s_barrier
    ds_read_b128 v[180:183], v19 offset:512
    ds_read_b128 v[192:195], v19 offset:768
    s_waitcnt lgkmcnt(1)
    v_mul_f32 v180, 0xbb000000, v180
    v_mul_f32 v181, 0xbb000000, v181
    v_mul_f32 v182, 0xbb000000, v182
    v_mul_f32 v183, 0xbb000000, v183
    s_waitcnt lgkmcnt(0)
    v_fma_f32 v192, v192, s49, v35
    v_fma_f32 v193, v193, s49, v35
    v_fma_f32 v194, v194, s49, v35
    v_fma_f32 v195, v195, s49, v35
    v_fma_f32 v192, -v180, v180, v192
    v_fma_f32 v193, -v181, v181, v193
    v_fma_f32 v194, -v182, v182, v194
    v_fma_f32 v195, -v183, v183, v195
    v_max_f32 v192, v35, v192
    v_max_f32 v193, v35, v193
    v_max_f32 v194, v35, v194
    v_max_f32 v195, v35, v195
    v_rsq_f32 v184, v192
    v_rsq_f32 v185, v193
    v_rsq_f32 v186, v194
    v_rsq_f32 v187, v195
    v_mul_f32 v188, v184, v184
    v_mul_f32 v189, v185, v185
    v_mul_f32 v190, v186, v186
    v_mul_f32 v191, v187, v187
    v_mul_f32 v188, v188, v184
    v_mul_f32 v189, v189, v185
    v_mul_f32 v190, v190, v186
    v_mul_f32 v191, v191, v187
    v_mul_f32 v184, 0xc0135761, v184
    v_mul_f32 v185, 0xc0135761, v185
    v_mul_f32 v186, 0xc0135761, v186
    v_mul_f32 v187, 0xc0135761, v187
    v_mul_f32 v188, 0xbdd2d3e8, v188
    v_mul_f32 v189, 0xbdd2d3e8, v189
    v_mul_f32 v190, 0xbdd2d3e8, v190
    v_mul_f32 v191, 0xbdd2d3e8, v191
    v_fmac_f32 v100, v36, v180
    v_fmac_f32 v101, v37, v180
    v_fmac_f32 v102, v38, v180
    v_fmac_f32 v103, v39, v180
    v_mul_f32 v196, v100, v100
    v_mul_f32 v197, v101, v101
    v_fma_f32 v196, v196, v188, v184
    v_fma_f32 v197, v197, v188, v184
    v_mul_f32 v196, v196, v100
    v_mul_f32 v197, v197, v101
    v_exp_f32 v196, v196
    v_exp_f32 v197, v197
    v_mul_f32 v100, v100, v102
    v_mul_f32 v101, v101, v103
    v_fma_f32 v196, v196, v192, v192
    v_fma_f32 v197, v197, v192, v192
    v_rcp_f32 v196, v196
    v_rcp_f32 v197, v197
    s_waitcnt vmcnt(0)
    v_cmp_gt_u32 vcc, s33, v48
    s_nop 1
    s_cbranch_vccz pok6
    s_mov_b32 s18, 40000
    s_mov_b32 s19, 33095680
psp6:
    s_sleep 2
    buffer_load_dword v48, v28, s[20:23], s19 offen sc1
    s_waitcnt vmcnt(0)
    v_cmp_gt_u32 vcc, s33, v48
    s_nop 1
    s_cbranch_vccz pok6
    s_sub_u32 s18, s18, 1
    s_cbranch_scc0 psp6
    s_endpgm
pok6:
    v_fmac_f32 v104, v36, v181
    v_fmac_f32 v105, v37, v181
    v_mul_f32 v100, v100, v196
    v_mul_f32 v101, v101, v197
    v_cvt_pk_bf16_f32 v200, v100, v101
    v_fmac_f32 v106, v38, v181
    s_add_u32 s14, s42, 0
    buffer_load_dwordx4 v[52:55], v21, s[20:23], s14 offen offset:0 sc1
    v_fmac_f32 v107, v39, v181
    v_mul_f32 v198, v104, v104
    v_mul_f32 v199, v105, v105
    v_fma_f32 v198, v198, v189, v185
    v_fma_f32 v199, v199, v189, v185
    v_mul_f32 v198, v198, v104
    buffer_load_dwordx4 v[56:59], v21, s[20:23], s14 offen offset:256 sc1
    v_mul_f32 v199, v199, v105
    v_exp_f32 v198, v198
    v_exp_f32 v199, v199
    v_mul_f32 v104, v104, v106
    v_mul_f32 v105, v105, v107
    v_fma_f32 v198, v198, v193, v193
    s_add_u32 s14, s42, 131072
    buffer_load_dwordx4 v[60:63], v21, s[20:23], s14 offen offset:0 sc1
    v_fma_f32 v199, v199, v193, v193
    v_rcp_f32 v198, v198
    v_rcp_f32 v199, v199
    v_fmac_f32 v108, v36, v182
    v_fmac_f32 v109, v37, v182
    v_mul_f32 v104, v104, v198
    buffer_load_dwordx4 v[64:67], v21, s[20:23], s14 offen offset:256 sc1
    v_mul_f32 v105, v105, v199
    v_cvt_pk_bf16_f32 v201, v104, v105
    v_fmac_f32 v110, v38, v182
    v_fmac_f32 v111, v39, v182
    v_mul_f32 v196, v108, v108
    v_mul_f32 v197, v109, v109
    s_add_u32 s14, s42, 262144
    buffer_load_dwordx4 v[68:71], v21, s[20:23], s14 offen offset:0 sc1
    v_fma_f32 v196, v196, v190, v186
    v_fma_f32 v197, v197, v190, v186
    v_mul_f32 v196, v196, v108
    v_mul_f32 v197, v197, v109
    v_exp_f32 v196, v196
    v_exp_f32 v197, v197
    buffer_load_dwordx4 v[72:75], v21, s[20:23], s14 offen offset:256 sc1
    v_mul_f32 v108, v108, v110
    v_mul_f32 v109, v109, v111
    v_fma_f32 v196, v196, v194, v194
    v_fma_f32 v197, v197, v194, v194
    v_rcp_f32 v196, v196
    v_rcp_f32 v197, v197
    s_add_u32 s14, s42, 393216
    buffer_load_dwordx4 v[76:79], v21, s[20:23], s14 offen offset:0 sc1
    v_fmac_f32 v112, v36, v183
    v_fmac_f32 v113, v37, v183
    v_mul_f32 v108, v108, v196
    v_mul_f32 v109, v109, v197
    v_cvt_pk_bf16_f32 v202, v108, v109
    v_fmac_f32 v114, v38, v183
    buffer_load_dwordx4 v[80:83], v21, s[20:23], s14 offen offset:256 sc1
    v_fmac_f32 v115, v39, v183
    v_mul_f32 v198, v112, v112
    v_mul_f32 v199, v113, v113
    v_fma_f32 v198, v198, v191, v187
    v_fma_f32 v199, v199, v191, v187
    v_mul_f32 v198, v198, v112
    s_add_u32 s14, s42, 524288
    buffer_load_dwordx4 v[84:87], v21, s[20:23], s14 offen offset:0 sc1
    v_mul_f32 v199, v199, v113
    v_exp_f32 v198, v198
    v_exp_f32 v199, v199
    v_mul_f32 v112, v112, v114
    v_mul_f32 v113, v113, v115
    v_fma_f32 v198, v198, v195, v195
    buffer_load_dwordx4 v[88:91], v21, s[20:23], s14 offen offset:256 sc1
    v_fma_f32 v199, v199, v195, v195
    v_rcp_f32 v198, v198
    v_rcp_f32 v199, v199
    v_mul_f32 v112, v112, v198
    v_mul_f32 v113, v113, v199
    v_cvt_pk_bf16_f32 v203, v112, v113
    s_add_u32 s14, s42, 655360
    buffer_load_dwordx4 v[92:95], v21, s[20:23], s14 offen offset:0 sc1
    v_fmac_f32 v116, v40, v180
    v_fmac_f32 v117, v41, v180
    v_fmac_f32 v118, v42, v180
    v_fmac_f32 v119, v43, v180
    v_mul_f32 v196, v116, v116
    v_mul_f32 v197, v117, v117
    buffer_load_dwordx4 v[96:99], v21, s[20:23], s14 offen offset:256 sc1
    v_fma_f32 v196, v196, v188, v184
    v_fma_f32 v197, v197, v188, v184
    v_mul_f32 v196, v196, v116
    v_mul_f32 v197, v197, v117
    v_exp_f32 v196, v196
    v_exp_f32 v197, v197
    s_add_u32 s14, s42, 786432
    buffer_load_dwordx4 v[148:151], v21, s[20:23], s14 offen offset:0 sc1
    v_mul_f32 v116, v116, v118
    v_mul_f32 v117, v117, v119
    v_fma_f32 v196, v196, v192, v192
    v_fma_f32 v197, v197, v192, v192
    v_rcp_f32 v196, v196
    v_rcp_f32 v197, v197
    buffer_load_dwordx4 v[152:155], v21, s[20:23], s14 offen offset:256 sc1
    v_fmac_f32 v120, v40, v181
    v_fmac_f32 v121, v41, v181
    v_mul_f32 v116, v116, v196
    v_mul_f32 v117, v117, v197
    v_cvt_pk_bf16_f32 v204, v116, v117
    v_fmac_f32 v122, v42, v181
    s_add_u32 s14, s42, 917504
    buffer_load_dwordx4 v[156:159], v21, s[20:23], s14 offen offset:0 sc1
    v_fmac_f32 v123, v43, v181
    v_mul_f32 v198, v120, v120
    v_mul_f32 v199, v121, v121
    v_fma_f32 v198, v198, v189, v185
    v_fma_f32 v199, v199, v189, v185
    v_mul_f32 v198, v198, v120
    buffer_load_dwordx4 v[160:163], v21, s[20:23], s14 offen offset:256 sc1
    v_mul_f32 v199, v199, v121
    v_exp_f32 v198, v198
    v_exp_f32 v199, v199
    v_mul_f32 v120, v120, v122
    v_mul_f32 v121, v121, v123
    v_fma_f32 v198, v198, v193, v193
    s_add_u32 s14, s42, 1048576
    buffer_load_dwordx4 v[164:167], v21, s[20:23], s14 offen offset:0 sc1
    v_fma_f32 v199, v199, v193, v193
    v_rcp_f32 v198, v198
    v_rcp_f32 v199, v199
    v_fmac_f32 v124, v40, v182
    v_fmac_f32 v125, v41, v182
    v_mul_f32 v120, v120, v198
    buffer_load_dwordx4 v[168:171], v21, s[20:23], s14 offen offset:256 sc1
    v_mul_f32 v121, v121, v199
    v_cvt_pk_bf16_f32 v205, v120, v121
    v_fmac_f32 v126, v42, v182
    v_fmac_f32 v127, v43, v182
    v_mul_f32 v196, v124, v124
    v_mul_f32 v197, v125, v125
    s_add_u32 s14, s42, 1179648
    buffer_load_dwordx4 v[172:175], v21, s[20:23], s14 offen offset:0 sc1
    v_fma_f32 v196, v196, v190, v186
    v_fma_f32 v197, v197, v190, v186
    v_mul_f32 v196, v196, v124
    v_mul_f32 v197, v197, v125
    v_exp_f32 v196, v196
    v_exp_f32 v197, v197
    buffer_load_dwordx4 v[176:179], v21, s[20:23], s14 offen offset:256 sc1
    v_mul_f32 v124, v124, v126
    v_mul_f32 v125, v125, v127
    v_fma_f32 v196, v196, v194, v194
    v_fma_f32 v197, v197, v194, v194
    v_rcp_f32 v196, v196
    v_rcp_f32 v197, v197
    s_add_u32 s14, s42, 1310720
    buffer_load_dwordx4 v[232:235], v21, s[20:23], s14 offen offset:0 sc1
    v_fmac_f32 v128, v40, v183
    v_fmac_f32 v129, v41, v183
    v_mul_f32 v124, v124, v196
    v_mul_f32 v125, v125, v197
    v_cvt_pk_bf16_f32 v206, v124, v125
    v_fmac_f32 v130, v42, v183
    buffer_load_dwordx4 v[236:239], v21, s[20:23], s14 offen offset:256 sc1
    v_fmac_f32 v131, v43, v183
    v_mul_f32 v198, v128, v128
    v_mul_f32 v199, v129, v129
    v_fma_f32 v198, v198, v191, v187
    v_fma_f32 v199, v199, v191, v187
    v_mul_f32 v198, v198, v128
    buffer_load_dwordx4 v[240:243], v23, s[20:23], s44 offen offset:0 sc1
    v_mul_f32 v199, v199, v129
    v_exp_f32 v198, v198
    v_exp_f32 v199, v199
    v_mul_f32 v128, v128, v130
    v_mul_f32 v129, v129, v131
    v_fma_f32 v198, v198, v195, v195
    v_fma_f32 v199, v199, v195, v195
    v_rcp_f32 v198, v198
    v_rcp_f32 v199, v199
    v_mul_f32 v128, v128, v198
    v_mul_f32 v129, v129, v199
    v_cvt_pk_bf16_f32 v207, v128, v129
    v_permlane32_swap_b32 v200, v202
    v_permlane32_swap_b32 v201, v203
    s_add_u32 s13, s41, 16384
    s_nop 0
    v_permlane16_swap_b32 v200, v201
    v_permlane16_swap_b32 v202, v203
    buffer_store_dwordx4 v[200:203], v20, s[20:23], s13 offen sc1
    v_permlane32_swap_b32 v204, v206
    v_permlane32_swap_b32 v205, v207
    s_add_u32 s13, s41, 49152
    s_nop 0
    v_permlane16_swap_b32 v204, v205
    v_permlane16_swap_b32 v206, v207
    buffer_store_dwordx4 v[204:207], v20, s[20:23], s13 offen sc1
    s_waitcnt vmcnt(24)
    v_mfma_f32_16x16x32_bf16 v[100:103], v[52:55], a[192:195], 0
    v_fmac_f32 v132, v44, v180
    v_fmac_f32 v133, v45, v180
    v_fmac_f32 v134, v46, v180
    v_mfma_f32_16x16x32_bf16 v[104:107], v[52:55], a[196:199], 0
    v_fmac_f32 v135, v47, v180
    v_mul_f32 v196, v132, v132
    v_mul_f32 v197, v133, v133
    v_mfma_f32_16x16x32_bf16 v[108:111], v[52:55], a[200:203], 0
    v_fma_f32 v196, v196, v188, v184
    v_fma_f32 v197, v197, v188, v184
    v_mul_f32 v196, v196, v132
    v_mfma_f32_16x16x32_bf16 v[112:115], v[52:55], a[204:207], 0
    v_mul_f32 v197, v197, v133
    v_exp_f32 v196, v196
    v_exp_f32 v197, v197
    s_waitcnt vmcnt(23)
    v_mfma_f32_16x16x32_bf16 v[116:119], v[56:59], a[192:195], 0
    v_mul_f32 v132, v132, v134
    v_mul_f32 v133, v133, v135
    v_fma_f32 v196, v196, v192, v192
    v_mfma_f32_16x16x32_bf16 v[120:123], v[56:59], a[196:199], 0
    v_fma_f32 v197, v197, v192, v192
    v_rcp_f32 v196, v196
    v_rcp_f32 v197, v197
    v_mfma_f32_16x16x32_bf16 v[124:127], v[56:59], a[200:203], 0
    v_fmac_f32 v136, v44, v181
    v_fmac_f32 v137, v45, v181
    v_mul_f32 v132, v132, v196
    v_mfma_f32_16x16x32_bf16 v[128:131], v[56:59], a[204:207], 0
    v_mul_f32 v133, v133, v197
    v_cvt_pk_bf16_f32 v208, v132, v133
    v_fmac_f32 v138, v46, v181
    s_waitcnt vmcnt(22)
    v_mfma_f32_16x16x32_bf16 v[100:103], v[60:63], a[208:211], v[100:103]
    v_fmac_f32 v139, v47, v181
    v_mul_f32 v198, v136, v136
    v_mul_f32 v199, v137, v137
    v_mfma_f32_16x16x32_bf16 v[104:107], v[60:63], a[212:215], v[104:107]
    v_fma_f32 v198, v198, v189, v185
    v_fma_f32 v199, v199, v189, v185
    v_mul_f32 v198, v198, v136
    v_mfma_f32_16x16x32_bf16 v[108:111], v[60:63], a[216:219], v[108:111]
    v_mul_f32 v199, v199, v137
    v_exp_f32 v198, v198
    v_exp_f32 v199, v199
    v_mfma_f32_16x16x32_bf16 v[112:115], v[60:63], a[220:223], v[112:115]
    v_mul_f32 v136, v136, v138
    v_mul_f32 v137, v137, v139
    v_fma_f32 v198, v198, v193, v193
    s_waitcnt vmcnt(21)
    v_mfma_f32_16x16x32_bf16 v[116:119], v[64:67], a[208:211], v[116:119]
    v_fma_f32 v199, v199, v193, v193
    v_rcp_f32 v198, v198
    v_rcp_f32 v199, v199
    v_mfma_f32_16x16x32_bf16 v[120:123], v[64:67], a[212:215], v[120:123]
    v_fmac_f32 v140, v44, v182
    v_fmac_f32 v141, v45, v182
    v_mul_f32 v136, v136, v198
    v_mfma_f32_16x16x32_bf16 v[124:127], v[64:67], a[216:219], v[124:127]
    v_mul_f32 v137, v137, v199
    v_cvt_pk_bf16_f32 v209, v136, v137
    v_fmac_f32 v142, v46, v182
    v_mfma_f32_16x16x32_bf16 v[128:131], v[64:67], a[220:223], v[128:131]
    v_fmac_f32 v143, v47, v182
    v_mul_f32 v196, v140, v140
    v_mul_f32 v197, v141, v141
    s_waitcnt vmcnt(20)
    v_mfma_f32_16x16x32_bf16 v[100:103], v[68:71], a[224:227], v[100:103]
    v_fma_f32 v196, v196, v190, v186
    v_fma_f32 v197, v197, v190, v186
    v_mul_f32 v196, v196, v140
    v_mfma_f32_16x16x32_bf16 v[104:107], v[68:71], a[228:231], v[104:107]
    v_mul_f32 v197, v197, v141
    v_exp_f32 v196, v196
    v_exp_f32 v197, v197
    v_mfma_f32_16x16x32_bf16 v[108:111], v[68:71], a[232:235], v[108:111]
    v_mul_f32 v140, v140, v142
    v_mul_f32 v141, v141, v143
    v_fma_f32 v196, v196, v194, v194
    v_mfma_f32_16x16x32_bf16 v[112:115], v[68:71], a[236:239], v[112:115]
    v_fma_f32 v197, v197, v194, v194
    v_rcp_f32 v196, v196
    v_rcp_f32 v197, v197
    s_waitcnt vmcnt(19)
    v_mfma_f32_16x16x32_bf16 v[116:119], v[72:75], a[224:227], v[116:119]
    v_fmac_f32 v144, v44, v183
    v_fmac_f32 v145, v45, v183
    v_mul_f32 v140, v140, v196
    v_mfma_f32_16x16x32_bf16 v[120:123], v[72:75], a[228:231], v[120:123]
    v_mul_f32 v141, v141, v197
    v_cvt_pk_bf16_f32 v210, v140, v141
    v_fmac_f32 v146, v46, v183
    v_mfma_f32_16x16x32_bf16 v[124:127], v[72:75], a[232:235], v[124:127]
    v_fmac_f32 v147, v47, v183
    v_mul_f32 v198, v144, v144
    v_mul_f32 v199, v145, v145
    v_mfma_f32_16x16x32_bf16 v[128:131], v[72:75], a[236:239], v[128:131]
    v_fma_f32 v198, v198, v191, v187
    v_fma_f32 v199, v199, v191, v187
    v_mul_f32 v198, v198, v144
    s_waitcnt vmcnt(18)
    v_mfma_f32_16x16x32_bf16 v[100:103], v[76:79], a[240:243], v[100:103]
    v_mul_f32 v199, v199, v145
    v_exp_f32 v198, v198
    v_exp_f32 v199, v199
    v_mfma_f32_16x16x32_bf16 v[104:107], v[76:79], a[244:247], v[104:107]
    v_mul_f32 v144, v144, v146
    v_mul_f32 v145, v145, v147
    v_fma_f32 v198, v198, v195, v195
    v_mfma_f32_16x16x32_bf16 v[108:111], v[76:79], a[248:251], v[108:111]
    v_fma_f32 v199, v199, v195, v195
    v_rcp_f32 v198, v198
    v_rcp_f32 v199, v199
    v_mfma_f32_16x16x32_bf16 v[112:115], v[76:79], a[252:255], v[112:115]
    v_mul_f32 v144, v144, v198
    v_mul_f32 v145, v145, v199
    v_cvt_pk_bf16_f32 v211, v144, v145
    s_waitcnt vmcnt(17)
    v_mfma_f32_16x16x32_bf16 v[116:119], v[80:83], a[240:243], v[116:119]
    v_permlane32_swap_b32 v208, v210
    v_permlane32_swap_b32 v209, v211
    s_add_u32 s13, s41, 81920
    v_mfma_f32_16x16x32_bf16 v[120:123], v[80:83], a[244:247], v[120:123]
    v_permlane16_swap_b32 v208, v209
    v_permlane16_swap_b32 v210, v211
    v_mfma_f32_16x16x32_bf16 v[124:127], v[80:83], a[248:251], v[124:127]
    v_mfma_f32_16x16x32_bf16 v[128:131], v[80:83], a[252:255], v[128:131]
    buffer_store_dwordx4 v[208:211], v20, s[20:23], s13 offen sc1
    s_nop 5
    s_branch g1j
g1w3:
    s_waitcnt vmcnt(15)
    s_barrier
    ds_read_b64_tr_b16 v[148:149], v15 offset:0
    ds_read_b64_tr_b16 v[150:151], v15 offset:2048
    ds_read_b64_tr_b16 v[152:153], v16 offset:0
    ds_read_b64_tr_b16 v[154:155], v16 offset:2048
    ds_read_b64_tr_b16 v[156:157], v17 offset:0
    ds_read_b64_tr_b16 v[158:159], v17 offset:2048
    ds_read_b64_tr_b16 v[160:161], v18 offset:0
    ds_read_b64_tr_b16 v[162:163], v18 offset:2048
    s_waitcnt lgkmcnt(6)
    v_mfma_f32_16x16x32_bf16 v[52:55], a[0:3], v[148:151], 0
    v_mfma_f32_16x16x32_bf16 v[68:71], a[4:7], v[148:151], 0
    ds_read_b64_tr_b16 v[164:165], v15 offset:4096
    v_mfma_f32_16x16x32_bf16 v[84:87], v[148:151], v[148:151], 0
    ds_read_b64_tr_b16 v[166:167], v15 offset:6144
    s_waitcnt lgkmcnt(6)
    v_mfma_f32_16x16x32_bf16 v[56:59], a[0:3], v[152:155], 0
    v_mfma_f32_16x16x32_bf16 v[72:75], a[4:7], v[152:155], 0
    ds_read_b64_tr_b16 v[168:169], v16 offset:4096
    v_mfma_f32_16x16x32_bf16 v[88:91], v[152:155], v[152:155], 0
    ds_read_b64_tr_b16 v[170:171], v16 offset:6144
    s_waitcnt lgkmcnt(6)
    v_mfma_f32_16x16x32_bf16 v[60:63], a[0:3], v[156:159], 0
    v_mfma_f32_16x16x32_bf16 v[76:79], a[4:7], v[156:159], 0
    ds_read_b64_tr_b16 v[172:173], v17 offset:4096
    v_mfma_f32_16x16x32_bf16 v[92:95], v[156:159], v[156:159], 0
    ds_read_b64_tr_b16 v[174:175], v17 offset:6144
    s_waitcnt lgkmcnt(6)
    v_mfma_f32_16x16x32_bf16 v[64:67], a[0:3], v[160:163], 0
    v_mfma_f32_16x16x32_bf16 v[80:83], a[4:7], v[160:163], 0
    ds_read_b64_tr_b16 v[176:177], v18 offset:4096
    v_mfma_f32_16x16x32_bf16 v[96:99], v[160:163], v[160:163], 0
    ds_read_b64_tr_b16 v[178:179], v18 offset:6144
    s_waitcnt vmcnt(11)
    s_barrier
    s_waitcnt lgkmcnt(6)
    v_mfma_f32_16x16x32_bf16 v[52:55], a[12:15], v[164:167], v[52:55]
    s_add_u32 s11, s43, 0
    buffer_load_dwordx4 a[192:195], v5, s[20:23], s11 offen offset:0 sc1
    v_mfma_f32_16x16x32_bf16 v[68:71], a[16:19], v[164:167], v[68:71]
    ds_read_b64_tr_b16 v[148:149], v15 offset:8192
    v_mfma_f32_16x16x32_bf16 v[84:87], v[164:167], v[164:167], v[84:87]
    ds_read_b64_tr_b16 v[150:151], v15 offset:10240
    s_waitcnt lgkmcnt(6)
    v_mfma_f32_16x16x32_bf16 v[56:59], a[12:15], v[168:171], v[56:59]
    v_mfma_f32_16x16x32_bf16 v[72:75], a[16:19], v[168:171], v[72:75]
    ds_read_b64_tr_b16 v[152:153], v16 offset:8192
    buffer_load_dwordx4 a[196:199], v5, s[20:23], s11 offen offset:1024 sc1
    v_mfma_f32_16x16x32_bf16 v[88:91], v[168:171], v[168:171], v[88:91]
    ds_read_b64_tr_b16 v[154:155], v16 offset:10240
    s_waitcnt lgkmcnt(6)
    v_mfma_f32_16x16x32_bf16 v[60:63], a[12:15], v[172:175], v[60:63]
    v_mfma_f32_16x16x32_bf16 v[76:79], a[16:19], v[172:175], v[76:79]
    ds_read_b64_tr_b16 v[156:157], v17 offset:8192
    v_mfma_f32_16x16x32_bf16 v[92:95], v[172:175], v[172:175], v[92:95]
    ds_read_b64_tr_b16 v[158:159], v17 offset:10240
    buffer_load_dwordx4 a[200:203], v5, s[20:23], s11 offen offset:2048 sc1
    s_waitcnt lgkmcnt(6)
    v_mfma_f32_16x16x32_bf16 v[64:67], a[12:15], v[176:179], v[64:67]
    v_mfma_f32_16x16x32_bf16 v[80:83], a[16:19], v[176:179], v[80:83]
    ds_read_b64_tr_b16 v[160:161], v18 offset:8192
    v_mfma_f32_16x16x32_bf16 v[96:99], v[176:179], v[176:179], v[96:99]
    ds_read_b64_tr_b16 v[162:163], v18 offset:10240
    s_waitcnt lgkmcnt(6)
    v_mfma_f32_16x16x32_bf16 v[52:55], a[24:27], v[148:151], v[52:55]
    v_mfma_f32_16x16x32_bf16 v[68:71], a[28:31], v[148:151], v[68:71]
    ds_read_b64_tr_b16 v[164:165], v15 offset:12288
    s_add_u32 s19, s46, 33062912
    v_mfma_f32_16x16x32_bf16 v[84:87], v[148:151], v[148:151], v[84:87]
    ds_read_b64_tr_b16 v[166:167], v15 offset:14336
    s_waitcnt vmcnt(3)
    s_barrier
    s_waitcnt lgkmcnt(6)
    v_mfma_f32_16x16x32_bf16 v[56:59], a[24:27], v[152:155], v[56:59]
    buffer_store_dword v32, v30, s[20:23], s19 offen sc1
    v_mfma_f32_16x16x32_bf16 v[72:75], a[28:31], v[152:155], v[72:75]
    ds_read_b64_tr_b16 v[168:169], v16 offset:12288
    v_mfma_f32_16x16x32_bf16 v[88:91], v[152:155], v[152:155], v[88:91]
    ds_read_b64_tr_b16 v[170:171], v16 offset:14336
    s_waitcnt lgkmcnt(6)
    v_mfma_f32_16x16x32_bf16 v[60:63], a[24:27], v[156:159], v[60:63]
    v_mfma_f32_16x16x32_bf16 v[76:79], a[28:31], v[156:159], v[76:79]
    ds_read_b64_tr_b16 v[172:173], v17 offset:12288
    v_mfma_f32_16x16x32_bf16 v[92:95], v[156:159], v[156:159], v[92:95]
    ds_read_b64_tr_b16 v[174:175], v17 offset:14336
    buffer_load_dwordx4 a[204:207], v5, s[20:23], s11 offen offset:3072 sc1
    s_waitcnt lgkmcnt(6)
    v_mfma_f32_16x16x32_bf16 v[64:67], a[24:27], v[160:163], v[64:67]
    v_mfma_f32_16x16x32_bf16 v[80:83], a[28:31], v[160:163], v[80:83]
    ds_read_b64_tr_b16 v[176:177], v18 offset:12288
    v_mfma_f32_16x16x32_bf16 v[96:99], v[160:163], v[160:163], v[96:99]
    ds_read_b64_tr_b16 v[178:179], v18 offset:14336
    s_waitcnt lgkmcnt(6)
    v_mfma_f32_16x16x32_bf16 v[52:55], a[36:39], v[164:167], v[52:55]
    s_add_u32 s11, s43, 4096
    buffer_load_dwordx4 a[208:211], v5, s[20:23], s11 offen offset:0 sc1
    v_mfma_f32_16x16x32_bf16 v[68:71], a[40:43], v[164:167], v[68:71]
    ds_read_b64_tr_b16 v[148:149], v15 offset:16384
    v_mfma_f32_16x16x32_bf16 v[84:87], v[164:167], v[164:167], v[84:87]
    ds_read_b64_tr_b16 v[150:151], v15 offset:18432
    s_waitcnt lgkmcnt(6)
    v_mfma_f32_16x16x32_bf16 v[56:59], a[36:39], v[168:171], v[56:59]
    v_mfma_f32_16x16x32_bf16 v[72:75], a[40:43], v[168:171], v[72:75]
    ds_read_b64_tr_b16 v[152:153], v16 offset:16384
    buffer_load_dwordx4 a[212:215], v5, s[20:23], s11 offen offset:1024 sc1
    v_mfma_f32_16x16x32_bf16 v[88:91], v[168:171], v[168:171], v[88:91]
    ds_read_b64_tr_b16 v[154:155], v16 offset:18432
    s_waitcnt lgkmcnt(6)
    v_mfma_f32_16x16x32_bf16 v[60:63], a[36:39], v[172:175], v[60:63]
    v_mfma_f32_16x16x32_bf16 v[76:79], a[40:43], v[172:175], v[76:79]
    ds_read_b64_tr_b16 v[156:157], v17 offset:16384
    v_mfma_f32_16x16x32_bf16 v[92:95], v[172:175], v[172:175], v[92:95]
    ds_read_b64_tr_b16 v[158:159], v17 offset:18432
    buffer_load_dwordx4 a[216:219], v5, s[20:23], s11 offen offset:2048 sc1
    s_waitcnt lgkmcnt(6)
    v_mfma_f32_16x16x32_bf16 v[64:67], a[36:39], v[176:179], v[64:67]
    v_mfma_f32_16x16x32_bf16 v[80:83], a[40:43], v[176:179], v[80:83]
    ds_read_b64_tr_b16 v[160:161], v18 offset:16384
    v_mfma_f32_16x16x32_bf16 v[96:99], v[176:179], v[176:179], v[96:99]
    ds_read_b64_tr_b16 v[162:163], v18 offset:18432
    s_waitcnt lgkmcnt(6)
    v_mfma_f32_16x16x32_bf16 v[52:55], a[48:51], v[148:151], v[52:55]
    buffer_load_dwordx4 a[220:223], v5, s[20:23], s11 offen offset:3072 sc1
    v_mfma_f32_16x16x32_bf16 v[68:71], a[52:55], v[148:151], v[68:71]
    ds_read_b64_tr_b16 v[164:165], v15 offset:20480
    v_mfma_f32_16x16x32_bf16 v[84:87], v[148:151], v[148:151], v[84:87]
    ds_read_b64_tr_b16 v[166:167], v15 offset:22528
    s_waitcnt lgkmcnt(6)
    v_mfma_f32_16x16x32_bf16 v[56:59], a[48:51], v[152:155], v[56:59]
    v_mfma_f32_16x16x32_bf16 v[72:75], a[52:55], v[152:155], v[72:75]
    ds_read_b64_tr_b16 v[168:169], v16 offset:20480
    s_add_u32 s11, s43, 8192
    buffer_load_dwordx4 a[224:227], v5, s[20:23], s11 offen offset:0 sc1
    v_mfma_f32_16x16x32_bf16 v[88:91], v[152:155], v[152:155], v[88:91]
    ds_read_b64_tr_b16 v[170:171], v16 offset:22528
    s_waitcnt lgkmcnt(6)
    v_mfma_f32_16x16x32_bf16 v[60:63], a[48:51], v[156:159], v[60:63]
    v_mfma_f32_16x16x32_bf16 v[76:79], a[52:55], v[156:159], v[76:79]
    ds_read_b64_tr_b16 v[172:173], v17 offset:20480
    v_mfma_f32_16x16x32_bf16 v[92:95], v[156:159], v[156:159], v[92:95]
    ds_read_b64_tr_b16 v[174:175], v17 offset:22528
    buffer_load_dwordx4 a[228:231], v5, s[20:23], s11 offen offset:1024 sc1
    s_waitcnt lgkmcnt(6)
    v_mfma_f32_16x16x32_bf16 v[64:67], a[48:51], v[160:163], v[64:67]
    v_mfma_f32_16x16x32_bf16 v[80:83], a[52:55], v[160:163], v[80:83]
    ds_read_b64_tr_b16 v[176:177], v18 offset:20480
    v_mfma_f32_16x16x32_bf16 v[96:99], v[160:163], v[160:163], v[96:99]
    ds_read_b64_tr_b16 v[178:179], v18 offset:22528
    s_barrier
    s_waitcnt lgkmcnt(6)
    v_mfma_f32_16x16x32_bf16 v[52:55], a[60:63], v[164:167], v[52:55]
    buffer_load_dwordx4 a[232:235], v5, s[20:23], s11 offen offset:2048 sc1
    v_mfma_f32_16x16x32_bf16 v[68:71], a[64:67], v[164:167], v[68:71]
    ds_read_b64_tr_b16 v[148:149], v15 offset:24576
    v_mfma_f32_16x16x32_bf16 v[84:87], v[164:167], v[164:167], v[84:87]
    ds_read_b64_tr_b16 v[150:151], v15 offset:26624
    s_waitcnt lgkmcnt(6)
    v_mfma_f32_16x16x32_bf16 v[56:59], a[60:63], v[168:171], v[56:59]
    v_mfma_f32_16x16x32_bf16 v[72:75], a[64:67], v[168:171], v[72:75]
    ds_read_b64_tr_b16 v[152:153], v16 offset:24576
    buffer_load_dwordx4 a[236:239], v5, s[20:23], s11 offen offset:3072 sc1
    v_mfma_f32_16x16x32_bf16 v[88:91], v[168:171], v[168:171], v[88:91]
    ds_read_b64_tr_b16 v[154:155], v16 offset:26624
    s_waitcnt lgkmcnt(6)
    v_mfma_f32_16x16x32_bf16 v[60:63], a[60:63], v[172:175], v[60:63]
    v_mfma_f32_16x16x32_bf16 v[76:79], a[64:67], v[172:175], v[76:79]
    ds_read_b64_tr_b16 v[156:157], v17 offset:24576
    v_mfma_f32_16x16x32_bf16 v[92:95], v[172:175], v[172:175], v[92:95]
    ds_read_b64_tr_b16 v[158:159], v17 offset:26624
    s_add_u32 s11, s43, 12288
    buffer_load_dwordx4 a[240:243], v5, s[20:23], s11 offen offset:0 sc1
    s_waitcnt lgkmcnt(6)
    v_mfma_f32_16x16x32_bf16 v[64:67], a[60:63], v[176:179], v[64:67]
    v_mfma_f32_16x16x32_bf16 v[80:83], a[64:67], v[176:179], v[80:83]
    ds_read_b64_tr_b16 v[160:161], v18 offset:24576
    v_mfma_f32_16x16x32_bf16 v[96:99], v[176:179], v[176:179], v[96:99]
    ds_read_b64_tr_b16 v[162:163], v18 offset:26624
    s_waitcnt lgkmcnt(6)
    v_mfma_f32_16x16x32_bf16 v[52:55], a[72:75], v[148:151], v[52:55]
    buffer_load_dwordx4 a[244:247], v5, s[20:23], s11 offen offset:1024 sc1
    v_mfma_f32_16x16x32_bf16 v[68:71], a[76:79], v[148:151], v[68:71]
    ds_read_b64_tr_b16 v[164:165], v15 offset:28672
    v_mfma_f32_16x16x32_bf16 v[84:87], v[148:151], v[148:151], v[84:87]
    ds_read_b64_tr_b16 v[166:167], v15 offset:30720
    s_waitcnt lgkmcnt(6)
    v_mfma_f32_16x16x32_bf16 v[56:59], a[72:75], v[152:155], v[56:59]
    v_mfma_f32_16x16x32_bf16 v[72:75], a[76:79], v[152:155], v[72:75]
    ds_read_b64_tr_b16 v[168:169], v16 offset:28672
    buffer_load_dwordx4 a[248:251], v5, s[20:23], s11 offen offset:2048 sc1
    v_mfma_f32_16x16x32_bf16 v[88:91], v[152:155], v[152:155], v[88:91]
    ds_read_b64_tr_b16 v[170:171], v16 offset:30720
    s_waitcnt lgkmcnt(6)
    v_mfma_f32_16x16x32_bf16 v[60:63], a[72:75], v[156:159], v[60:63]
    v_mfma_f32_16x16x32_bf16 v[76:79], a[76:79], v[156:159], v[76:79]
    ds_read_b64_tr_b16 v[172:173], v17 offset:28672
    v_mfma_f32_16x16x32_bf16 v[92:95], v[156:159], v[156:159], v[92:95]
    ds_read_b64_tr_b16 v[174:175], v17 offset:30720
    buffer_load_dwordx4 a[252:255], v5, s[20:23], s11 offen offset:3072 sc1
    s_waitcnt lgkmcnt(6)
    v_mfma_f32_16x16x32_bf16 v[64:67], a[72:75], v[160:163], v[64:67]
    v_mfma_f32_16x16x32_bf16 v[80:83], a[76:79], v[160:163], v[80:83]
    ds_read_b64_tr_b16 v[176:177], v18 offset:28672
    v_mfma_f32_16x16x32_bf16 v[96:99], v[160:163], v[160:163], v[96:99]
    ds_read_b64_tr_b16 v[178:179], v18 offset:30720
    s_waitcnt lgkmcnt(6)
    v_mfma_f32_16x16x32_bf16 v[52:55], a[84:87], v[164:167], v[52:55]
    v_mfma_f32_16x16x32_bf16 v[68:71], a[88:91], v[164:167], v[68:71]
    ds_read_b64_tr_b16 v[148:149], v15 offset:32768
    v_mfma_f32_16x16x32_bf16 v[84:87], v[164:167], v[164:167], v[84:87]
    ds_read_b64_tr_b16 v[150:151], v15 offset:34816
    s_waitcnt lgkmcnt(6)
    v_mfma_f32_16x16x32_bf16 v[56:59], a[84:87], v[168:171], v[56:59]
    v_mfma_f32_16x16x32_bf16 v[72:75], a[88:91], v[168:171], v[72:75]
    ds_read_b64_tr_b16 v[152:153], v16 offset:32768
    v_mfma_f32_16x16x32_bf16 v[88:91], v[168:171], v[168:171], v[88:91]
    ds_read_b64_tr_b16 v[154:155], v16 offset:34816
    s_waitcnt lgkmcnt(6)
    v_mfma_f32_16x16x32_bf16 v[60:63], a[84:87], v[172:175], v[60:63]
    v_mfma_f32_16x16x32_bf16 v[76:79], a[88:91], v[172:175], v[76:79]
    ds_read_b64_tr_b16 v[156:157], v17 offset:32768
    v_mfma_f32_16x16x32_bf16 v[92:95], v[172:175], v[172:175], v[92:95]
    ds_read_b64_tr_b16 v[158:159], v17 offset:34816
    s_waitcnt lgkmcnt(6)
    v_mfma_f32_16x16x32_bf16 v[64:67], a[84:87], v[176:179], v[64:67]
    v_mfma_f32_16x16x32_bf16 v[80:83], a[88:91], v[176:179], v[80:83]
    ds_read_b64_tr_b16 v[160:161], v18 offset:32768
    v_mfma_f32_16x16x32_bf16 v[96:99], v[176:179], v[176:179], v[96:99]
    ds_read_b64_tr_b16 v[162:163], v18 offset:34816
    s_waitcnt lgkmcnt(6)
    v_mfma_f32_16x16x32_bf16 v[52:55], a[96:99], v[148:151], v[52:55]
    s_mov_b32 s19, 33062912
    v_mfma_f32_16x16x32_bf16 v[68:71], a[100:103], v[148:151], v[68:71]
    ds_read_b64_tr_b16 v[164:165], v15 offset:36864
    buffer_load_dword v48, v29, s[20:23], s19 offen sc1
    v_mfma_f32_16x16x32_bf16 v[84:87], v[148:151], v[148:151], v[84:87]
    ds_read_b64_tr_b16 v[166:167], v15 offset:38912
    s_waitcnt lgkmcnt(6)
    v_mfma_f32_16x16x32_bf16 v[56:59], a[96:99], v[152:155], v[56:59]
    v_mfma_f32_16x16x32_bf16 v[72:75], a[100:103], v[152:155], v[72:75]
    ds_read_b64_tr_b16 v[168:169], v16 offset:36864
    v_mfma_f32_16x16x32_bf16 v[88:91], v[152:155], v[152:155], v[88:91]
    ds_read_b64_tr_b16 v[170:171], v16 offset:38912
    s_waitcnt lgkmcnt(6)
    v_mfma_f32_16x16x32_bf16 v[60:63], a[96:99], v[156:159], v[60:63]
    v_mfma_f32_16x16x32_bf16 v[76:79], a[100:103], v[156:159], v[76:79]
    ds_read_b64_tr_b16 v[172:173], v17 offset:36864
    v_mfma_f32_16x16x32_bf16 v[92:95], v[156:159], v[156:159], v[92:95]
    ds_read_b64_tr_b16 v[174:175], v17 offset:38912
    s_waitcnt lgkmcnt(6)
    v_mfma_f32_16x16x32_bf16 v[64:67], a[96:99], v[160:163], v[64:67]
    v_mfma_f32_16x16x32_bf16 v[80:83], a[100:103], v[160:163], v[80:83]
    ds_read_b64_tr_b16 v[176:177], v18 offset:36864
    v_mfma_f32_16x16x32_bf16 v[96:99], v[160:163], v[160:163], v[96:99]
    ds_read_b64_tr_b16 v[178:179], v18 offset:38912
    s_waitcnt lgkmcnt(6)
    v_mfma_f32_16x16x32_bf16 v[52:55], a[108:111], v[164:167], v[52:55]
    v_mfma_f32_16x16x32_bf16 v[68:71], a[112:115], v[164:167], v[68:71]
    ds_read_b64_tr_b16 v[148:149], v15 offset:40960
    v_mfma_f32_16x16x32_bf16 v[84:87], v[164:167], v[164:167], v[84:87]
    ds_read_b64_tr_b16 v[150:151], v15 offset:43008
    s_waitcnt lgkmcnt(6)
    v_mfma_f32_16x16x32_bf16 v[56:59], a[108:111], v[168:171], v[56:59]
    v_mfma_f32_16x16x32_bf16 v[72:75], a[112:115], v[168:171], v[72:75]
    ds_read_b64_tr_b16 v[152:153], v16 offset:40960
    v_mfma_f32_16x16x32_bf16 v[88:91], v[168:171], v[168:171], v[88:91]
    ds_read_b64_tr_b16 v[154:155], v16 offset:43008
    s_waitcnt lgkmcnt(6)
    v_mfma_f32_16x16x32_bf16 v[60:63], a[108:111], v[172:175], v[60:63]
    v_mfma_f32_16x16x32_bf16 v[76:79], a[112:115], v[172:175], v[76:79]
    ds_read_b64_tr_b16 v[156:157], v17 offset:40960
    v_mfma_f32_16x16x32_bf16 v[92:95], v[172:175], v[172:175], v[92:95]
    ds_read_b64_tr_b16 v[158:159], v17 offset:43008
    s_waitcnt lgkmcnt(6)
    v_mfma_f32_16x16x32_bf16 v[64:67], a[108:111], v[176:179], v[64:67]
    v_mfma_f32_16x16x32_bf16 v[80:83], a[112:115], v[176:179], v[80:83]
    ds_read_b64_tr_b16 v[160:161], v18 offset:40960
    v_mfma_f32_16x16x32_bf16 v[96:99], v[176:179], v[176:179], v[96:99]
    ds_read_b64_tr_b16 v[162:163], v18 offset:43008
    s_waitcnt lgkmcnt(6)
    v_mfma_f32_16x16x32_bf16 v[52:55], a[120:123], v[148:151], v[52:55]
    s_waitcnt vmcnt(0)
    v_cmp_gt_u32 vcc, s33, v48
    s_nop 1
    s_cbranch_vccz pok7
    s_mov_b32 s18, 40000
    s_mov_b32 s19, 33062912
psp7:
    s_sleep 2
    buffer_load_dword v48, v29, s[20:23], s19 offen sc1
    s_waitcnt vmcnt(0)
    v_cmp_gt_u32 vcc, s33, v48
    s_nop 1
    s_cbranch_vccz pok7
    s_sub_u32 s18, s18, 1
    s_cbranch_scc0 psp7
    s_endpgm
pok7:
    s_add_u32 m0, s39, 65536
    s_add_u32 s12, s38, 2048
    buffer_load_dwordx4 v14, s[20:23], s12 offen sc1 lds
    v_mfma_f32_16x16x32_bf16 v[68:71], a[124:127], v[148:151], v[68:71]
    ds_read_b64_tr_b16 v[164:165], v15 offset:45056
    v_mfma_f32_16x16x32_bf16 v[84:87], v[148:151], v[148:151], v[84:87]
    ds_read_b64_tr_b16 v[166:167], v15 offset:47104
    s_waitcnt lgkmcnt(6)
    v_mfma_f32_16x16x32_bf16 v[56:59], a[120:123], v[152:155], v[56:59]
    s_add_u32 m0, s39, 69632
    s_add_u32 s12, s38, 133120
    buffer_load_dwordx4 v14, s[20:23], s12 offen sc1 lds
    v_mfma_f32_16x16x32_bf16 v[72:75], a[124:127], v[152:155], v[72:75]
    ds_read_b64_tr_b16 v[168:169], v16 offset:45056
    v_mfma_f32_16x16x32_bf16 v[88:91], v[152:155], v[152:155], v[88:91]
    ds_read_b64_tr_b16 v[170:171], v16 offset:47104
    s_waitcnt lgkmcnt(6)
    v_mfma_f32_16x16x32_bf16 v[60:63], a[120:123], v[156:159], v[60:63]
    s_add_u32 m0, s39, 73728
    s_add_u32 s12, s38, 264192
    buffer_load_dwordx4 v14, s[20:23], s12 offen sc1 lds
    v_mfma_f32_16x16x32_bf16 v[76:79], a[124:127], v[156:159], v[76:79]
    ds_read_b64_tr_b16 v[172:173], v17 offset:45056
    v_mfma_f32_16x16x32_bf16 v[92:95], v[156:159], v[156:159], v[92:95]
    ds_read_b64_tr_b16 v[174:175], v17 offset:47104
    s_waitcnt lgkmcnt(6)
    v_mfma_f32_16x16x32_bf16 v[64:67], a[120:123], v[160:163], v[64:67]
    s_add_u32 m0, s39, 77824
    s_add_u32 s12, s38, 395264
    buffer_load_dwordx4 v14, s[20:23], s12 offen sc1 lds
    v_mfma_f32_16x16x32_bf16 v[80:83], a[124:127], v[160:163], v[80:83]
    ds_read_b64_tr_b16 v[176:177], v18 offset:45056
    v_mfma_f32_16x16x32_bf16 v[96:99], v[160:163], v[160:163], v[96:99]
    ds_read_b64_tr_b16 v[178:179], v18 offset:47104
    s_waitcnt lgkmcnt(6)
    v_mfma_f32_16x16x32_bf16 v[52:55], a[132:135], v[164:167], v[52:55]
    s_add_u32 m0, s39, 81920
    s_add_u32 s12, s38, 526336
    buffer_load_dwordx4 v14, s[20:23], s12 offen sc1 lds
    v_mfma_f32_16x16x32_bf16 v[68:71], a[136:139], v[164:167], v[68:71]
    ds_read_b64_tr_b16 v[148:149], v15 offset:49152
    v_mfma_f32_16x16x32_bf16 v[84:87], v[164:167], v[164:167], v[84:87]
    ds_read_b64_tr_b16 v[150:151], v15 offset:51200
    s_waitcnt lgkmcnt(6)
    v_mfma_f32_16x16x32_bf16 v[56:59], a[132:135], v[168:171], v[56:59]
    s_add_u32 m0, s39, 86016
    s_add_u32 s12, s38, 657408
    buffer_load_dwordx4 v14, s[20:23], s12 offen sc1 lds
    v_mfma_f32_16x16x32_bf16 v[72:75], a[136:139], v[168:171], v[72:75]
    ds_read_b64_tr_b16 v[152:153], v16 offset:49152
    v_mfma_f32_16x16x32_bf16 v[88:91], v[168:171], v[168:171], v[88:91]
    ds_read_b64_tr_b16 v[154:155], v16 offset:51200
    s_waitcnt lgkmcnt(6)
    v_mfma_f32_16x16x32_bf16 v[60:63], a[132:135], v[172:175], v[60:63]
    s_add_u32 m0, s39, 90112
    s_add_u32 s12, s38, 788480
    buffer_load_dwordx4 v14, s[20:23], s12 offen sc1 lds
    v_mfma_f32_16x16x32_bf16 v[76:79], a[136:139], v[172:175], v[76:79]
    ds_read_b64_tr_b16 v[156:157], v17 offset:49152
    v_mfma_f32_16x16x32_bf16 v[92:95], v[172:175], v[172:175], v[92:95]
    ds_read_b64_tr_b16 v[158:159], v17 offset:51200
    s_waitcnt lgkmcnt(6)
    v_mfma_f32_16x16x32_bf16 v[64:67], a[132:135], v[176:179], v[64:67]
    s_add_u32 m0, s39, 94208
    s_add_u32 s12, s38, 919552
    buffer_load_dwordx4 v14, s[20:23], s12 offen sc1 lds
    v_mfma_f32_16x16x32_bf16 v[80:83], a[136:139], v[176:179], v[80:83]
    ds_read_b64_tr_b16 v[160:161], v18 offset:49152
    v_mfma_f32_16x16x32_bf16 v[96:99], v[176:179], v[176:179], v[96:99]
    ds_read_b64_tr_b16 v[162:163], v18 offset:51200
    s_waitcnt lgkmcnt(6)
    v_mfma_f32_16x16x32_bf16 v[52:55], a[144:147], v[148:151], v[52:55]
    s_add_u32 m0, s39, 98304
    s_add_u32 s12, s38, 1050624
    buffer_load_dwordx4 v14, s[20:23], s12 offen sc1 lds
    v_mfma_f32_16x16x32_bf16 v[68:71], a[148:151], v[148:151], v[68:71]
    ds_read_b64_tr_b16 v[164:165], v15 offset:53248
    v_mfma_f32_16x16x32_bf16 v[84:87], v[148:151], v[148:151], v[84:87]
    ds_read_b64_tr_b16 v[166:167], v15 offset:55296
    s_waitcnt lgkmcnt(6)
    v_mfma_f32_16x16x32_bf16 v[56:59], a[144:147], v[152:155], v[56:59]
    s_add_u32 m0, s39, 102400
    s_add_u32 s12, s38, 1181696
    buffer_load_dwordx4 v14, s[20:23], s12 offen sc1 lds
    v_mfma_f32_16x16x32_bf16 v[72:75], a[148:151], v[152:155], v[72:75]
    ds_read_b64_tr_b16 v[168:169], v16 offset:53248
    v_mfma_f32_16x16x32_bf16 v[88:91], v[152:155], v[152:155], v[88:91]
    ds_read_b64_tr_b16 v[170:171], v16 offset:55296
    s_waitcnt lgkmcnt(6)
    v_mfma_f32_16x16x32_bf16 v[60:63], a[144:147], v[156:159], v[60:63]
    s_add_u32 m0, s39, 106496
    s_add_u32 s12, s38, 1312768
    buffer_load_dwordx4 v14, s[20:23], s12 offen sc1 lds
    v_mfma_f32_16x16x32_bf16 v[76:79], a[148:151], v[156:159], v[76:79]
    ds_read_b64_tr_b16 v[172:173], v17 offset:53248
    v_mfma_f32_16x16x32_bf16 v[92:95], v[156:159], v[156:159], v[92:95]
    ds_read_b64_tr_b16 v[174:175], v17 offset:55296
    s_waitcnt lgkmcnt(6)
    v_mfma_f32_16x16x32_bf16 v[64:67], a[144:147], v[160:163], v[64:67]
    s_add_u32 m0, s39, 110592
    s_add_u32 s12, s38, 1443840
    buffer_load_dwordx4 v14, s[20:23], s12 offen sc1 lds
    v_mfma_f32_16x16x32_bf16 v[80:83], a[148:151], v[160:163], v[80:83]
    ds_read_b64_tr_b16 v[176:177], v18 offset:53248
    v_mfma_f32_16x16x32_bf16 v[96:99], v[160:163], v[160:163], v[96:99]
    ds_read_b64_tr_b16 v[178:179], v18 offset:55296
    s_waitcnt lgkmcnt(6)
    v_mfma_f32_16x16x32_bf16 v[52:55], a[156:159], v[164:167], v[52:55]
    s_add_u32 m0, s39, 114688
    s_add_u32 s12, s38, 1574912
    buffer_load_dwordx4 v14, s[20:23], s12 offen sc1 lds
    v_mfma_f32_16x16x32_bf16 v[68:71], a[160:163], v[164:167], v[68:71]
    ds_read_b64_tr_b16 v[148:149], v15 offset:57344
    v_mfma_f32_16x16x32_bf16 v[84:87], v[164:167], v[164:167], v[84:87]
    ds_read_b64_tr_b16 v[150:151], v15 offset:59392
    s_waitcnt lgkmcnt(6)
    v_mfma_f32_16x16x32_bf16 v[56:59], a[156:159], v[168:171], v[56:59]
    s_add_u32 m0, s39, 118784
    s_add_u32 s12, s38, 1705984
    buffer_load_dwordx4 v14, s[20:23], s12 offen sc1 lds
    v_mfma_f32_16x16x32_bf16 v[72:75], a[160:163], v[168:171], v[72:75]
    ds_read_b64_tr_b16 v[152:153], v16 offset:57344
    v_mfma_f32_16x16x32_bf16 v[88:91], v[168:171], v[168:171], v[88:91]
    ds_read_b64_tr_b16 v[154:155], v16 offset:59392
    s_waitcnt lgkmcnt(6)
    v_mfma_f32_16x16x32_bf16 v[60:63], a[156:159], v[172:175], v[60:63]
    s_add_u32 m0, s39, 122880
    s_add_u32 s12, s38, 1837056
    buffer_load_dwordx4 v14, s[20:23], s12 offen sc1 lds
    v_mfma_f32_16x16x32_bf16 v[76:79], a[160:163], v[172:175], v[76:79]
    ds_read_b64_tr_b16 v[156:157], v17 offset:57344
    v_mfma_f32_16x16x32_bf16 v[92:95], v[172:175], v[172:175], v[92:95]
    ds_read_b64_tr_b16 v[158:159], v17 offset:59392
    s_waitcnt lgkmcnt(6)
    v_mfma_f32_16x16x32_bf16 v[64:67], a[156:159], v[176:179], v[64:67]
    s_add_u32 m0, s39, 126976
    s_add_u32 s12, s38, 1968128
    buffer_load_dwordx4 v14, s[20:23], s12 offen sc1 lds
    v_mfma_f32_16x16x32_bf16 v[80:83], a[160:163], v[176:179], v[80:83]
    ds_read_b64_tr_b16 v[160:161], v18 offset:57344
    v_mfma_f32_16x16x32_bf16 v[96:99], v[176:179], v[176:179], v[96:99]
    ds_read_b64_tr_b16 v[162:163], v18 offset:59392
    s_waitcnt lgkmcnt(6)
    v_mfma_f32_16x16x32_bf16 v[52:55], a[168:171], v[148:151], v[52:55]
    v_mfma_f32_16x16x32_bf16 v[68:71], a[172:175], v[148:151], v[68:71]
    ds_read_b64_tr_b16 v[164:165], v15 offset:61440
    v_mfma_f32_16x16x32_bf16 v[84:87], v[148:151], v[148:151], v[84:87]
    ds_read_b64_tr_b16 v[166:167], v15 offset:63488
    s_waitcnt lgkmcnt(6)
    v_mfma_f32_16x16x32_bf16 v[56:59], a[168:171], v[152:155], v[56:59]
    v_mfma_f32_16x16x32_bf16 v[72:75], a[172:175], v[152:155], v[72:75]
    ds_read_b64_tr_b16 v[168:169], v16 offset:61440
    v_mfma_f32_16x16x32_bf16 v[88:91], v[152:155], v[152:155], v[88:91]
    ds_read_b64_tr_b16 v[170:171], v16 offset:63488
    s_waitcnt lgkmcnt(6)
    v_mfma_f32_16x16x32_bf16 v[60:63], a[168:171], v[156:159], v[60:63]
    v_mfma_f32_16x16x32_bf16 v[76:79], a[172:175], v[156:159], v[76:79]
    ds_read_b64_tr_b16 v[172:173], v17 offset:61440
    v_mfma_f32_16x16x32_bf16 v[92:95], v[156:159], v[156:159], v[92:95]
    ds_read_b64_tr_b16 v[174:175], v17 offset:63488
    s_waitcnt lgkmcnt(6)
    v_mfma_f32_16x16x32_bf16 v[64:67], a[168:171], v[160:163], v[64:67]
    v_mfma_f32_16x16x32_bf16 v[80:83], a[172:175], v[160:163], v[80:83]
    ds_read_b64_tr_b16 v[176:177], v18 offset:61440
    v_mfma_f32_16x16x32_bf16 v[96:99], v[160:163], v[160:163], v[96:99]
    ds_read_b64_tr_b16 v[178:179], v18 offset:63488
    s_waitcnt vmcnt(14)
    s_barrier
    s_waitcnt lgkmcnt(6)
    v_mfma_f32_16x16x32_bf16 v[52:55], a[180:183], v[164:167], v[52:55]
    v_xor_b32 v15, 0x10000, v15
    v_mfma_f32_16x16x32_bf16 v[68:71], a[184:187], v[164:167], v[68:71]
    ds_read_b64_tr_b16 v[148:149], v15 offset:0
    v_mfma_f32_16x16x32_bf16 v[84:87], v[164:167], v[164:167], v[84:87]
    ds_read_b64_tr_b16 v[150:151], v15 offset:2048
    s_waitcnt lgkmcnt(6)
    v_mfma_f32_16x16x32_bf16 v[56:59], a[180:183], v[168:171], v[56:59]
    v_xor_b32 v16, 0x10000, v16
    v_mfma_f32_16x16x32_bf16 v[72:75], a[184:187], v[168:171], v[72:75]
    ds_read_b64_tr_b16 v[152:153], v16 offset:0
    v_mfma_f32_16x16x32_bf16 v[88:91], v[168:171], v[168:171], v[88:91]
    ds_read_b64_tr_b16 v[154:155], v16 offset:2048
    s_waitcnt lgkmcnt(6)
    v_mfma_f32_16x16x32_bf16 v[60:63], a[180:183], v[172:175], v[60:63]
    v_xor_b32 v17, 0x10000, v17
    v_mfma_f32_16x16x32_bf16 v[76:79], a[184:187], v[172:175], v[76:79]
    ds_read_b64_tr_b16 v[156:157], v17 offset:0
    v_mfma_f32_16x16x32_bf16 v[92:95], v[172:175], v[172:175], v[92:95]
    ds_read_b64_tr_b16 v[158:159], v17 offset:2048
    s_waitcnt lgkmcnt(6)
    v_mfma_f32_16x16x32_bf16 v[64:67], a[180:183], v[176:179], v[64:67]
    v_xor_b32 v18, 0x10000, v18
    v_mfma_f32_16x16x32_bf16 v[80:83], a[184:187], v[176:179], v[80:83]
    ds_read_b64_tr_b16 v[160:161], v18 offset:0
    v_mfma_f32_16x16x32_bf16 v[96:99], v[176:179], v[176:179], v[96:99]
    ds_read_b64_tr_b16 v[162:163], v18 offset:2048
    s_waitcnt lgkmcnt(6)
    v_mfma_f32_16x16x32_bf16 v[100:103], a[0:3], v[148:151], 0
    v_mfma_f32_16x16x32_bf16 v[116:119], a[4:7], v[148:151], 0
    ds_read_b64_tr_b16 v[164:165], v15 offset:4096
    v_mfma_f32_16x16x32_bf16 v[132:135], v[148:151], v[148:151], 0
    ds_read_b64_tr_b16 v[166:167], v15 offset:6144
    s_waitcnt lgkmcnt(6)
    v_mfma_f32_16x16x32_bf16 v[104:107], a[0:3], v[152:155], 0
    v_cndmask_b32 v192, v84, v85, s[52:53]
    v_cndmask_b32 v192, v192, v86, s[54:55]
    v_cndmask_b32 v192, v192, v87, s[56:57]
    v_mov_b32 v180, v68
    v_mfma_f32_16x16x32_bf16 v[120:123], a[4:7], v[152:155], 0
    ds_read_b64_tr_b16 v[168:169], v16 offset:4096
    v_cndmask_b32 v193, v88, v89, s[52:53]
    v_cndmask_b32 v193, v193, v90, s[54:55]
    v_cndmask_b32 v193, v193, v91, s[56:57]
    v_mfma_f32_16x16x32_bf16 v[136:139], v[152:155], v[152:155], 0
    ds_read_b64_tr_b16 v[170:171], v16 offset:6144
    v_mov_b32 v181, v72
    v_cndmask_b32 v194, v92, v93, s[52:53]
    v_cndmask_b32 v194, v194, v94, s[54:55]
    s_waitcnt lgkmcnt(6)
    v_mfma_f32_16x16x32_bf16 v[108:111], a[0:3], v[156:159], 0
    v_cndmask_b32 v194, v194, v95, s[56:57]
    v_mov_b32 v182, v76
    v_cndmask_b32 v195, v96, v97, s[52:53]
    v_cndmask_b32 v195, v195, v98, s[54:55]
    v_mfma_f32_16x16x32_bf16 v[124:127], a[4:7], v[156:159], 0
    ds_read_b64_tr_b16 v[172:173], v17 offset:4096
    v_cndmask_b32 v195, v195, v99, s[56:57]
    v_mov_b32 v183, v80
    s_mov_b64 exec, s[58:59]
    ds_write_b128 v19, v[192:195] offset:256
    s_mov_b64 exec, s[60:61]
    ds_write_b128 v19, v[180:183] offset:0
    s_mov_b64 exec, -1
    v_mfma_f32_16x16x32_bf16 v[140:143], v[156:159], v[156:159], 0
    ds_read_b64_tr_b16 v[174:175], v17 offset:6144
    s_waitcnt lgkmcnt(8)
    v_mfma_f32_16x16x32_bf16 v[112:115], a[0:3], v[160:163], 0
    v_mfma_f32_16x16x32_bf16 v[128:131], a[4:7], v[160:163], 0
    ds_read_b64_tr_b16 v[176:177], v18 offset:4096
    v_mfma_f32_16x16x32_bf16 v[144:147], v[160:163], v[160:163], 0
    ds_read_b64_tr_b16 v[178:179], v18 offset:6144
    s_waitcnt vmcnt(10)
    s_waitcnt lgkmcnt(0)
    s_barrier
    v_mfma_f32_16x16x32_bf16 v[100:103], a[12:15], v[164:167], v[100:103]
    ds_read_b128 v[180:183], v19 offset:0
    ds_read_b128 v[192:195], v19 offset:256
    s_waitcnt lgkmcnt(1)
    v_mul_f32 v180, 0xbb000000, v180
    v_mul_f32 v181, 0xbb000000, v181
    v_mfma_f32_16x16x32_bf16 v[116:119], a[16:19], v[164:167], v[116:119]
    ds_read_b64_tr_b16 v[148:149], v15 offset:8192
    v_mul_f32 v182, 0xbb000000, v182
    v_mul_f32 v183, 0xbb000000, v183
    s_waitcnt lgkmcnt(1)
    v_fma_f32 v192, v192, s49, v35
    v_mfma_f32_16x16x32_bf16 v[132:135], v[164:167], v[164:167], v[132:135]
    ds_read_b64_tr_b16 v[150:151], v15 offset:10240
    v_fma_f32 v193, v193, s49, v35
    v_fma_f32 v194, v194, s49, v35
    v_fma_f32 v195, v195, s49, v35
    v_mfma_f32_16x16x32_bf16 v[104:107], a[12:15], v[168:171], v[104:107]
    v_fma_f32 v192, -v180, v180, v192
    v_fma_f32 v193, -v181, v181, v193
    v_fma_f32 v194, -v182, v182, v194
    v_fma_f32 v195, -v183, v183, v195
    v_mfma_f32_16x16x32_bf16 v[120:123], a[16:19], v[168:171], v[120:123]
    ds_read_b64_tr_b16 v[152:153], v16 offset:8192
    v_max_f32 v192, v35, v192
    v_max_f32 v193, v35, v193
    v_max_f32 v194, v35, v194
    v_mfma_f32_16x16x32_bf16 v[136:139], v[168:171], v[168:171], v[136:139]
    ds_read_b64_tr_b16 v[154:155], v16 offset:10240
    v_max_f32 v195, v35, v195
    v_rsq_f32 v184, v192
    v_rsq_f32 v185, v193
    v_mfma_f32_16x16x32_bf16 v[108:111], a[12:15], v[172:175], v[108:111]
    v_rsq_f32 v186, v194
    v_rsq_f32 v187, v195
    v_mul_f32 v188, v184, v184
    v_mul_f32 v189, v185, v185
    v_mfma_f32_16x16x32_bf16 v[124:127], a[16:19], v[172:175], v[124:127]
    ds_read_b64_tr_b16 v[156:157], v17 offset:8192
    v_mul_f32 v190, v186, v186
    v_mul_f32 v191, v187, v187
    v_mul_f32 v188, v188, v184
    v_mfma_f32_16x16x32_bf16 v[140:143], v[172:175], v[172:175], v[140:143]
    ds_read_b64_tr_b16 v[158:159], v17 offset:10240
    v_mul_f32 v189, v189, v185
    v_mul_f32 v190, v190, v186
    v_mul_f32 v191, v191, v187
    v_mfma_f32_16x16x32_bf16 v[112:115], a[12:15], v[176:179], v[112:115]
    v_mul_f32 v184, 0xc0135761, v184
    v_mul_f32 v185, 0xc0135761, v185
    v_mul_f32 v186, 0xc0135761, v186
    v_mul_f32 v187, 0xc0135761, v187
    v_mfma_f32_16x16x32_bf16 v[128:131], a[16:19], v[176:179], v[128:131]
    ds_read_b64_tr_b16 v[160:161], v18 offset:8192
    v_mul_f32 v188, 0xbdd2d3e8, v188
    v_mul_f32 v189, 0xbdd2d3e8, v189
    v_mul_f32 v190, 0xbdd2d3e8, v190
    v_mfma_f32_16x16x32_bf16 v[144:147], v[176:179], v[176:179], v[144:147]
    ds_read_b64_tr_b16 v[162:163], v18 offset:10240
    v_mul_f32 v191, 0xbdd2d3e8, v191
    v_fmac_f32 v52, v36, v180
    v_fmac_f32 v53, v37, v180
    s_waitcnt lgkmcnt(6)
    v_mfma_f32_16x16x32_bf16 v[100:103], a[24:27], v[148:151], v[100:103]
    v_fmac_f32 v54, v38, v180
    v_fmac_f32 v55, v39, v180
    v_mul_f32 v196, v52, v52
    v_mul_f32 v197, v53, v53
    v_mfma_f32_16x16x32_bf16 v[116:119], a[28:31], v[148:151], v[116:119]
    ds_read_b64_tr_b16 v[164:165], v15 offset:12288
    v_fma_f32 v196, v196, v188, v184
    v_fma_f32 v197, v197, v188, v184
    v_mul_f32 v196, v196, v52
    v_mfma_f32_16x16x32_bf16 v[132:135], v[148:151], v[148:151], v[132:135]
    ds_read_b64_tr_b16 v[166:167], v15 offset:14336
    v_mul_f32 v197, v197, v53
    v_exp_f32 v196, v196
    v_exp_f32 v197, v197
    s_waitcnt lgkmcnt(6)
    v_mfma_f32_16x16x32_bf16 v[104:107], a[24:27], v[152:155], v[104:107]
    v_mul_f32 v52, v52, v54
    v_mul_f32 v53, v53, v55
    v_fma_f32 v196, v196, v192, v192
    v_fma_f32 v197, v197, v192, v192
    v_mfma_f32_16x16x32_bf16 v[120:123], a[28:31], v[152:155], v[120:123]
    ds_read_b64_tr_b16 v[168:169], v16 offset:12288
    s_add_u32 s11, s43, 16384
    buffer_load_dwordx4 a[0:3], v5, s[20:23], s11 offen offset:0 sc1
    v_rcp_f32 v196, v196
    v_rcp_f32 v197, v197
    v_fmac_f32 v56, v36, v181
    v_mfma_f32_16x16x32_bf16 v[136:139], v[152:155], v[152:155], v[136:139]
    ds_read_b64_tr_b16 v[170:171], v16 offset:14336
    v_fmac_f32 v57, v37, v181
    v_mul_f32 v52, v52, v196
    v_mul_f32 v53, v53, v197
    s_waitcnt lgkmcnt(6)
    v_mfma_f32_16x16x32_bf16 v[108:111], a[24:27], v[156:159], v[108:111]
    v_cvt_pk_bf16_f32 v200, v52, v53
    v_fmac_f32 v58, v38, v181
    v_fmac_f32 v59, v39, v181
    v_mul_f32 v198, v56, v56
    v_mfma_f32_16x16x32_bf16 v[124:127], a[28:31], v[156:159], v[124:127]
    ds_read_b64_tr_b16 v[172:173], v17 offset:12288
    v_mul_f32 v199, v57, v57
    v_fma_f32 v198, v198, v189, v185
    v_fma_f32 v199, v199, v189, v185
    v_mfma_f32_16x16x32_bf16 v[140:143], v[156:159], v[156:159], v[140:143]
    ds_read_b64_tr_b16 v[174:175], v17 offset:14336
    v_mul_f32 v198, v198, v56
    v_mul_f32 v199, v199, v57
    v_exp_f32 v198, v198
    s_waitcnt lgkmcnt(6)
    v_mfma_f32_16x16x32_bf16 v[112:115], a[24:27], v[160:163], v[112:115]
    buffer_load_dwordx4 a[4:7], v5, s[20:23], s11 offen offset:1024 sc1
    v_exp_f32 v199, v199
    v_mul_f32 v56, v56, v58
    v_mul_f32 v57, v57, v59
    v_fma_f32 v198, v198, v193, v193
    v_mfma_f32_16x16x32_bf16 v[128:131], a[28:31], v[160:163], v[128:131]
    ds_read_b64_tr_b16 v[176:177], v18 offset:12288
    v_fma_f32 v199, v199, v193, v193
    v_rcp_f32 v198, v198
    v_rcp_f32 v199, v199
    v_mfma_f32_16x16x32_bf16 v[144:147], v[160:163], v[160:163], v[144:147]
    ds_read_b64_tr_b16 v[178:179], v18 offset:14336
    v_fmac_f32 v60, v36, v182
    v_fmac_f32 v61, v37, v182
    v_mul_f32 v56, v56, v198
    s_waitcnt lgkmcnt(6)
    v_mfma_f32_16x16x32_bf16 v[100:103], a[36:39], v[164:167], v[100:103]
    v_mul_f32 v57, v57, v199
    v_cvt_pk_bf16_f32 v201, v56, v57
    v_fmac_f32 v62, v38, v182
    v_fmac_f32 v63, v39, v182
    v_mfma_f32_16x16x32_bf16 v[116:119], a[40:43], v[164:167], v[116:119]
    ds_read_b64_tr_b16 v[148:149], v15 offset:16384
    v_mul_f32 v196, v60, v60
    v_mul_f32 v197, v61, v61
    v_fma_f32 v196, v196, v190, v186
    v_mfma_f32_16x16x32_bf16 v[132:135], v[164:167], v[164:167], v[132:135]
    ds_read_b64_tr_b16 v[150:151], v15 offset:18432
    buffer_load_dwordx4 a[8:11], v5, s[20:23], s11 offen offset:2048 sc1
    v_fma_f32 v197, v197, v190, v186
    v_mul_f32 v196, v196, v60
    v_mul_f32 v197, v197, v61
    s_waitcnt lgkmcnt(6)
    v_mfma_f32_16x16x32_bf16 v[104:107], a[36:39], v[168:171], v[104:107]
    v_exp_f32 v196, v196
    v_exp_f32 v197, v197
    v_mul_f32 v60, v60, v62
    v_mul_f32 v61, v61, v63
    v_mfma_f32_16x16x32_bf16 v[120:123], a[40:43], v[168:171], v[120:123]
    ds_read_b64_tr_b16 v[152:153], v16 offset:16384
    v_fma_f32 v196, v196, v194, v194
    v_fma_f32 v197, v197, v194, v194
    v_rcp_f32 v196, v196
    v_mfma_f32_16x16x32_bf16 v[136:139], v[168:171], v[168:171], v[136:139]
    ds_read_b64_tr_b16 v[154:155], v16 offset:18432
    v_rcp_f32 v197, v197
    v_fmac_f32 v64, v36, v183
    v_fmac_f32 v65, v37, v183
    s_waitcnt lgkmcnt(6)
    v_mfma_f32_16x16x32_bf16 v[108:111], a[36:39], v[172:175], v[108:111]
    v_mul_f32 v60, v60, v196
    v_mul_f32 v61, v61, v197
    v_cvt_pk_bf16_f32 v202, v60, v61
    v_fmac_f32 v66, v38, v183
    v_mfma_f32_16x16x32_bf16 v[124:127], a[40:43], v[172:175], v[124:127]
    ds_read_b64_tr_b16 v[156:157], v17 offset:16384
    buffer_load_dwordx4 a[12:15], v5, s[20:23], s11 offen offset:3072 sc1
    v_fmac_f32 v67, v39, v183
    v_mul_f32 v198, v64, v64
    v_mul_f32 v199, v65, v65
    v_mfma_f32_16x16x32_bf16 v[140:143], v[172:175], v[172:175], v[140:143]
    ds_read_b64_tr_b16 v[158:159], v17 offset:18432
    v_fma_f32 v198, v198, v191, v187
    v_fma_f32 v199, v199, v191, v187
    v_mul_f32 v198, v198, v64
    s_waitcnt lgkmcnt(6)
    v_mfma_f32_16x16x32_bf16 v[112:115], a[36:39], v[176:179], v[112:115]
    v_mul_f32 v199, v199, v65
    v_exp_f32 v198, v198
    v_exp_f32 v199, v199
    v_mul_f32 v64, v64, v66
    v_mfma_f32_16x16x32_bf16 v[128:131], a[40:43], v[176:179], v[128:131]
    ds_read_b64_tr_b16 v[160:161], v18 offset:16384
    v_mul_f32 v65, v65, v67
    v_fma_f32 v198, v198, v195, v195
    v_fma_f32 v199, v199, v195, v195
    v_mfma_f32_16x16x32_bf16 v[144:147], v[176:179], v[176:179], v[144:147]
    ds_read_b64_tr_b16 v[162:163], v18 offset:18432
    v_rcp_f32 v198, v198
    v_rcp_f32 v199, v199
    v_mul_f32 v64, v64, v198
    s_waitcnt lgkmcnt(6)
    v_mfma_f32_16x16x32_bf16 v[100:103], a[48:51], v[148:151], v[100:103]
    s_add_u32 s11, s43, 20480
    buffer_load_dwordx4 a[16:19], v5, s[20:23], s11 offen offset:0 sc1
    v_mul_f32 v65, v65, v199
    v_cvt_pk_bf16_f32 v203, v64, v65
    v_permlane32_swap_b32 v200, v202
    s_nop 0
    v_permlane32_swap_b32 v201, v203
    v_mfma_f32_16x16x32_bf16 v[116:119], a[52:55], v[148:151], v[116:119]
    ds_read_b64_tr_b16 v[164:165], v15 offset:20480
    s_add_u32 s13, s41, 0
    v_permlane16_swap_b32 v200, v201
    v_permlane16_swap_b32 v202, v203
    v_mfma_f32_16x16x32_bf16 v[132:135], v[148:151], v[148:151], v[132:135]
    ds_read_b64_tr_b16 v[166:167], v15 offset:22528
    buffer_store_dwordx4 v[200:203], v20, s[20:23], s13 offen sc1
    v_fmac_f32 v68, v40, v180
    v_fmac_f32 v69, v41, v180
    s_waitcnt lgkmcnt(6)
    v_mfma_f32_16x16x32_bf16 v[104:107], a[48:51], v[152:155], v[104:107]
    v_fmac_f32 v70, v42, v180
    v_fmac_f32 v71, v43, v180
    v_mul_f32 v196, v68, v68
    v_mul_f32 v197, v69, v69
    v_mfma_f32_16x16x32_bf16 v[120:123], a[52:55], v[152:155], v[120:123]
    ds_read_b64_tr_b16 v[168:169], v16 offset:20480
    v_fma_f32 v196, v196, v188, v184
    v_fma_f32 v197, v197, v188, v184
    v_mul_f32 v196, v196, v68
    v_mfma_f32_16x16x32_bf16 v[136:139], v[152:155], v[152:155], v[136:139]
    ds_read_b64_tr_b16 v[170:171], v16 offset:22528
    buffer_load_dwordx4 a[20:23], v5, s[20:23], s11 offen offset:1024 sc1
    v_mul_f32 v197, v197, v69
    v_exp_f32 v196, v196
    v_exp_f32 v197, v197
    s_waitcnt lgkmcnt(6)
    v_mfma_f32_16x16x32_bf16 v[108:111], a[48:51], v[156:159], v[108:111]
    v_mul_f32 v68, v68, v70
    v_mul_f32 v69, v69, v71
    v_fma_f32 v196, v196, v192, v192
    v_fma_f32 v197, v197, v192, v192
    v_mfma_f32_16x16x32_bf16 v[124:127], a[52:55], v[156:159], v[124:127]
    ds_read_b64_tr_b16 v[172:173], v17 offset:20480
    v_rcp_f32 v196, v196
    v_rcp_f32 v197, v197
    v_fmac_f32 v72, v40, v181
    v_mfma_f32_16x16x32_bf16 v[140:143], v[156:159], v[156:159], v[140:143]
    ds_read_b64_tr_b16 v[174:175], v17 offset:22528
    v_fmac_f32 v73, v41, v181
    v_mul_f32 v68, v68, v196
    v_mul_f32 v69, v69, v197
    s_waitcnt lgkmcnt(6)
    v_mfma_f32_16x16x32_bf16 v[112:115], a[48:51], v[160:163], v[112:115]
    v_cvt_pk_bf16_f32 v204, v68, v69
    v_fmac_f32 v74, v42, v181
    v_fmac_f32 v75, v43, v181
    v_mul_f32 v198, v72, v72
    v_mfma_f32_16x16x32_bf16 v[128:131], a[52:55], v[160:163], v[128:131]
    ds_read_b64_tr_b16 v[176:177], v18 offset:20480
    buffer_load_dwordx4 a[24:27], v5, s[20:23], s11 offen offset:2048 sc1
    v_mul_f32 v199, v73, v73
    v_fma_f32 v198, v198, v189, v185
    v_fma_f32 v199, v199, v189, v185
    v_mfma_f32_16x16x32_bf16 v[144:147], v[160:163], v[160:163], v[144:147]
    ds_read_b64_tr_b16 v[178:179], v18 offset:22528
    v_mul_f32 v198, v198, v72
    v_mul_f32 v199, v199, v73
    v_exp_f32 v198, v198
    s_waitcnt vmcnt(8)
    s_barrier
    s_waitcnt lgkmcnt(6)
    v_mfma_f32_16x16x32_bf16 v[100:103], a[60:63], v[164:167], v[100:103]
    v_exp_f32 v199, v199
    v_mul_f32 v72, v72, v74
    v_mul_f32 v73, v73, v75
    v_fma_f32 v198, v198, v193, v193
    v_mfma_f32_16x16x32_bf16 v[116:119], a[64:67], v[164:167], v[116:119]
    ds_read_b64_tr_b16 v[148:149], v15 offset:24576
    v_fma_f32 v199, v199, v193, v193
    v_rcp_f32 v198, v198
    v_rcp_f32 v199, v199
    v_mfma_f32_16x16x32_bf16 v[132:135], v[164:167], v[164:167], v[132:135]
    ds_read_b64_tr_b16 v[150:151], v15 offset:26624
    v_fmac_f32 v76, v40, v182
    v_fmac_f32 v77, v41, v182
    v_mul_f32 v72, v72, v198
    s_waitcnt lgkmcnt(6)
    v_mfma_f32_16x16x32_bf16 v[104:107], a[60:63], v[168:171], v[104:107]
    buffer_load_dwordx4 a[28:31], v5, s[20:23], s11 offen offset:3072 sc1
    v_mul_f32 v73, v73, v199
    v_cvt_pk_bf16_f32 v205, v72, v73
    v_fmac_f32 v78, v42, v182
    v_fmac_f32 v79, v43, v182
    v_mfma_f32_16x16x32_bf16 v[120:123], a[64:67], v[168:171], v[120:123]
    ds_read_b64_tr_b16 v[152:153], v16 offset:24576
    v_mul_f32 v196, v76, v76
    v_mul_f32 v197, v77, v77
    v_fma_f32 v196, v196, v190, v186
    v_mfma_f32_16x16x32_bf16 v[136:139], v[168:171], v[168:171], v[136:139]
    ds_read_b64_tr_b16 v[154:155], v16 offset:26624
    v_fma_f32 v197, v197, v190, v186
    v_mul_f32 v196, v196, v76
    v_mul_f32 v197, v197, v77
    s_waitcnt lgkmcnt(6)
    v_mfma_f32_16x16x32_bf16 v[108:111], a[60:63], v[172:175], v[108:111]
    v_exp_f32 v196, v196
    v_exp_f32 v197, v197
    v_mul_f32 v76, v76, v78
    v_mul_f32 v77, v77, v79
    v_mfma_f32_16x16x32_bf16 v[124:127], a[64:67], v[172:175], v[124:127]
    ds_read_b64_tr_b16 v[156:157], v17 offset:24576
    v_fma_f32 v196, v196, v194, v194
    v_fma_f32 v197, v197, v194, v194
    v_rcp_f32 v196, v196
    v_mfma_f32_16x16x32_bf16 v[140:143], v[172:175], v[172:175], v[140:143]
    ds_read_b64_tr_b16 v[158:159], v17 offset:26624
    s_add_u32 s11, s43, 24576
    buffer_load_dwordx4 a[32:35], v5, s[20:23], s11 offen offset:0 sc1
    v_rcp_f32 v197, v197
    v_fmac_f32 v80, v40, v183
    v_fmac_f32 v81, v41, v183
    s_waitcnt lgkmcnt(6)
    v_mfma_f32_16x16x32_bf16 v[112:115], a[60:63], v[176:179], v[112:115]
    v_mul_f32 v76, v76, v196
    v_mul_f32 v77, v77, v197
    v_cvt_pk_bf16_f32 v206, v76, v77
    v_fmac_f32 v82, v42, v183
    v_mfma_f32_16x16x32_bf16 v[128:131], a[64:67], v[176:179], v[128:131]
    ds_read_b64_tr_b16 v[160:161], v18 offset:24576
    v_fmac_f32 v83, v43, v183
    v_mul_f32 v198, v80, v80
    v_mul_f32 v199, v81, v81
    v_mfma_f32_16x16x32_bf16 v[144:147], v[176:179], v[176:179], v[144:147]
    ds_read_b64_tr_b16 v[162:163], v18 offset:26624
    v_fma_f32 v198, v198, v191, v187
    v_fma_f32 v199, v199, v191, v187
    v_mul_f32 v198, v198, v80
    s_waitcnt lgkmcnt(6)
    v_mfma_f32_16x16x32_bf16 v[100:103], a[72:75], v[148:151], v[100:103]
    v_mul_f32 v199, v199, v81
    v_exp_f32 v198, v198
    v_exp_f32 v199, v199
    v_mul_f32 v80, v80, v82
    v_mfma_f32_16x16x32_bf16 v[116:119], a[76:79], v[148:151], v[116:119]
    ds_read_b64_tr_b16 v[164:165], v15 offset:28672
    buffer_load_dwordx4 a[36:39], v5, s[20:23], s11 offen offset:1024 sc1
    v_mul_f32 v81, v81, v83
    v_fma_f32 v198, v198, v195, v195
    v_fma_f32 v199, v199, v195, v195
    v_mfma_f32_16x16x32_bf16 v[132:135], v[148:151], v[148:151], v[132:135]
    ds_read_b64_tr_b16 v[166:167], v15 offset:30720
    v_rcp_f32 v198, v198
    v_rcp_f32 v199, v199
    v_mul_f32 v80, v80, v198
    s_waitcnt lgkmcnt(6)
    v_mfma_f32_16x16x32_bf16 v[104:107], a[72:75], v[152:155], v[104:107]
    v_mul_f32 v81, v81, v199
    v_cvt_pk_bf16_f32 v207, v80, v81
    v_permlane32_swap_b32 v204, v206
    s_nop 0
    v_permlane32_swap_b32 v205, v207
    v_mfma_f32_16x16x32_bf16 v[120:123], a[76:79], v[152:155], v[120:123]
    ds_read_b64_tr_b16 v[168:169], v16 offset:28672
    s_add_u32 s13, s41, 32768
    v_permlane16_swap_b32 v204, v205
    v_permlane16_swap_b32 v206, v207
    v_mfma_f32_16x16x32_bf16 v[136:139], v[152:155], v[152:155], v[136:139]
    ds_read_b64_tr_b16 v[170:171], v16 offset:30720
    v_mov_b32 v207, 0
    buffer_store_dwordx4 v[204:207], v20, s[20:23], s13 offen sc1
    s_waitcnt lgkmcnt(6)
    v_mfma_f32_16x16x32_bf16 v[108:111], a[72:75], v[156:159], v[108:111]
    buffer_load_dwordx4 a[40:43], v5, s[20:23], s11 offen offset:2048 sc1
    v_mfma_f32_16x16x32_bf16 v[124:127], a[76:79], v[156:159], v[124:127]
    ds_read_b64_tr_b16 v[172:173], v17 offset:28672
    v_mfma_f32_16x16x32_bf16 v[140:143], v[156:159], v[156:159], v[140:143]
    ds_read_b64_tr_b16 v[174:175], v17 offset:30720
    s_waitcnt lgkmcnt(6)
    v_mfma_f32_16x16x32_bf16 v[112:115], a[72:75], v[160:163], v[112:115]
    v_mfma_f32_16x16x32_bf16 v[128:131], a[76:79], v[160:163], v[128:131]
    ds_read_b64_tr_b16 v[176:177], v18 offset:28672
    v_mfma_f32_16x16x32_bf16 v[144:147], v[160:163], v[160:163], v[144:147]
    ds_read_b64_tr_b16 v[178:179], v18 offset:30720
    buffer_load_dwordx4 a[44:47], v5, s[20:23], s11 offen offset:3072 sc1
    s_waitcnt lgkmcnt(6)
    v_mfma_f32_16x16x32_bf16 v[100:103], a[84:87], v[164:167], v[100:103]
    v_mfma_f32_16x16x32_bf16 v[116:119], a[88:91], v[164:167], v[116:119]
    ds_read_b64_tr_b16 v[148:149], v15 offset:32768
    v_mfma_f32_16x16x32_bf16 v[132:135], v[164:167], v[164:167], v[132:135]
    ds_read_b64_tr_b16 v[150:151], v15 offset:34816
    s_waitcnt lgkmcnt(6)
    v_mfma_f32_16x16x32_bf16 v[104:107], a[84:87], v[168:171], v[104:107]
    v_mfma_f32_16x16x32_bf16 v[120:123], a[88:91], v[168:171], v[120:123]
    ds_read_b64_tr_b16 v[152:153], v16 offset:32768
    s_add_u32 s11, s43, 28672
    buffer_load_dwordx4 a[48:51], v5, s[20:23], s11 offen offset:0 sc1
    v_mfma_f32_16x16x32_bf16 v[136:139], v[168:171], v[168:171], v[136:139]
    ds_read_b64_tr_b16 v[154:155], v16 offset:34816
    s_waitcnt lgkmcnt(6)
    v_mfma_f32_16x16x32_bf16 v[108:111], a[84:87], v[172:175], v[108:111]
    v_mfma_f32_16x16x32_bf16 v[124:127], a[88:91], v[172:175], v[124:127]
    ds_read_b64_tr_b16 v[156:157], v17 offset:32768
    v_mfma_f32_16x16x32_bf16 v[140:143], v[172:175], v[172:175], v[140:143]
    ds_read_b64_tr_b16 v[158:159], v17 offset:34816
    s_waitcnt lgkmcnt(6)
    v_mfma_f32_16x16x32_bf16 v[112:115], a[84:87], v[176:179], v[112:115]
    buffer_load_dwordx4 a[52:55], v5, s[20:23], s11 offen offset:1024 sc1
    v_mfma_f32_16x16x32_bf16 v[128:131], a[88:91], v[176:179], v[128:131]
    ds_read_b64_tr_b16 v[160:161], v18 offset:32768
    v_mfma_f32_16x16x32_bf16 v[144:147], v[176:179], v[176:179], v[144:147]
    ds_read_b64_tr_b16 v[162:163], v18 offset:34816
    s_waitcnt lgkmcnt(6)
    v_mfma_f32_16x16x32_bf16 v[100:103], a[96:99], v[148:151], v[100:103]
    v_mfma_f32_16x16x32_bf16 v[116:119], a[100:103], v[148:151], v[116:119]
    ds_read_b64_tr_b16 v[164:165], v15 offset:36864
    v_mfma_f32_16x16x32_bf16 v[132:135], v[148:151], v[148:151], v[132:135]
    ds_read_b64_tr_b16 v[166:167], v15 offset:38912
    buffer_load_dwordx4 a[56:59], v5, s[20:23], s11 offen offset:2048 sc1
    s_waitcnt lgkmcnt(6)
    v_mfma_f32_16x16x32_bf16 v[104:107], a[96:99], v[152:155], v[104:107]
    v_mfma_f32_16x16x32_bf16 v[120:123], a[100:103], v[152:155], v[120:123]
    ds_read_b64_tr_b16 v[168:169], v16 offset:36864
    v_mfma_f32_16x16x32_bf16 v[136:139], v[152:155], v[152:155], v[136:139]
    ds_read_b64_tr_b16 v[170:171], v16 offset:38912
    s_waitcnt lgkmcnt(6)
    v_mfma_f32_16x16x32_bf16 v[108:111], a[96:99], v[156:159], v[108:111]
    v_mfma_f32_16x16x32_bf16 v[124:127], a[100:103], v[156:159], v[124:127]
    ds_read_b64_tr_b16 v[172:173], v17 offset:36864
    buffer_load_dwordx4 a[60:63], v5, s[20:23], s11 offen offset:3072 sc1
    v_mfma_f32_16x16x32_bf16 v[140:143], v[156:159], v[156:159], v[140:143]
    ds_read_b64_tr_b16 v[174:175], v17 offset:38912
    s_waitcnt lgkmcnt(6)
    v_mfma_f32_16x16x32_bf16 v[112:115], a[96:99], v[160:163], v[112:115]
    v_mfma_f32_16x16x32_bf16 v[128:131], a[100:103], v[160:163], v[128:131]
    ds_read_b64_tr_b16 v[176:177], v18 offset:36864
    v_mfma_f32_16x16x32_bf16 v[144:147], v[160:163], v[160:163], v[144:147]
    ds_read_b64_tr_b16 v[178:179], v18 offset:38912
    s_waitcnt lgkmcnt(6)
    v_mfma_f32_16x16x32_bf16 v[100:103], a[108:111], v[164:167], v[100:103]
    s_add_u32 s11, s43, 32768
    buffer_load_dwordx4 a[64:67], v5, s[20:23], s11 offen offset:0 sc1
    v_mfma_f32_16x16x32_bf16 v[116:119], a[112:115], v[164:167], v[116:119]
    ds_read_b64_tr_b16 v[148:149], v15 offset:40960
    v_mfma_f32_16x16x32_bf16 v[132:135], v[164:167], v[164:167], v[132:135]
    ds_read_b64_tr_b16 v[150:151], v15 offset:43008
    s_waitcnt lgkmcnt(6)
    v_mfma_f32_16x16x32_bf16 v[104:107], a[108:111], v[168:171], v[104:107]
    v_mfma_f32_16x16x32_bf16 v[120:123], a[112:115], v[168:171], v[120:123]
    ds_read_b64_tr_b16 v[152:153], v16 offset:40960
    v_mfma_f32_16x16x32_bf16 v[136:139], v[168:171], v[168:171], v[136:139]
    ds_read_b64_tr_b16 v[154:155], v16 offset:43008
    buffer_load_dwordx4 a[68:71], v5, s[20:23], s11 offen offset:1024 sc1
    s_waitcnt lgkmcnt(6)
    v_mfma_f32_16x16x32_bf16 v[108:111], a[108:111], v[172:175], v[108:111]
    v_mfma_f32_16x16x32_bf16 v[124:127], a[112:115], v[172:175], v[124:127]
    ds_read_b64_tr_b16 v[156:157], v17 offset:40960
    v_mfma_f32_16x16x32_bf16 v[140:143], v[172:175], v[172:175], v[140:143]
    ds_read_b64_tr_b16 v[158:159], v17 offset:43008
    s_waitcnt lgkmcnt(6)
    v_mfma_f32_16x16x32_bf16 v[112:115], a[108:111], v[176:179], v[112:115]
    v_mfma_f32_16x16x32_bf16 v[128:131], a[112:115], v[176:179], v[128:131]
    ds_read_b64_tr_b16 v[160:161], v18 offset:40960
    buffer_load_dwordx4 a[72:75], v5, s[20:23], s11 offen offset:2048 sc1
    v_mfma_f32_16x16x32_bf16 v[144:147], v[176:179], v[176:179], v[144:147]
    ds_read_b64_tr_b16 v[162:163], v18 offset:43008
    s_waitcnt lgkmcnt(6)
    v_mfma_f32_16x16x32_bf16 v[100:103], a[120:123], v[148:151], v[100:103]
    v_mfma_f32_16x16x32_bf16 v[116:119], a[124:127], v[148:151], v[116:119]
    ds_read_b64_tr_b16 v[164:165], v15 offset:45056
    v_mfma_f32_16x16x32_bf16 v[132:135], v[148:151], v[148:151], v[132:135]
    ds_read_b64_tr_b16 v[166:167], v15 offset:47104
    s_waitcnt lgkmcnt(6)
    v_mfma_f32_16x16x32_bf16 v[104:107], a[120:123], v[152:155], v[104:107]
    buffer_load_dwordx4 a[76:79], v5, s[20:23], s11 offen offset:3072 sc1
    v_mfma_f32_16x16x32_bf16 v[120:123], a[124:127], v[152:155], v[120:123]
    ds_read_b64_tr_b16 v[168:169], v16 offset:45056
    v_mfma_f32_16x16x32_bf16 v[136:139], v[152:155], v[152:155], v[136:139]
    ds_read_b64_tr_b16 v[170:171], v16 offset:47104
    s_waitcnt lgkmcnt(6)
    v_mfma_f32_16x16x32_bf16 v[108:111], a[120:123], v[156:159], v[108:111]
    v_mfma_f32_16x16x32_bf16 v[124:127], a[124:127], v[156:159], v[124:127]
    ds_read_b64_tr_b16 v[172:173], v17 offset:45056
    v_mfma_f32_16x16x32_bf16 v[140:143], v[156:159], v[156:159], v[140:143]
    ds_read_b64_tr_b16 v[174:175], v17 offset:47104
    s_add_u32 s11, s43, 36864
    buffer_load_dwordx4 a[80:83], v5, s[20:23], s11 offen offset:0 sc1
    s_waitcnt lgkmcnt(6)
    v_mfma_f32_16x16x32_bf16 v[112:115], a[120:123], v[160:163], v[112:115]
    v_mfma_f32_16x16x32_bf16 v[128:131], a[124:127], v[160:163], v[128:131]
    ds_read_b64_tr_b16 v[176:177], v18 offset:45056
    v_mfma_f32_16x16x32_bf16 v[144:147], v[160:163], v[160:163], v[144:147]
    ds_read_b64_tr_b16 v[178:179], v18 offset:47104
    s_waitcnt lgkmcnt(6)
    v_mfma_f32_16x16x32_bf16 v[100:103], a[132:135], v[164:167], v[100:103]
    v_mfma_f32_16x16x32_bf16 v[116:119], a[136:139], v[164:167], v[116:119]
    ds_read_b64_tr_b16 v[148:149], v15 offset:49152
    s_add_u32 s19, s47, 33095680
    v_mfma_f32_16x16x32_bf16 v[132:135], v[164:167], v[164:167], v[132:135]
    ds_read_b64_tr_b16 v[150:151], v15 offset:51200
    s_waitcnt vmcnt(11)
    s_barrier
    s_waitcnt lgkmcnt(6)
    v_mfma_f32_16x16x32_bf16 v[104:107], a[132:135], v[168:171], v[104:107]
    buffer_store_dword v32, v31, s[20:23], s19 offen sc1
    v_mfma_f32_16x16x32_bf16 v[120:123], a[136:139], v[168:171], v[120:123]
    ds_read_b64_tr_b16 v[152:153], v16 offset:49152
    v_mfma_f32_16x16x32_bf16 v[136:139], v[168:171], v[168:171], v[136:139]
    ds_read_b64_tr_b16 v[154:155], v16 offset:51200
    s_waitcnt lgkmcnt(6)
    v_mfma_f32_16x16x32_bf16 v[108:111], a[132:135], v[172:175], v[108:111]
    buffer_load_dwordx4 a[84:87], v5, s[20:23], s11 offen offset:1024 sc1
    v_mfma_f32_16x16x32_bf16 v[124:127], a[136:139], v[172:175], v[124:127]
    ds_read_b64_tr_b16 v[156:157], v17 offset:49152
    v_mfma_f32_16x16x32_bf16 v[140:143], v[172:175], v[172:175], v[140:143]
    ds_read_b64_tr_b16 v[158:159], v17 offset:51200
    s_waitcnt lgkmcnt(6)
    v_mfma_f32_16x16x32_bf16 v[112:115], a[132:135], v[176:179], v[112:115]
    v_mfma_f32_16x16x32_bf16 v[128:131], a[136:139], v[176:179], v[128:131]
    ds_read_b64_tr_b16 v[160:161], v18 offset:49152
    v_mfma_f32_16x16x32_bf16 v[144:147], v[176:179], v[176:179], v[144:147]
    ds_read_b64_tr_b16 v[162:163], v18 offset:51200
    buffer_load_dwordx4 a[88:91], v5, s[20:23], s11 offen offset:2048 sc1
    s_waitcnt lgkmcnt(6)
    v_mfma_f32_16x16x32_bf16 v[100:103], a[144:147], v[148:151], v[100:103]
    v_mfma_f32_16x16x32_bf16 v[116:119], a[148:151], v[148:151], v[116:119]
    ds_read_b64_tr_b16 v[164:165], v15 offset:53248
    v_mfma_f32_16x16x32_bf16 v[132:135], v[148:151], v[148:151], v[132:135]
    ds_read_b64_tr_b16 v[166:167], v15 offset:55296
    s_waitcnt lgkmcnt(6)
    v_mfma_f32_16x16x32_bf16 v[104:107], a[144:147], v[152:155], v[104:107]
    v_mfma_f32_16x16x32_bf16 v[120:123], a[148:151], v[152:155], v[120:123]
    ds_read_b64_tr_b16 v[168:169], v16 offset:53248
    buffer_load_dwordx4 a[92:95], v5, s[20:23], s11 offen offset:3072 sc1
    v_mfma_f32_16x16x32_bf16 v[136:139], v[152:155], v[152:155], v[136:139]
    ds_read_b64_tr_b16 v[170:171], v16 offset:55296
    s_waitcnt lgkmcnt(6)
    v_mfma_f32_16x16x32_bf16 v[108:111], a[144:147], v[156:159], v[108:111]
    v_mfma_f32_16x16x32_bf16 v[124:127], a[148:151], v[156:159], v[124:127]
    ds_read_b64_tr_b16 v[172:173], v17 offset:53248
    v_mfma_f32_16x16x32_bf16 v[140:143], v[156:159], v[156:159], v[140:143]
    ds_read_b64_tr_b16 v[174:175], v17 offset:55296
    s_waitcnt lgkmcnt(6)
    v_mfma_f32_16x16x32_bf16 v[112:115], a[144:147], v[160:163], v[112:115]
    s_add_u32 s11, s43, 40960
    buffer_load_dwordx4 a[96:99], v5, s[20:23], s11 offen offset:0 sc1
    v_mfma_f32_16x16x32_bf16 v[128:131], a[148:151], v[160:163], v[128:131]
    ds_read_b64_tr_b16 v[176:177], v18 offset:53248
    v_mfma_f32_16x16x32_bf16 v[144:147], v[160:163], v[160:163], v[144:147]
    ds_read_b64_tr_b16 v[178:179], v18 offset:55296
    s_waitcnt lgkmcnt(6)
    v_mfma_f32_16x16x32_bf16 v[100:103], a[156:159], v[164:167], v[100:103]
    v_mfma_f32_16x16x32_bf16 v[116:119], a[160:163], v[164:167], v[116:119]
    ds_read_b64_tr_b16 v[148:149], v15 offset:57344
    v_mfma_f32_16x16x32_bf16 v[132:135], v[164:167], v[164:167], v[132:135]
    ds_read_b64_tr_b16 v[150:151], v15 offset:59392
    buffer_load_dwordx4 a[100:103], v5, s[20:23], s11 offen offset:1024 sc1
    s_waitcnt lgkmcnt(6)
    v_mfma_f32_16x16x32_bf16 v[104:107], a[156:159], v[168:171], v[104:107]
    v_mfma_f32_16x16x32_bf16 v[120:123], a[160:163], v[168:171], v[120:123]
    ds_read_b64_tr_b16 v[152:153], v16 offset:57344
    v_mfma_f32_16x16x32_bf16 v[136:139], v[168:171], v[168:171], v[136:139]
    ds_read_b64_tr_b16 v[154:155], v16 offset:59392
    s_waitcnt lgkmcnt(6)
    v_mfma_f32_16x16x32_bf16 v[108:111], a[156:159], v[172:175], v[108:111]
    v_mfma_f32_16x16x32_bf16 v[124:127], a[160:163], v[172:175], v[124:127]
    ds_read_b64_tr_b16 v[156:157], v17 offset:57344
    buffer_load_dwordx4 a[104:107], v5, s[20:23], s11 offen offset:2048 sc1
    v_mfma_f32_16x16x32_bf16 v[140:143], v[172:175], v[172:175], v[140:143]
    ds_read_b64_tr_b16 v[158:159], v17 offset:59392
    s_waitcnt lgkmcnt(6)
    v_mfma_f32_16x16x32_bf16 v[112:115], a[156:159], v[176:179], v[112:115]
    v_mfma_f32_16x16x32_bf16 v[128:131], a[160:163], v[176:179], v[128:131]
    ds_read_b64_tr_b16 v[160:161], v18 offset:57344
    v_mfma_f32_16x16x32_bf16 v[144:147], v[176:179], v[176:179], v[144:147]
    ds_read_b64_tr_b16 v[162:163], v18 offset:59392
    s_waitcnt lgkmcnt(6)
    v_mfma_f32_16x16x32_bf16 v[100:103], a[168:171], v[148:151], v[100:103]
    buffer_load_dwordx4 a[108:111], v5, s[20:23], s11 offen offset:3072 sc1
    v_mfma_f32_16x16x32_bf16 v[116:119], a[172:175], v[148:151], v[116:119]
    ds_read_b64_tr_b16 v[164:165], v15 offset:61440
    v_mfma_f32_16x16x32_bf16 v[132:135], v[148:151], v[148:151], v[132:135]
    ds_read_b64_tr_b16 v[166:167], v15 offset:63488
    s_waitcnt lgkmcnt(6)
    v_mfma_f32_16x16x32_bf16 v[104:107], a[168:171], v[152:155], v[104:107]
    v_mfma_f32_16x16x32_bf16 v[120:123], a[172:175], v[152:155], v[120:123]
    ds_read_b64_tr_b16 v[168:169], v16 offset:61440
    v_mfma_f32_16x16x32_bf16 v[136:139], v[152:155], v[152:155], v[136:139]
    ds_read_b64_tr_b16 v[170:171], v16 offset:63488
    s_waitcnt lgkmcnt(6)
    v_mfma_f32_16x16x32_bf16 v[108:111], a[168:171], v[156:159], v[108:111]
    v_mfma_f32_16x16x32_bf16 v[124:127], a[172:175], v[156:159], v[124:127]
    ds_read_b64_tr_b16 v[172:173], v17 offset:61440
    v_mfma_f32_16x16x32_bf16 v[140:143], v[156:159], v[156:159], v[140:143]
    ds_read_b64_tr_b16 v[174:175], v17 offset:63488
    s_waitcnt lgkmcnt(6)
    v_mfma_f32_16x16x32_bf16 v[112:115], a[168:171], v[160:163], v[112:115]
    v_mfma_f32_16x16x32_bf16 v[128:131], a[172:175], v[160:163], v[128:131]
    ds_read_b64_tr_b16 v[176:177], v18 offset:61440
    v_mfma_f32_16x16x32_bf16 v[144:147], v[160:163], v[160:163], v[144:147]
    ds_read_b64_tr_b16 v[178:179], v18 offset:63488
    s_waitcnt lgkmcnt(6)
    v_mfma_f32_16x16x32_bf16 v[100:103], a[180:183], v[164:167], v[100:103]
    v_xor_b32 v15, 0x10000, v15
    s_mov_b32 s19, 33095680
    v_mfma_f32_16x16x32_bf16 v[116:119], a[184:187], v[164:167], v[116:119]
    buffer_load_dword v48, v28, s[20:23], s19 offen sc1
    v_mfma_f32_16x16x32_bf16 v[132:135], v[164:167], v[164:167], v[132:135]
    s_waitcnt lgkmcnt(4)
    v_mfma_f32_16x16x32_bf16 v[104:107], a[180:183], v[168:171], v[104:107]
    v_xor_b32 v16, 0x10000, v16
    v_mfma_f32_16x16x32_bf16 v[120:123], a[184:187], v[168:171], v[120:123]
    v_mfma_f32_16x16x32_bf16 v[136:139], v[168:171], v[168:171], v[136:139]
    s_waitcnt lgkmcnt(2)
    v_mfma_f32_16x16x32_bf16 v[108:111], a[180:183], v[172:175], v[108:111]
    v_xor_b32 v17, 0x10000, v17
    v_mfma_f32_16x16x32_bf16 v[124:127], a[184:187], v[172:175], v[124:127]
    v_mfma_f32_16x16x32_bf16 v[140:143], v[172:175], v[172:175], v[140:143]
    s_waitcnt lgkmcnt(0)
    v_mfma_f32_16x16x32_bf16 v[112:115], a[180:183], v[176:179], v[112:115]
    v_xor_b32 v18, 0x10000, v18
    v_mfma_f32_16x16x32_bf16 v[128:131], a[184:187], v[176:179], v[128:131]
    v_mfma_f32_16x16x32_bf16 v[144:147], v[176:179], v[176:179], v[144:147]
    v_cndmask_b32 v192, v132, v133, s[52:53]
    v_cndmask_b32 v192, v192, v134, s[54:55]
    v_cndmask_b32 v192, v192, v135, s[56:57]
    v_mov_b32 v180, v116
    v_cndmask_b32 v193, v136, v137, s[52:53]
    v_cndmask_b32 v193, v193, v138, s[54:55]
    v_cndmask_b32 v193, v193, v139, s[56:57]
    v_mov_b32 v181, v120
    v_cndmask_b32 v194, v140, v141, s[52:53]
    v_cndmask_b32 v194, v194, v142, s[54:55]
    v_cndmask_b32 v194, v194, v143, s[56:57]
    v_mov_b32 v182, v124
    v_cndmask_b32 v195, v144, v145, s[52:53]
    v_cndmask_b32 v195, v195, v146, s[54:55]
    v_cndmask_b32 v195, v195, v147, s[56:57]
    v_mov_b32 v183, v128
    s_mov_b64 exec, s[58:59]
    ds_write_b128 v19, v[192:195] offset:768
    s_mov_b64 exec, s[60:61]
    ds_write_b128 v19, v[180:183] offset:512
    s_mov_b64 exec, -1
    s_waitcnt lgkmcnt(0)
    s_barrier
    ds_read_b128 v[180:183], v19 offset:512
    ds_read_b128 v[192:195], v19 offset:768
    s_waitcnt lgkmcnt(1)
    v_mul_f32 v180, 0xbb000000, v180
    v_mul_f32 v181, 0xbb000000, v181
    v_mul_f32 v182, 0xbb000000, v182
    v_mul_f32 v183, 0xbb000000, v183
    s_waitcnt lgkmcnt(0)
    v_fma_f32 v192, v192, s49, v35
    v_fma_f32 v193, v193, s49, v35
    v_fma_f32 v194, v194, s49, v35
    v_fma_f32 v195, v195, s49, v35
    v_fma_f32 v192, -v180, v180, v192
    v_fma_f32 v193, -v181, v181, v193
    v_fma_f32 v194, -v182, v182, v194
    v_fma_f32 v195, -v183, v183, v195
    v_max_f32 v192, v35, v192
    v_max_f32 v193, v35, v193
    v_max_f32 v194, v35, v194
    v_max_f32 v195, v35, v195
    v_rsq_f32 v184, v192
    v_rsq_f32 v185, v193
    v_rsq_f32 v186, v194
    v_rsq_f32 v187, v195
    v_mul_f32 v188, v184, v184
    v_mul_f32 v189, v185, v185
    v_mul_f32 v190, v186, v186
    v_mul_f32 v191, v187, v187
    v_mul_f32 v188, v188, v184
    v_mul_f32 v189, v189, v185
    v_mul_f32 v190, v190, v186
    v_mul_f32 v191, v191, v187
    v_mul_f32 v184, 0xc0135761, v184
    v_mul_f32 v185, 0xc0135761, v185
    v_mul_f32 v186, 0xc0135761, v186
    v_mul_f32 v187, 0xc0135761, v187
    v_mul_f32 v188, 0xbdd2d3e8, v188
    v_mul_f32 v189, 0xbdd2d3e8, v189
    v_mul_f32 v190, 0xbdd2d3e8, v190
    v_mul_f32 v191, 0xbdd2d3e8, v191
    v_fmac_f32 v100, v36, v180
    v_fmac_f32 v101, v37, v180
    v_fmac_f32 v102, v38, v180
    v_fmac_f32 v103, v39, v180
    v_mul_f32 v196, v100, v100
    v_mul_f32 v197, v101, v101
    v_fma_f32 v196, v196, v188, v184
    v_fma_f32 v197, v197, v188, v184
    v_mul_f32 v196, v196, v100
    v_mul_f32 v197, v197, v101
    v_exp_f32 v196, v196
    v_exp_f32 v197, v197
    v_mul_f32 v100, v100, v102
    v_mul_f32 v101, v101, v103
    v_fma_f32 v196, v196, v192, v192
    v_fma_f32 v197, v197, v192, v192
    v_rcp_f32 v196, v196
    v_rcp_f32 v197, v197
    s_waitcnt vmcnt(0)
    v_cmp_gt_u32 vcc, s33, v48
    s_nop 1
    s_cbranch_vccz pok8
    s_mov_b32 s18, 40000
    s_mov_b32 s19, 33095680
psp8:
    s_sleep 2
    buffer_load_dword v48, v28, s[20:23], s19 offen sc1
    s_waitcnt vmcnt(0)
    v_cmp_gt_u32 vcc, s33, v48
    s_nop 1
    s_cbranch_vccz pok8
    s_sub_u32 s18, s18, 1
    s_cbranch_scc0 psp8
    s_endpgm
pok8:
    v_fmac_f32 v104, v36, v181
    v_fmac_f32 v105, v37, v181
    v_mul_f32 v100, v100, v196
    v_mul_f32 v101, v101, v197
    v_cvt_pk_bf16_f32 v200, v100, v101
    v_fmac_f32 v106, v38, v181
    s_add_u32 s14, s42, 0
    buffer_load_dwordx4 v[52:55], v21, s[20:23], s14 offen offset:0 sc1
    v_fmac_f32 v107, v39, v181
    v_mul_f32 v198, v104, v104
    v_mul_f32 v199, v105, v105
    v_fma_f32 v198, v198, v189, v185
    v_fma_f32 v199, v199, v189, v185
    v_mul_f32 v198, v198, v104
    buffer_load_dwordx4 v[56:59], v21, s[20:23], s14 offen offset:256 sc1
    v_mul_f32 v199, v199, v105
    v_exp_f32 v198, v198
    v_exp_f32 v199, v199
    v_mul_f32 v104, v104, v106
    v_mul_f32 v105, v105, v107
    v_fma_f32 v198, v198, v193, v193
    s_add_u32 s14, s42, 131072
    buffer_load_dwordx4 v[60:63], v21, s[20:23], s14 offen offset:0 sc1
    v_fma_f32 v199, v199, v193, v193
    v_rcp_f32 v198, v198
    v_rcp_f32 v199, v199
    v_fmac_f32 v108, v36, v182
    v_fmac_f32 v109, v37, v182
    v_mul_f32 v104, v104, v198
    buffer_load_dwordx4 v[64:67], v21, s[20:23], s14 offen offset:256 sc1
    v_mul_f32 v105, v105, v199
    v_cvt_pk_bf16_f32 v201, v104, v105
    v_fmac_f32 v110, v38, v182
    v_fmac_f32 v111, v39, v182
    v_mul_f32 v196, v108, v108
    v_mul_f32 v197, v109, v109
    s_add_u32 s14, s42, 262144
    buffer_load_dwordx4 v[68:71], v21, s[20:23], s14 offen offset:0 sc1
    v_fma_f32 v196, v196, v190, v186
    v_fma_f32 v197, v197, v190, v186
    v_mul_f32 v196, v196, v108
    v_mul_f32 v197, v197, v109
    v_exp_f32 v196, v196
    v_exp_f32 v197, v197
    buffer_load_dwordx4 v[72:75], v21, s[20:23], s14 offen offset:256 sc1
    v_mul_f32 v108, v108, v110
    v_mul_f32 v109, v109, v111
    v_fma_f32 v196, v196, v194, v194
    v_fma_f32 v197, v197, v194, v194
    v_rcp_f32 v196, v196
    v_rcp_f32 v197, v197
    s_add_u32 s14, s42, 393216
    buffer_load_dwordx4 v[76:79], v21, s[20:23], s14 offen offset:0 sc1
    v_fmac_f32 v112, v36, v183
    v_fmac_f32 v113, v37, v183
    v_mul_f32 v108, v108, v196
    v_mul_f32 v109, v109, v197
    v_cvt_pk_bf16_f32 v202, v108, v109
    v_fmac_f32 v114, v38, v183
    buffer_load_dwordx4 v[80:83], v21, s[20:23], s14 offen offset:256 sc1
    v_fmac_f32 v115, v39, v183
    v_mul_f32 v198, v112, v112
    v_mul_f32 v199, v113, v113
    v_fma_f32 v198, v198, v191, v187
    v_fma_f32 v199, v199, v191, v187
    v_mul_f32 v198, v198, v112
    s_add_u32 s14, s42, 524288
    buffer_load_dwordx4 v[84:87], v21, s[20:23], s14 offen offset:0 sc1
    v_mul_f32 v199, v199, v113
    v_exp_f32 v198, v198
    v_exp_f32 v199, v199
    v_mul_f32 v112, v112, v114
    v_mul_f32 v113, v113, v115
    v_fma_f32 v198, v198, v195, v195
    buffer_load_dwordx4 v[88:91], v21, s[20:23], s14 offen offset:256 sc1
    v_fma_f32 v199, v199, v195, v195
    v_rcp_f32 v198, v198
    v_rcp_f32 v199, v199
    v_mul_f32 v112, v112, v198
    v_mul_f32 v113, v113, v199
    v_cvt_pk_bf16_f32 v203, v112, v113
    s_add_u32 s14, s42, 655360
    buffer_load_dwordx4 v[92:95], v21, s[20:23], s14 offen offset:0 sc1
    v_fmac_f32 v116, v40, v180
    v_fmac_f32 v117, v41, v180
    v_fmac_f32 v118, v42, v180
    v_fmac_f32 v119, v43, v180
    v_mul_f32 v196, v116, v116
    v_mul_f32 v197, v117, v117
    buffer_load_dwordx4 v[96:99], v21, s[20:23], s14 offen offset:256 sc1
    v_fma_f32 v196, v196, v188, v184
    v_fma_f32 v197, v197, v188, v184
    v_mul_f32 v196, v196, v116
    v_mul_f32 v197, v197, v117
    v_exp_f32 v196, v196
    v_exp_f32 v197, v197
    s_add_u32 s14, s42, 786432
    buffer_load_dwordx4 v[148:151], v21, s[20:23], s14 offen offset:0 sc1
    v_mul_f32 v116, v116, v118
    v_mul_f32 v117, v117, v119
    v_fma_f32 v196, v196, v192, v192
    v_fma_f32 v197, v197, v192, v192
    v_rcp_f32 v196, v196
    v_rcp_f32 v197, v197
    buffer_load_dwordx4 v[152:155], v21, s[20:23], s14 offen offset:256 sc1
    v_fmac_f32 v120, v40, v181
    v_fmac_f32 v121, v41, v181
    v_mul_f32 v116, v116, v196
    v_mul_f32 v117, v117, v197
    v_cvt_pk_bf16_f32 v204, v116, v117
    v_fmac_f32 v122, v42, v181
    s_add_u32 s14, s42, 917504
    buffer_load_dwordx4 v[156:159], v21, s[20:23], s14 offen offset:0 sc1
    v_fmac_f32 v123, v43, v181
    v_mul_f32 v198, v120, v120
    v_mul_f32 v199, v121, v121
    v_fma_f32 v198, v198, v189, v185
    v_fma_f32 v199, v199, v189, v185
    v_mul_f32 v198, v198, v120
    buffer_load_dwordx4 v[160:163], v21, s[20:23], s14 offen offset:256 sc1
    v_mul_f32 v199, v199, v121
    v_exp_f32 v198, v198
    v_exp_f32 v199, v199
    v_mul_f32 v120, v120, v122
    v_mul_f32 v121, v121, v123
    v_fma_f32 v198, v198, v193, v193
    s_add_u32 s14, s42, 1048576
    buffer_load_dwordx4 v[164:167], v21, s[20:23], s14 offen offset:0 sc1
    v_fma_f32 v199, v199, v193, v193
    v_rcp_f32 v198, v198
    v_rcp_f32 v199, v199
    v_fmac_f32 v124, v40, v182
    v_fmac_f32 v125, v41, v182
    v_mul_f32 v120, v120, v198
    buffer_load_dwordx4 v[168:171], v21, s[20:23], s14 offen offset:256 sc1
    v_mul_f32 v121, v121, v199
    v_cvt_pk_bf16_f32 v205, v120, v121
    v_fmac_f32 v126, v42, v182
    v_fmac_f32 v127, v43, v182
    v_mul_f32 v196, v124, v124
    v_mul_f32 v197, v125, v125
    s_add_u32 s14, s42, 1179648
    buffer_load_dwordx4 v[172:175], v21, s[20:23], s14 offen offset:0 sc1
    v_fma_f32 v196, v196, v190, v186
    v_fma_f32 v197, v197, v190, v186
    v_mul_f32 v196, v196, v124
    v_mul_f32 v197, v197, v125
    v_exp_f32 v196, v196
    v_exp_f32 v197, v197
    buffer_load_dwordx4 v[176:179], v21, s[20:23], s14 offen offset:256 sc1
    v_mul_f32 v124, v124, v126
    v_mul_f32 v125, v125, v127
    v_fma_f32 v196, v196, v194, v194
    v_fma_f32 v197, v197, v194, v194
    v_rcp_f32 v196, v196
    v_rcp_f32 v197, v197
    s_add_u32 s14, s42, 1310720
    buffer_load_dwordx4 v[232:235], v21, s[20:23], s14 offen offset:0 sc1
    v_fmac_f32 v128, v40, v183
    v_fmac_f32 v129, v41, v183
    v_mul_f32 v124, v124, v196
    v_mul_f32 v125, v125, v197
    v_cvt_pk_bf16_f32 v206, v124, v125
    v_fmac_f32 v130, v42, v183
    buffer_load_dwordx4 v[236:239], v21, s[20:23], s14 offen offset:256 sc1
    v_fmac_f32 v131, v43, v183
    v_mul_f32 v198, v128, v128
    v_mul_f32 v199, v129, v129
    v_fma_f32 v198, v198, v191, v187
    v_fma_f32 v199, v199, v191, v187
    v_mul_f32 v198, v198, v128
    buffer_load_dwordx4 v[240:243], v23, s[20:23], s44 offen offset:0 sc1
    v_mul_f32 v199, v199, v129
    v_exp_f32 v198, v198
    v_exp_f32 v199, v199
    v_mul_f32 v128, v128, v130
    v_mul_f32 v129, v129, v131
    v_fma_f32 v198, v198, v195, v195
    v_fma_f32 v199, v199, v195, v195
    v_rcp_f32 v198, v198
    v_rcp_f32 v199, v199
    v_mul_f32 v128, v128, v198
    v_mul_f32 v129, v129, v199
    v_cvt_pk_bf16_f32 v207, v128, v129
    v_permlane32_swap_b32 v200, v202
    v_permlane32_swap_b32 v201, v203
    s_add_u32 s13, s41, 16384
    s_nop 0
    v_permlane16_swap_b32 v200, v201
    v_permlane16_swap_b32 v202, v203
    buffer_store_dwordx4 v[200:203], v20, s[20:23], s13 offen sc1
    v_permlane32_swap_b32 v204, v206
    v_permlane32_swap_b32 v205, v207
    s_add_u32 s13, s41, 49152
    s_nop 0
    v_permlane16_swap_b32 v204, v205
    v_permlane16_swap_b32 v206, v207
    v_mov_b32 v207, 0
    buffer_store_dwordx4 v[204:207], v20, s[20:23], s13 offen sc1
    s_waitcnt vmcnt(24)
    v_mfma_f32_16x16x32_bf16 v[100:103], v[52:55], a[192:195], 0
    v_mfma_f32_16x16x32_bf16 v[104:107], v[52:55], a[196:199], 0
    v_mfma_f32_16x16x32_bf16 v[108:111], v[52:55], a[200:203], 0
    v_mfma_f32_16x16x32_bf16 v[112:115], v[52:55], a[204:207], 0
    s_waitcnt vmcnt(23)
    v_mfma_f32_16x16x32_bf16 v[116:119], v[56:59], a[192:195], 0
    v_mfma_f32_16x16x32_bf16 v[120:123], v[56:59], a[196:199], 0
    v_mfma_f32_16x16x32_bf16 v[124:127], v[56:59], a[200:203], 0
    v_mfma_f32_16x16x32_bf16 v[128:131], v[56:59], a[204:207], 0
    s_waitcnt vmcnt(22)
    v_mfma_f32_16x16x32_bf16 v[100:103], v[60:63], a[208:211], v[100:103]
    v_mfma_f32_16x16x32_bf16 v[104:107], v[60:63], a[212:215], v[104:107]
    v_mfma_f32_16x16x32_bf16 v[108:111], v[60:63], a[216:219], v[108:111]
    v_mfma_f32_16x16x32_bf16 v[112:115], v[60:63], a[220:223], v[112:115]
    s_waitcnt vmcnt(21)
    v_mfma_f32_16x16x32_bf16 v[116:119], v[64:67], a[208:211], v[116:119]
    v_mfma_f32_16x16x32_bf16 v[120:123], v[64:67], a[212:215], v[120:123]
    v_mfma_f32_16x16x32_bf16 v[124:127], v[64:67], a[216:219], v[124:127]
    v_mfma_f32_16x16x32_bf16 v[128:131], v[64:67], a[220:223], v[128:131]
    s_waitcnt vmcnt(20)
    v_mfma_f32_16x16x32_bf16 v[100:103], v[68:71], a[224:227], v[100:103]
    v_mfma_f32_16x16x32_bf16 v[104:107], v[68:71], a[228:231], v[104:107]
    v_mfma_f32_16x16x32_bf16 v[108:111], v[68:71], a[232:235], v[108:111]
    v_mfma_f32_16x16x32_bf16 v[112:115], v[68:71], a[236:239], v[112:115]
    s_waitcnt vmcnt(19)
    v_mfma_f32_16x16x32_bf16 v[116:119], v[72:75], a[224:227], v[116:119]
    v_mfma_f32_16x16x32_bf16 v[120:123], v[72:75], a[228:231], v[120:123]
    v_mfma_f32_16x16x32_bf16 v[124:127], v[72:75], a[232:235], v[124:127]
    v_mfma_f32_16x16x32_bf16 v[128:131], v[72:75], a[236:239], v[128:131]
    s_waitcnt vmcnt(18)
    v_mfma_f32_16x16x32_bf16 v[100:103], v[76:79], a[240:243], v[100:103]
    v_mfma_f32_16x16x32_bf16 v[104:107], v[76:79], a[244:247], v[104:107]
    v_mfma_f32_16x16x32_bf16 v[108:111], v[76:79], a[248:251], v[108:111]
    v_mfma_f32_16x16x32_bf16 v[112:115], v[76:79], a[252:255], v[112:115]
    s_waitcnt vmcnt(17)
    v_mfma_f32_16x16x32_bf16 v[116:119], v[80:83], a[240:243], v[116:119]
    v_mfma_f32_16x16x32_bf16 v[120:123], v[80:83], a[244:247], v[120:123]
    v_mfma_f32_16x16x32_bf16 v[124:127], v[80:83], a[248:251], v[124:127]
    v_mfma_f32_16x16x32_bf16 v[128:131], v[80:83], a[252:255], v[128:131]
    buffer_store_dwordx4 v[200:203], v33, s[20:23], s13 offen sc1
g1j:
    s_waitcnt vmcnt(17)
    v_mfma_f32_16x16x32_bf16 v[100:103], v[84:87], a[0:3], v[100:103]
    v_mfma_f32_16x16x32_bf16 v[104:107], v[84:87], a[4:7], v[104:107]
    v_mfma_f32_16x16x32_bf16 v[108:111], v[84:87], a[8:11], v[108:111]
    v_mfma_f32_16x16x32_bf16 v[112:115], v[84:87], a[12:15], v[112:115]
    s_waitcnt vmcnt(16)
    v_mfma_f32_16x16x32_bf16 v[116:119], v[88:91], a[0:3], v[116:119]
    v_mfma_f32_16x16x32_bf16 v[120:123], v[88:91], a[4:7], v[120:123]
    v_mfma_f32_16x16x32_bf16 v[124:127], v[88:91], a[8:11], v[124:127]
    v_mfma_f32_16x16x32_bf16 v[128:131], v[88:91], a[12:15], v[128:131]
    s_waitcnt vmcnt(15)
    v_mfma_f32_16x16x32_bf16 v[100:103], v[92:95], a[16:19], v[100:103]
    v_mfma_f32_16x16x32_bf16 v[104:107], v[92:95], a[20:23], v[104:107]
    v_mfma_f32_16x16x32_bf16 v[108:111], v[92:95], a[24:27], v[108:111]
    v_mfma_f32_16x16x32_bf16 v[112:115], v[92:95], a[28:31], v[112:115]
    s_waitcnt vmcnt(14)
    v_mfma_f32_16x16x32_bf16 v[116:119], v[96:99], a[16:19], v[116:119]
    v_mfma_f32_16x16x32_bf16 v[120:123], v[96:99], a[20:23], v[120:123]
    v_mfma_f32_16x16x32_bf16 v[124:127], v[96:99], a[24:27], v[124:127]
    v_mfma_f32_16x16x32_bf16 v[128:131], v[96:99], a[28:31], v[128:131]
    s_waitcnt vmcnt(13)
    v_mfma_f32_16x16x32_bf16 v[100:103], v[148:151], a[32:35], v[100:103]
    v_mfma_f32_16x16x32_bf16 v[104:107], v[148:151], a[36:39], v[104:107]
    v_mfma_f32_16x16x32_bf16 v[108:111], v[148:151], a[40:43], v[108:111]
    v_mfma_f32_16x16x32_bf16 v[112:115], v[148:151], a[44:47], v[112:115]
    s_waitcnt vmcnt(12)
    v_mfma_f32_16x16x32_bf16 v[116:119], v[152:155], a[32:35], v[116:119]
    v_mfma_f32_16x16x32_bf16 v[120:123], v[152:155], a[36:39], v[120:123]
    v_mfma_f32_16x16x32_bf16 v[124:127], v[152:155], a[40:43], v[124:127]
    v_mfma_f32_16x16x32_bf16 v[128:131], v[152:155], a[44:47], v[128:131]
    s_waitcnt vmcnt(11)
    v_mfma_f32_16x16x32_bf16 v[100:103], v[156:159], a[48:51], v[100:103]
    v_mfma_f32_16x16x32_bf16 v[104:107], v[156:159], a[52:55], v[104:107]
    v_mfma_f32_16x16x32_bf16 v[108:111], v[156:159], a[56:59], v[108:111]
    v_mfma_f32_16x16x32_bf16 v[112:115], v[156:159], a[60:63], v[112:115]
    s_waitcnt vmcnt(10)
    v_mfma_f32_16x16x32_bf16 v[116:119], v[160:163], a[48:51], v[116:119]
    v_mfma_f32_16x16x32_bf16 v[120:123], v[160:163], a[52:55], v[120:123]
    v_mfma_f32_16x16x32_bf16 v[124:127], v[160:163], a[56:59], v[124:127]
    v_mfma_f32_16x16x32_bf16 v[128:131], v[160:163], a[60:63], v[128:131]
    s_waitcnt vmcnt(9)
    v_mfma_f32_16x16x32_bf16 v[100:103], v[164:167], a[64:67], v[100:103]
    s_add_u32 s19, s47, 33128448
    v_mfma_f32_16x16x32_bf16 v[104:107], v[164:167], a[68:71], v[104:107]
    s_waitcnt vmcnt(0)
    s_barrier
    v_mfma_f32_16x16x32_bf16 v[108:111], v[164:167], a[72:75], v[108:111]
    buffer_store_dword v32, v31, s[20:23], s19 offen sc1
    v_mfma_f32_16x16x32_bf16 v[112:115], v[164:167], a[76:79], v[112:115]
    v_mfma_f32_16x16x32_bf16 v[116:119], v[168:171], a[64:67], v[116:119]
    v_mfma_f32_16x16x32_bf16 v[120:123], v[168:171], a[68:71], v[120:123]
    v_mfma_f32_16x16x32_bf16 v[124:127], v[168:171], a[72:75], v[124:127]
    v_mfma_f32_16x16x32_bf16 v[128:131], v[168:171], a[76:79], v[128:131]
    v_mfma_f32_16x16x32_bf16 v[100:103], v[172:175], a[80:83], v[100:103]
    v_mfma_f32_16x16x32_bf16 v[104:107], v[172:175], a[84:87], v[104:107]
    v_mfma_f32_16x16x32_bf16 v[108:111], v[172:175], a[88:91], v[108:111]
    v_mfma_f32_16x16x32_bf16 v[112:115], v[172:175], a[92:95], v[112:115]
    v_mfma_f32_16x16x32_bf16 v[116:119], v[176:179], a[80:83], v[116:119]
    v_mfma_f32_16x16x32_bf16 v[120:123], v[176:179], a[84:87], v[120:123]
    v_mfma_f32_16x16x32_bf16 v[124:127], v[176:179], a[88:91], v[124:127]
    v_mfma_f32_16x16x32_bf16 v[128:131], v[176:179], a[92:95], v[128:131]
    v_mfma_f32_16x16x32_bf16 v[100:103], v[232:235], a[96:99], v[100:103]
    v_mfma_f32_16x16x32_bf16 v[104:107], v[232:235], a[100:103], v[104:107]
    v_mfma_f32_16x16x32_bf16 v[108:111], v[232:235], a[104:107], v[108:111]
    v_mfma_f32_16x16x32_bf16 v[112:115], v[232:235], a[108:111], v[112:115]
    v_mfma_f32_16x16x32_bf16 v[116:119], v[236:239], a[96:99], v[116:119]
    v_mfma_f32_16x16x32_bf16 v[120:123], v[236:239], a[100:103], v[120:123]
    v_mfma_f32_16x16x32_bf16 v[124:127], v[236:239], a[104:107], v[124:127]
    v_mfma_f32_16x16x32_bf16 v[128:131], v[236:239], a[108:111], v[128:131]
    s_cmp_eq_u32 s32, 1
    s_nop 5
    s_cbranch_scc1 fin
    v_xor_b32 v133, 8192, v22
    v_xor_b32 v134, 16384, v22
    v_xor_b32 v135, 24576, v22
    ds_write_b128 v22, v[104:107] offset:2048
    ds_write_b128 v22, v[120:123] offset:3072
    ds_write_b128 v22, v[108:111] offset:4096
    ds_write_b128 v22, v[124:127] offset:5120
    ds_write_b128 v22, v[112:115] offset:6144
    ds_write_b128 v22, v[128:131] offset:7168
    v_lshlrev_b32 v136, 16, v240
    v_and_b32 v137, 0xffff0000, v240
    v_add_f32 v100, v100, v136
    v_add_f32 v101, v101, v137
    v_lshlrev_b32 v136, 16, v241
    v_and_b32 v137, 0xffff0000, v241
    v_add_f32 v102, v102, v136
    v_add_f32 v103, v103, v137
    v_lshlrev_b32 v136, 16, v242
    v_and_b32 v137, 0xffff0000, v242
    v_add_f32 v116, v116, v136
    v_add_f32 v117, v117, v137
    v_lshlrev_b32 v136, 16, v243
    v_and_b32 v137, 0xffff0000, v243
    v_add_f32 v118, v118, v136
    v_add_f32 v119, v119, v137
    s_waitcnt lgkmcnt(0)
    s_barrier
    ds_read_b128 v[180:183], v133 offset:2048
    ds_read_b128 v[184:187], v134 offset:4096
    ds_read_b128 v[188:191], v135 offset:6144
    ds_read_b128 v[192:195], v133 offset:3072
    ds_read_b128 v[196:199], v134 offset:5120
    ds_read_b128 v[200:203], v135 offset:7168
    s_waitcnt lgkmcnt(5)
    v_add_f32 v100, v100, v180
    v_add_f32 v101, v101, v181
    v_add_f32 v102, v102, v182
    v_add_f32 v103, v103, v183
    s_waitcnt lgkmcnt(4)
    v_add_f32 v100, v100, v184
    v_add_f32 v101, v101, v185
    v_add_f32 v102, v102, v186
    v_add_f32 v103, v103, v187
    s_waitcnt lgkmcnt(3)
    v_add_f32 v100, v100, v188
    v_add_f32 v101, v101, v189
    v_add_f32 v102, v102, v190
    v_add_f32 v103, v103, v191
    v_cvt_pk_bf16_f32 v140, v100, v101
    v_cvt_pk_bf16_f32 v141, v102, v103
    s_waitcnt lgkmcnt(2)
    v_add_f32 v116, v116, v192
    v_add_f32 v117, v117, v193
    v_add_f32 v118, v118, v194
    v_add_f32 v119, v119, v195
    s_waitcnt lgkmcnt(1)
    v_add_f32 v116, v116, v196
    v_add_f32 v117, v117, v197
    v_add_f32 v118, v118, v198
    v_add_f32 v119, v119, v199
    s_waitcnt lgkmcnt(0)
    v_add_f32 v116, v116, v200
    v_add_f32 v117, v117, v201
    v_add_f32 v118, v118, v202
    v_add_f32 v119, v119, v203
    v_cvt_pk_bf16_f32 v142, v116, v117
    v_cvt_pk_bf16_f32 v143, v118, v119
    s_add_u32 s15, s44, 2097152
    buffer_store_dwordx4 v[140:143], v23, s[20:23], s15 offen offset:0 sc1
    v_mul_f32 v180, v100, v100
    v_mul_f32 v181, v101, v101
    v_mul_f32 v182, v102, v102
    v_mul_f32 v183, v103, v103
    v_mul_f32 v184, v116, v116
    v_mul_f32 v185, v117, v117
    v_mul_f32 v186, v118, v118
    v_mul_f32 v187, v119, v119
    v_add_f32_dpp v100, v100, v100 row_ror:8 row_mask:0xf bank_mask:0x3
    v_add_f32_dpp v101, v101, v101 row_ror:8 row_mask:0xf bank_mask:0x3
    v_add_f32_dpp v102, v102, v102 row_ror:8 row_mask:0xf bank_mask:0x3
    v_add_f32_dpp v103, v103, v103 row_ror:8 row_mask:0xf bank_mask:0x3
    v_add_f32_dpp v116, v116, v116 row_ror:8 row_mask:0xf bank_mask:0x3
    v_add_f32_dpp v117, v117, v117 row_ror:8 row_mask:0xf bank_mask:0x3
    v_add_f32_dpp v118, v118, v118 row_ror:8 row_mask:0xf bank_mask:0x3
    v_add_f32_dpp v119, v119, v119 row_ror:8 row_mask:0xf bank_mask:0x3
    v_add_f32_dpp v100, v180, v180 row_ror:8 row_mask:0xf bank_mask:0xc
    v_add_f32_dpp v101, v181, v181 row_ror:8 row_mask:0xf bank_mask:0xc
    v_add_f32_dpp v102, v182, v182 row_ror:8 row_mask:0xf bank_mask:0xc
    v_add_f32_dpp v103, v183, v183 row_ror:8 row_mask:0xf bank_mask:0xc
    v_add_f32_dpp v116, v184, v184 row_ror:8 row_mask:0xf bank_mask:0xc
    v_add_f32_dpp v117, v185, v185 row_ror:8 row_mask:0xf bank_mask:0xc
    v_add_f32_dpp v118, v186, v186 row_ror:8 row_mask:0xf bank_mask:0xc
    v_add_f32_dpp v119, v187, v187 row_ror:8 row_mask:0xf bank_mask:0xc
    v_add_f32_dpp v100, v100, v100 row_half_mirror row_mask:0xf bank_mask:0x5
    v_add_f32_dpp v101, v101, v101 row_half_mirror row_mask:0xf bank_mask:0x5
    v_add_f32_dpp v102, v102, v102 row_half_mirror row_mask:0xf bank_mask:0x5
    v_add_f32_dpp v103, v103, v103 row_half_mirror row_mask:0xf bank_mask:0x5
    v_add_f32_dpp v100, v116, v116 row_half_mirror row_mask:0xf bank_mask:0xa
    v_add_f32_dpp v101, v117, v117 row_half_mirror row_mask:0xf bank_mask:0xa
    v_add_f32_dpp v102, v118, v118 row_half_mirror row_mask:0xf bank_mask:0xa
    v_add_f32_dpp v103, v119, v119 row_half_mirror row_mask:0xf bank_mask:0xa
    v_add_f32_dpp v100, v100, v100 quad_perm:[1,0,3,2] row_mask:0xf bank_mask:0xf
    v_add_f32_dpp v101, v101, v101 quad_perm:[1,0,3,2] row_mask:0xf bank_mask:0xf
    v_add_f32_dpp v102, v102, v102 quad_perm:[1,0,3,2] row_mask:0xf bank_mask:0xf
    v_add_f32_dpp v103, v103, v103 quad_perm:[1,0,3,2] row_mask:0xf bank_mask:0xf
    v_add_f32_dpp v100, v100, v100 quad_perm:[2,3,0,1] row_mask:0xf bank_mask:0xf
    v_add_f32_dpp v101, v101, v101 quad_perm:[2,3,0,1] row_mask:0xf bank_mask:0xf
    v_add_f32_dpp v102, v102, v102 quad_perm:[2,3,0,1] row_mask:0xf bank_mask:0xf
    v_add_f32_dpp v103, v103, v103 quad_perm:[2,3,0,1] row_mask:0xf bank_mask:0xf
    s_add_u32 s15, s45, 0
    v_cndmask_b32 v100, v100, v101, s[52:53]
    v_cndmask_b32 v100, v100, v102, s[54:55]
    v_cndmask_b32 v100, v100, v103, s[56:57]
    ds_write_b32 v252, v100 offset:0
    s_waitcnt lgkmcnt(0)
    s_barrier
    ds_read_b128 v[180:183], v253 offset:0
    s_waitcnt lgkmcnt(0)
    v_add_f32 v180, v180, v181
    v_add_f32 v182, v182, v183
    v_add_f32 v180, v180, v182
    buffer_atomic_add_f32 v180, v24, s[20:23], s15 offen sc1
    s_mov_b32 s19, 33128448
    buffer_load_dword v48, v28, s[20:23], s19 offen sc1
    s_add_u32 s19, s48, 33161216
    s_waitcnt vmcnt(1)
    s_barrier
    buffer_store_dword v32, v30, s[20:23], s19 offen sc1
    s_waitcnt vmcnt(1)
    v_cmp_gt_u32 vcc, s33, v48
    s_nop 1
    s_cbranch_vccz pok9
    s_mov_b32 s18, 40000
    s_mov_b32 s19, 33128448
psp9:
    s_sleep 2
    buffer_load_dword v48, v28, s[20:23], s19 offen sc1
    s_waitcnt vmcnt(0)
    v_cmp_gt_u32 vcc, s33, v48
    s_nop 1
    s_cbranch_vccz pok9
    s_sub_u32 s18, s18, 1
    s_cbranch_scc0 psp9
    s_endpgm
pok9:
    s_add_u32 s14, s42, 16384
    buffer_load_dwordx4 v[52:55], v21, s[20:23], s14 offen offset:0 sc1
    buffer_load_dwordx4 v[56:59], v21, s[20:23], s14 offen offset:256 sc1
    s_add_u32 s14, s42, 147456
    buffer_load_dwordx4 v[60:63], v21, s[20:23], s14 offen offset:0 sc1
    buffer_load_dwordx4 v[64:67], v21, s[20:23], s14 offen offset:256 sc1
    s_add_u32 s14, s42, 278528
    buffer_load_dwordx4 v[68:71], v21, s[20:23], s14 offen offset:0 sc1
    buffer_load_dwordx4 v[72:75], v21, s[20:23], s14 offen offset:256 sc1
    s_add_u32 s14, s42, 409600
    buffer_load_dwordx4 v[76:79], v21, s[20:23], s14 offen offset:0 sc1
    buffer_load_dwordx4 v[80:83], v21, s[20:23], s14 offen offset:256 sc1
    s_add_u32 s14, s42, 540672
    buffer_load_dwordx4 v[84:87], v21, s[20:23], s14 offen offset:0 sc1
    buffer_load_dwordx4 v[88:91], v21, s[20:23], s14 offen offset:256 sc1
    s_add_u32 s14, s42, 671744
    buffer_load_dwordx4 v[92:95], v21, s[20:23], s14 offen offset:0 sc1
    buffer_load_dwordx4 v[96:99], v21, s[20:23], s14 offen offset:256 sc1
    s_add_u32 s14, s42, 802816
    buffer_load_dwordx4 v[148:151], v21, s[20:23], s14 offen offset:0 sc1
    buffer_load_dwordx4 v[152:155], v21, s[20:23], s14 offen offset:256 sc1
    s_add_u32 s14, s42, 933888
    buffer_load_dwordx4 v[156:159], v21, s[20:23], s14 offen offset:0 sc1
    buffer_load_dwordx4 v[160:163], v21, s[20:23], s14 offen offset:256 sc1
    s_add_u32 s14, s42, 1064960
    buffer_load_dwordx4 v[164:167], v21, s[20:23], s14 offen offset:0 sc1
    buffer_load_dwordx4 v[168:171], v21, s[20:23], s14 offen offset:256 sc1
    s_add_u32 s14, s42, 1196032
    buffer_load_dwordx4 v[172:175], v21, s[20:23], s14 offen offset:0 sc1
    buffer_load_dwordx4 v[176:179], v21, s[20:23], s14 offen offset:256 sc1
    s_add_u32 s14, s42, 1327104
    buffer_load_dwordx4 v[232:235], v21, s[20:23], s14 offen offset:0 sc1
    buffer_load_dwordx4 v[236:239], v21, s[20:23], s14 offen offset:256 sc1
    buffer_load_dwordx4 v[240:243], v23, s[20:23], s44 offen offset:2048 sc1
    s_waitcnt vmcnt(22)
    v_mfma_f32_16x16x32_bf16 v[100:103], v[52:55], a[192:195], 0
    v_mfma_f32_16x16x32_bf16 v[104:107], v[52:55], a[196:199], 0
    v_mfma_f32_16x16x32_bf16 v[108:111], v[52:55], a[200:203], 0
    v_mfma_f32_16x16x32_bf16 v[112:115], v[52:55], a[204:207], 0
    s_waitcnt vmcnt(21)
    v_mfma_f32_16x16x32_bf16 v[116:119], v[56:59], a[192:195], 0
    v_mfma_f32_16x16x32_bf16 v[120:123], v[56:59], a[196:199], 0
    v_mfma_f32_16x16x32_bf16 v[124:127], v[56:59], a[200:203], 0
    v_mfma_f32_16x16x32_bf16 v[128:131], v[56:59], a[204:207], 0
    s_waitcnt vmcnt(20)
    v_mfma_f32_16x16x32_bf16 v[100:103], v[60:63], a[208:211], v[100:103]
    ds_read2_b32 a[192:193], v246 offset0:176 offset1:177
    v_mfma_f32_16x16x32_bf16 v[104:107], v[60:63], a[212:215], v[104:107]
    ds_read2_b32 a[194:195], v246 offset0:178 offset1:179
    v_mfma_f32_16x16x32_bf16 v[108:111], v[60:63], a[216:219], v[108:111]
    ds_read2_b32 a[196:197], v246 offset0:48 offset1:49
    v_mfma_f32_16x16x32_bf16 v[112:115], v[60:63], a[220:223], v[112:115]
    ds_read2_b32 a[198:199], v246 offset0:50 offset1:51
    s_waitcnt vmcnt(19)
    v_mfma_f32_16x16x32_bf16 v[116:119], v[64:67], a[208:211], v[116:119]
    ds_read2_b32 a[200:201], v245 offset0:176 offset1:177
    v_mfma_f32_16x16x32_bf16 v[120:123], v[64:67], a[212:215], v[120:123]
    ds_read2_b32 a[202:203], v245 offset0:178 offset1:179
    v_mfma_f32_16x16x32_bf16 v[124:127], v[64:67], a[216:219], v[124:127]
    ds_read2_b32 a[204:205], v245 offset0:48 offset1:49
    v_mfma_f32_16x16x32_bf16 v[128:131], v[64:67], a[220:223], v[128:131]
    ds_read2_b32 a[206:207], v245 offset0:50 offset1:51
    s_waitcnt vmcnt(18)
    v_mfma_f32_16x16x32_bf16 v[100:103], v[68:71], a[224:227], v[100:103]
    ds_read2_b32 a[208:209], v246 offset0:160 offset1:161
    v_mfma_f32_16x16x32_bf16 v[104:107], v[68:71], a[228:231], v[104:107]
    ds_read2_b32 a[210:211], v246 offset0:162 offset1:163
    v_mfma_f32_16x16x32_bf16 v[108:111], v[68:71], a[232:235], v[108:111]
    ds_read2_b32 a[212:213], v246 offset0:32 offset1:33
    v_mfma_f32_16x16x32_bf16 v[112:115], v[68:71], a[236:239], v[112:115]
    ds_read2_b32 a[214:215], v246 offset0:34 offset1:35
    s_waitcnt vmcnt(17)
    v_mfma_f32_16x16x32_bf16 v[116:119], v[72:75], a[224:227], v[116:119]
    ds_read2_b32 a[216:217], v245 offset0:160 offset1:161
    v_mfma_f32_16x16x32_bf16 v[120:123], v[72:75], a[228:231], v[120:123]
    ds_read2_b32 a[218:219], v245 offset0:162 offset1:163
    v_mfma_f32_16x16x32_bf16 v[124:127], v[72:75], a[232:235], v[124:127]
    ds_read2_b32 a[220:221], v245 offset0:32 offset1:33
    v_mfma_f32_16x16x32_bf16 v[128:131], v[72:75], a[236:239], v[128:131]
    ds_read2_b32 a[222:223], v245 offset0:34 offset1:35
    s_waitcnt vmcnt(16)
    v_mfma_f32_16x16x32_bf16 v[100:103], v[76:79], a[240:243], v[100:103]
    ds_read2_b32 a[224:225], v246 offset0:144 offset1:145
    v_mfma_f32_16x16x32_bf16 v[104:107], v[76:79], a[244:247], v[104:107]
    ds_read2_b32 a[226:227], v246 offset0:146 offset1:147
    v_mfma_f32_16x16x32_bf16 v[108:111], v[76:79], a[248:251], v[108:111]
    ds_read2_b32 a[228:229], v246 offset0:16 offset1:17
    v_mfma_f32_16x16x32_bf16 v[112:115], v[76:79], a[252:255], v[112:115]
    ds_read2_b32 a[230:231], v246 offset0:18 offset1:19
    s_waitcnt vmcnt(15)
    v_mfma_f32_16x16x32_bf16 v[116:119], v[80:83], a[240:243], v[116:119]
    ds_read2_b32 a[232:233], v245 offset0:144 offset1:145
    v_mfma_f32_16x16x32_bf16 v[120:123], v[80:83], a[244:247], v[120:123]
    ds_read2_b32 a[234:235], v245 offset0:146 offset1:147
    v_mfma_f32_16x16x32_bf16 v[124:127], v[80:83], a[248:251], v[124:127]
    ds_read2_b32 a[236:237], v245 offset0:16 offset1:17
    v_mfma_f32_16x16x32_bf16 v[128:131], v[80:83], a[252:255], v[128:131]
    ds_read2_b32 a[238:239], v245 offset0:18 offset1:19
    s_waitcnt vmcnt(14)
    v_mfma_f32_16x16x32_bf16 v[100:103], v[84:87], a[0:3], v[100:103]
    ds_read2_b32 a[240:241], v246 offset0:128 offset1:129
    v_mfma_f32_16x16x32_bf16 v[104:107], v[84:87], a[4:7], v[104:107]
    ds_read2_b32 a[242:243], v246 offset0:130 offset1:131
    v_mfma_f32_16x16x32_bf16 v[108:111], v[84:87], a[8:11], v[108:111]
    ds_read2_b32 a[244:245], v246 offset0:0 offset1:1
    v_mfma_f32_16x16x32_bf16 v[112:115], v[84:87], a[12:15], v[112:115]
    ds_read2_b32 a[246:247], v246 offset0:2 offset1:3
    s_waitcnt vmcnt(13)
    v_mfma_f32_16x16x32_bf16 v[116:119], v[88:91], a[0:3], v[116:119]
    ds_read2_b32 a[248:249], v245 offset0:128 offset1:129
    v_mfma_f32_16x16x32_bf16 v[120:123], v[88:91], a[4:7], v[120:123]
    ds_read2_b32 a[250:251], v245 offset0:130 offset1:131
    v_mfma_f32_16x16x32_bf16 v[124:127], v[88:91], a[8:11], v[124:127]
    ds_read2_b32 a[252:253], v245 offset0:0 offset1:1
    v_mfma_f32_16x16x32_bf16 v[128:131], v[88:91], a[12:15], v[128:131]
    ds_read2_b32 a[254:255], v245 offset0:2 offset1:3
    s_waitcnt vmcnt(12)
    v_mfma_f32_16x16x32_bf16 v[100:103], v[92:95], a[16:19], v[100:103]
    s_mov_b32 s19, 33161216
    v_mfma_f32_16x16x32_bf16 v[104:107], v[92:95], a[20:23], v[104:107]
    buffer_load_dword v48, v29, s[20:23], s19 offen sc1
    v_mfma_f32_16x16x32_bf16 v[108:111], v[92:95], a[24:27], v[108:111]
    v_mfma_f32_16x16x32_bf16 v[112:115], v[92:95], a[28:31], v[112:115]
    s_waitcnt vmcnt(12)
    v_mfma_f32_16x16x32_bf16 v[116:119], v[96:99], a[16:19], v[116:119]
    v_mfma_f32_16x16x32_bf16 v[120:123], v[96:99], a[20:23], v[120:123]
    v_mfma_f32_16x16x32_bf16 v[124:127], v[96:99], a[24:27], v[124:127]
    v_mfma_f32_16x16x32_bf16 v[128:131], v[96:99], a[28:31], v[128:131]
    s_waitcnt vmcnt(11)
    v_mfma_f32_16x16x32_bf16 v[100:103], v[148:151], a[32:35], v[100:103]
    v_mfma_f32_16x16x32_bf16 v[104:107], v[148:151], a[36:39], v[104:107]
    v_mfma_f32_16x16x32_bf16 v[108:111], v[148:151], a[40:43], v[108:111]
    v_mfma_f32_16x16x32_bf16 v[112:115], v[148:151], a[44:47], v[112:115]
    s_waitcnt vmcnt(10)
    v_mfma_f32_16x16x32_bf16 v[116:119], v[152:155], a[32:35], v[116:119]
    v_mfma_f32_16x16x32_bf16 v[120:123], v[152:155], a[36:39], v[120:123]
    v_mfma_f32_16x16x32_bf16 v[124:127], v[152:155], a[40:43], v[124:127]
    v_mfma_f32_16x16x32_bf16 v[128:131], v[152:155], a[44:47], v[128:131]
    s_waitcnt vmcnt(9)
    v_mfma_f32_16x16x32_bf16 v[100:103], v[156:159], a[48:51], v[100:103]
    v_mfma_f32_16x16x32_bf16 v[104:107], v[156:159], a[52:55], v[104:107]
    v_mfma_f32_16x16x32_bf16 v[108:111], v[156:159], a[56:59], v[108:111]
    v_mfma_f32_16x16x32_bf16 v[112:115], v[156:159], a[60:63], v[112:115]
    s_waitcnt vmcnt(8)
    v_mfma_f32_16x16x32_bf16 v[116:119], v[160:163], a[48:51], v[116:119]
    v_mfma_f32_16x16x32_bf16 v[120:123], v[160:163], a[52:55], v[120:123]
    v_mfma_f32_16x16x32_bf16 v[124:127], v[160:163], a[56:59], v[124:127]
    v_mfma_f32_16x16x32_bf16 v[128:131], v[160:163], a[60:63], v[128:131]
    s_waitcnt vmcnt(7)
    v_mfma_f32_16x16x32_bf16 v[100:103], v[164:167], a[64:67], v[100:103]
    s_waitcnt vmcnt(0)
    v_cmp_gt_u32 vcc, s33, v48
    s_nop 1
    s_cbranch_vccz pok10
    s_mov_b32 s18, 40000
    s_mov_b32 s19, 33161216
psp10:
    s_sleep 2
    buffer_load_dword v48, v29, s[20:23], s19 offen sc1
    s_waitcnt vmcnt(0)
    v_cmp_gt_u32 vcc, s33, v48
    s_nop 1
    s_cbranch_vccz pok10
    s_sub_u32 s18, s18, 1
    s_cbranch_scc0 psp10
    s_endpgm
pok10:
    s_add_u32 s34, s34, 4194304
    s_add_u32 s35, s35, 16384
    v_mfma_f32_16x16x32_bf16 v[104:107], v[164:167], a[68:71], v[104:107]
    s_add_u32 s4, s35, 0
    s_add_u32 s5, s35, 8192
    s_add_u32 s6, s34, 4096
    v_mfma_f32_16x16x32_bf16 v[108:111], v[164:167], a[72:75], v[108:111]
    buffer_load_dwordx4 v[52:55], v6, s[20:23], s4 offen sc1
    buffer_load_dwordx4 v[56:59], v6, s[20:23], s5 offen sc1
    buffer_load_dwordx2 v[60:61], v7, s[20:23], s34 offen offset:0 sc1
    v_mfma_f32_16x16x32_bf16 v[112:115], v[164:167], a[76:79], v[112:115]
    buffer_load_dwordx2 v[62:63], v7, s[20:23], s6 offen offset:0 sc1
    ds_read2_b32 a[48:49], v244 offset0:176 offset1:177
    ds_read2_b32 a[50:51], v244 offset0:178 offset1:179
    v_mfma_f32_16x16x32_bf16 v[116:119], v[168:171], a[64:67], v[116:119]
    ds_read2_b32 a[52:53], v244 offset0:48 offset1:49
    ds_read2_b32 a[54:55], v244 offset0:50 offset1:51
    ds_read2_b32 a[56:57], v9 offset0:176 offset1:177
    v_mfma_f32_16x16x32_bf16 v[120:123], v[168:171], a[68:71], v[120:123]
    ds_read2_b32 a[58:59], v9 offset0:178 offset1:179
    ds_read2_b32 a[60:61], v9 offset0:48 offset1:49
    ds_read2_b32 a[62:63], v9 offset0:50 offset1:51
    v_mfma_f32_16x16x32_bf16 v[124:127], v[168:171], a[72:75], v[124:127]
    v_mfma_f32_16x16x32_bf16 v[128:131], v[168:171], a[76:79], v[128:131]
    v_mfma_f32_16x16x32_bf16 v[100:103], v[172:175], a[80:83], v[100:103]
    ds_read2_b32 a[64:65], v244 offset0:160 offset1:161
    v_mfma_f32_16x16x32_bf16 v[104:107], v[172:175], a[84:87], v[104:107]
    ds_read2_b32 a[66:67], v244 offset0:162 offset1:163
    v_mfma_f32_16x16x32_bf16 v[108:111], v[172:175], a[88:91], v[108:111]
    ds_read2_b32 a[68:69], v244 offset0:32 offset1:33
    v_mfma_f32_16x16x32_bf16 v[112:115], v[172:175], a[92:95], v[112:115]
    ds_read2_b32 a[70:71], v244 offset0:34 offset1:35
    v_mfma_f32_16x16x32_bf16 v[116:119], v[176:179], a[80:83], v[116:119]
    ds_read2_b32 a[72:73], v9 offset0:160 offset1:161
    v_mfma_f32_16x16x32_bf16 v[120:123], v[176:179], a[84:87], v[120:123]
    ds_read2_b32 a[74:75], v9 offset0:162 offset1:163
    v_mfma_f32_16x16x32_bf16 v[124:127], v[176:179], a[88:91], v[124:127]
    ds_read2_b32 a[76:77], v9 offset0:32 offset1:33
    v_mfma_f32_16x16x32_bf16 v[128:131], v[176:179], a[92:95], v[128:131]
    ds_read2_b32 a[78:79], v9 offset0:34 offset1:35
    v_mfma_f32_16x16x32_bf16 v[100:103], v[232:235], a[96:99], v[100:103]
    ds_read2_b32 a[80:81], v244 offset0:144 offset1:145
    v_mfma_f32_16x16x32_bf16 v[104:107], v[232:235], a[100:103], v[104:107]
    ds_read2_b32 a[82:83], v244 offset0:146 offset1:147
    v_mfma_f32_16x16x32_bf16 v[108:111], v[232:235], a[104:107], v[108:111]
    ds_read2_b32 a[84:85], v244 offset0:16 offset1:17
    v_mfma_f32_16x16x32_bf16 v[112:115], v[232:235], a[108:111], v[112:115]
    ds_read2_b32 a[86:87], v244 offset0:18 offset1:19
    v_mfma_f32_16x16x32_bf16 v[116:119], v[236:239], a[96:99], v[116:119]
    ds_read2_b32 a[88:89], v9 offset0:144 offset1:145
    v_mfma_f32_16x16x32_bf16 v[120:123], v[236:239], a[100:103], v[120:123]
    ds_read2_b32 a[90:91], v9 offset0:146 offset1:147
    v_mfma_f32_16x16x32_bf16 v[124:127], v[236:239], a[104:107], v[124:127]
    ds_read2_b32 a[92:93], v9 offset0:16 offset1:17
    v_mfma_f32_16x16x32_bf16 v[128:131], v[236:239], a[108:111], v[128:131]
    ds_read2_b32 a[94:95], v9 offset0:18 offset1:19
    v_xor_b32 v133, 8192, v22
    v_xor_b32 v134, 16384, v22
    v_xor_b32 v135, 24576, v22
    ds_write_b128 v22, v[104:107] offset:34816
    ds_write_b128 v22, v[120:123] offset:35840
    ds_write_b128 v22, v[108:111] offset:36864
    ds_write_b128 v22, v[124:127] offset:37888
    ds_write_b128 v22, v[112:115] offset:38912
    ds_write_b128 v22, v[128:131] offset:39936
    v_lshlrev_b32 v136, 16, v240
    v_and_b32 v137, 0xffff0000, v240
    v_add_f32 v100, v100, v136
    v_add_f32 v101, v101, v137
    v_lshlrev_b32 v136, 16, v241
    v_and_b32 v137, 0xffff0000, v241
    v_add_f32 v102, v102, v136
    v_add_f32 v103, v103, v137
    v_lshlrev_b32 v136, 16, v242
    v_and_b32 v137, 0xffff0000, v242
    v_add_f32 v116, v116, v136
    v_add_f32 v117, v117, v137
    v_lshlrev_b32 v136, 16, v243
    v_and_b32 v137, 0xffff0000, v243
    v_add_f32 v118, v118, v136
    v_add_f32 v119, v119, v137
    s_waitcnt lgkmcnt(0)
    s_barrier
    ds_read_b128 v[180:183], v133 offset:34816
    ds_read_b128 v[184:187], v134 offset:36864
    ds_read_b128 v[188:191], v135 offset:38912
    ds_read_b128 v[192:195], v133 offset:35840
    ds_read_b128 v[196:199], v134 offset:37888
    ds_read_b128 v[200:203], v135 offset:39936
    s_waitcnt vmcnt(3)
    v_mul_f32 v52, s49, v52
    v_mul_f32 v53, s49, v53
    v_mul_f32 v54, s49, v54
    v_mul_f32 v55, s49, v55
    s_waitcnt vmcnt(2)
    v_fma_f32 v56, v56, s49, v35
    v_fma_f32 v57, v57, s49, v35
    v_fma_f32 v58, v58, s49, v35
    v_fma_f32 v59, v59, s49, v35
    v_fma_f32 v56, -v52, v52, v56
    v_fma_f32 v57, -v53, v53, v57
    v_fma_f32 v58, -v54, v54, v58
    v_fma_f32 v59, -v55, v55, v59
    v_max_f32 v56, v35, v56
    v_max_f32 v57, v35, v57
    v_max_f32 v58, v35, v58
    v_max_f32 v59, v35, v59
    v_rsq_f32 v56, v56
    v_rsq_f32 v57, v57
    v_rsq_f32 v58, v58
    v_rsq_f32 v59, v59
    s_waitcnt vmcnt(1)
    ds_write_b64 v8, v[60:61] offset:0
    v_lshlrev_b32 v64, 16, v60
    v_and_b32 v65, 0xffff0000, v60
    v_lshlrev_b32 v66, 16, v61
    v_and_b32 v67, 0xffff0000, v61
    v_sub_f32 v64, v64, v52
    v_sub_f32 v65, v65, v53
    v_sub_f32 v66, v66, v54
    v_sub_f32 v67, v67, v55
    v_mul_f32 v64, v64, v56
    v_mul_f32 v65, v65, v57
    v_mul_f32 v66, v66, v58
    v_mul_f32 v67, v67, v59
    v_cvt_pk_bf16_f32 v72, v64, v65
    v_cvt_pk_bf16_f32 v73, v66, v67
    ds_write_b64 v8, v[72:73] offset:29184
    s_waitcnt vmcnt(0)
    ds_write_b64 v8, v[62:63] offset:4096
    v_lshlrev_b32 v68, 16, v62
    v_and_b32 v69, 0xffff0000, v62
    v_lshlrev_b32 v70, 16, v63
    v_and_b32 v71, 0xffff0000, v63
    v_sub_f32 v68, v68, v52
    v_sub_f32 v69, v69, v53
    v_sub_f32 v70, v70, v54
    v_sub_f32 v71, v71, v55
    v_mul_f32 v68, v68, v56
    v_mul_f32 v69, v69, v57
    v_mul_f32 v70, v70, v58
    v_mul_f32 v71, v71, v59
    v_cvt_pk_bf16_f32 v74, v68, v69
    v_cvt_pk_bf16_f32 v75, v70, v71
    ds_write_b64 v8, v[74:75] offset:33792
    s_waitcnt lgkmcnt(9)
    v_add_f32 v100, v100, v180
    v_add_f32 v101, v101, v181
    v_add_f32 v102, v102, v182
    v_add_f32 v103, v103, v183
    s_waitcnt lgkmcnt(8)
    v_add_f32 v100, v100, v184
    v_add_f32 v101, v101, v185
    v_add_f32 v102, v102, v186
    v_add_f32 v103, v103, v187
    s_waitcnt lgkmcnt(7)
    v_add_f32 v100, v100, v188
    v_add_f32 v101, v101, v189
    v_add_f32 v102, v102, v190
    v_add_f32 v103, v103, v191
    v_cvt_pk_bf16_f32 v140, v100, v101
    v_cvt_pk_bf16_f32 v141, v102, v103
    s_waitcnt lgkmcnt(6)
    v_add_f32 v116, v116, v192
    v_add_f32 v117, v117, v193
    v_add_f32 v118, v118, v194
    v_add_f32 v119, v119, v195
    s_waitcnt lgkmcnt(5)
    v_add_f32 v116, v116, v196
    v_add_f32 v117, v117, v197
    v_add_f32 v118, v118, v198
    v_add_f32 v119, v119, v199
    s_waitcnt lgkmcnt(4)
    v_add_f32 v116, v116, v200
    v_add_f32 v117, v117, v201
    v_add_f32 v118, v118, v202
    v_add_f32 v119, v119, v203
    v_cvt_pk_bf16_f32 v142, v116, v117
    v_cvt_pk_bf16_f32 v143, v118, v119
    s_add_u32 s15, s44, 2097152
    buffer_store_dwordx4 v[140:143], v23, s[20:23], s15 offen offset:2048 sc1
    v_mul_f32 v180, v100, v100
    v_mul_f32 v181, v101, v101
    v_mul_f32 v182, v102, v102
    v_mul_f32 v183, v103, v103
    v_mul_f32 v184, v116, v116
    v_mul_f32 v185, v117, v117
    v_mul_f32 v186, v118, v118
    v_mul_f32 v187, v119, v119
    v_add_f32_dpp v100, v100, v100 row_ror:8 row_mask:0xf bank_mask:0x3
    v_add_f32_dpp v101, v101, v101 row_ror:8 row_mask:0xf bank_mask:0x3
    v_add_f32_dpp v102, v102, v102 row_ror:8 row_mask:0xf bank_mask:0x3
    v_add_f32_dpp v103, v103, v103 row_ror:8 row_mask:0xf bank_mask:0x3
    v_add_f32_dpp v116, v116, v116 row_ror:8 row_mask:0xf bank_mask:0x3
    v_add_f32_dpp v117, v117, v117 row_ror:8 row_mask:0xf bank_mask:0x3
    v_add_f32_dpp v118, v118, v118 row_ror:8 row_mask:0xf bank_mask:0x3
    v_add_f32_dpp v119, v119, v119 row_ror:8 row_mask:0xf bank_mask:0x3
    v_add_f32_dpp v100, v180, v180 row_ror:8 row_mask:0xf bank_mask:0xc
    v_add_f32_dpp v101, v181, v181 row_ror:8 row_mask:0xf bank_mask:0xc
    v_add_f32_dpp v102, v182, v182 row_ror:8 row_mask:0xf bank_mask:0xc
    v_add_f32_dpp v103, v183, v183 row_ror:8 row_mask:0xf bank_mask:0xc
    v_add_f32_dpp v116, v184, v184 row_ror:8 row_mask:0xf bank_mask:0xc
    v_add_f32_dpp v117, v185, v185 row_ror:8 row_mask:0xf bank_mask:0xc
    v_add_f32_dpp v118, v186, v186 row_ror:8 row_mask:0xf bank_mask:0xc
    v_add_f32_dpp v119, v187, v187 row_ror:8 row_mask:0xf bank_mask:0xc
    v_add_f32_dpp v100, v100, v100 row_half_mirror row_mask:0xf bank_mask:0x5
    v_add_f32_dpp v101, v101, v101 row_half_mirror row_mask:0xf bank_mask:0x5
    v_add_f32_dpp v102, v102, v102 row_half_mirror row_mask:0xf bank_mask:0x5
    v_add_f32_dpp v103, v103, v103 row_half_mirror row_mask:0xf bank_mask:0x5
    v_add_f32_dpp v100, v116, v116 row_half_mirror row_mask:0xf bank_mask:0xa
    v_add_f32_dpp v101, v117, v117 row_half_mirror row_mask:0xf bank_mask:0xa
    v_add_f32_dpp v102, v118, v118 row_half_mirror row_mask:0xf bank_mask:0xa
    v_add_f32_dpp v103, v119, v119 row_half_mirror row_mask:0xf bank_mask:0xa
    v_add_f32_dpp v100, v100, v100 quad_perm:[1,0,3,2] row_mask:0xf bank_mask:0xf
    v_add_f32_dpp v101, v101, v101 quad_perm:[1,0,3,2] row_mask:0xf bank_mask:0xf
    v_add_f32_dpp v102, v102, v102 quad_perm:[1,0,3,2] row_mask:0xf bank_mask:0xf
    v_add_f32_dpp v103, v103, v103 quad_perm:[1,0,3,2] row_mask:0xf bank_mask:0xf
    v_add_f32_dpp v100, v100, v100 quad_perm:[2,3,0,1] row_mask:0xf bank_mask:0xf
    v_add_f32_dpp v101, v101, v101 quad_perm:[2,3,0,1] row_mask:0xf bank_mask:0xf
    v_add_f32_dpp v102, v102, v102 quad_perm:[2,3,0,1] row_mask:0xf bank_mask:0xf
    v_add_f32_dpp v103, v103, v103 quad_perm:[2,3,0,1] row_mask:0xf bank_mask:0xf
    s_add_u32 s15, s45, 4096
    v_cndmask_b32 v100, v100, v101, s[52:53]
    v_cndmask_b32 v100, v100, v102, s[54:55]
    v_cndmask_b32 v100, v100, v103, s[56:57]
    ds_write_b32 v252, v100 offset:1024
    s_waitcnt lgkmcnt(0)
    s_barrier
    ds_read_b128 v[180:183], v253 offset:1024
    s_waitcnt lgkmcnt(0)
    v_add_f32 v180, v180, v181
    v_add_f32 v182, v182, v183
    v_add_f32 v180, v180, v182
    buffer_atomic_add_f32 v180, v24, s[20:23], s15 offen sc1
    s_add_u32 s36, s36, 4194304
    s_add_u32 s38, s38, 4194304
    s_add_u32 s44, s44, 4194304
    s_add_u32 s41, s41, 6291456
    s_add_u32 s42, s42, 6291456
    s_add_u32 s32, s32, 1
    s_add_u32 s33, s33, 1
    s_mov_b64 s[62:63], 0
    ds_read_b128 v[84:87], v10 offset:192
    ds_read_b128 v[88:91], v10 offset:704
    ds_read_b128 v[92:95], v10 offset:1216
    ds_read_b128 v[96:99], v10 offset:1728
    s_waitcnt lgkmcnt(3)
    v_mfma_f32_16x16x32_bf16 v[52:55], a[192:195], v[84:87], 0
    ds_read_b128 v[100:103], v10 offset:128
    v_mfma_f32_16x16x32_bf16 v[56:59], a[196:199], v[84:87], 0
    ds_read_b128 v[104:107], v10 offset:640
    v_mfma_f32_16x16x32_bf16 v[60:63], a[200:203], v[84:87], 0
    ds_read_b128 v[108:111], v10 offset:1152
    v_mfma_f32_16x16x32_bf16 v[64:67], a[204:207], v[84:87], 0
    ds_read_b128 v[112:115], v10 offset:1664
    s_waitcnt lgkmcnt(6)
    v_mfma_f32_16x16x32_bf16 v[56:59], a[192:195], v[88:91], v[56:59]
    ds_read_b128 v[116:119], v10 offset:64
    v_mfma_f32_16x16x32_bf16 v[60:63], a[196:199], v[88:91], v[60:63]
    ds_read_b128 v[120:123], v10 offset:576
    v_mfma_f32_16x16x32_bf16 v[64:67], a[200:203], v[88:91], v[64:67]
    ds_read_b128 v[124:127], v10 offset:1088
    s_waitcnt lgkmcnt(8)
    v_mfma_f32_16x16x32_bf16 v[60:63], a[192:195], v[92:95], v[60:63]
    ds_read_b128 v[128:131], v10 offset:1600
    v_mfma_f32_16x16x32_bf16 v[64:67], a[196:199], v[92:95], v[64:67]
    ds_read_b128 v[132:135], v10 offset:0
    s_waitcnt lgkmcnt(9)
    v_mfma_f32_16x16x32_bf16 v[64:67], a[192:195], v[96:99], v[64:67]
    ds_read_b128 v[136:139], v10 offset:512
    s_waitcnt lgkmcnt(9)
    v_mfma_f32_16x16x32_bf16 v[52:55], a[208:211], v[100:103], v[52:55]
    ds_read_b128 v[140:143], v10 offset:1024
    v_mfma_f32_16x16x32_bf16 v[56:59], a[212:215], v[100:103], v[56:59]
    ds_read_b128 v[144:147], v10 offset:1536
    v_mfma_f32_16x16x32_bf16 v[60:63], a[216:219], v[100:103], v[60:63]
    ds_read2_b32 a[96:97], v244 offset0:128 offset1:129
    v_mfma_f32_16x16x32_bf16 v[64:67], a[220:223], v[100:103], v[64:67]
    ds_read2_b32 a[98:99], v244 offset0:130 offset1:131
    s_waitcnt lgkmcnt(12)
    v_mfma_f32_16x16x32_bf16 v[56:59], a[208:211], v[104:107], v[56:59]
    s_add_u32 s8, s40, 0
    s_add_u32 s9, s40, 16384
    s_add_u32 s10, s40, 32768
    buffer_load_dwordx4 a[0:3], v5, s[20:23], s8 offen offset:0 sc1
    v_mfma_f32_16x16x32_bf16 v[60:63], a[212:215], v[104:107], v[60:63]
    ds_read2_b32 a[100:101], v244 offset0:0 offset1:1
    v_mfma_f32_16x16x32_bf16 v[64:67], a[216:219], v[104:107], v[64:67]
    ds_read2_b32 a[102:103], v244 offset0:2 offset1:3
    s_waitcnt lgkmcnt(13)
    v_mfma_f32_16x16x32_bf16 v[60:63], a[208:211], v[108:111], v[60:63]
    buffer_load_dwordx4 a[4:7], v5, s[20:23], s9 offen offset:0 sc1
    v_mfma_f32_16x16x32_bf16 v[64:67], a[212:215], v[108:111], v[64:67]
    ds_read2_b32 a[104:105], v9 offset0:128 offset1:129
    s_waitcnt lgkmcnt(13)
    v_mfma_f32_16x16x32_bf16 v[64:67], a[208:211], v[112:115], v[64:67]
    ds_read2_b32 a[106:107], v9 offset0:130 offset1:131
    s_waitcnt lgkmcnt(13)
    v_mfma_f32_16x16x32_bf16 v[52:55], a[224:227], v[116:119], v[52:55]
    buffer_load_dwordx4 a[8:11], v33, s[20:23], s10 offen offset:0 sc1
    v_mfma_f32_16x16x32_bf16 v[56:59], a[228:231], v[116:119], v[56:59]
    ds_read2_b32 a[108:109], v9 offset0:0 offset1:1
    v_mfma_f32_16x16x32_bf16 v[60:63], a[232:235], v[116:119], v[60:63]
    ds_read2_b32 a[110:111], v9 offset0:2 offset1:3
    v_mfma_f32_16x16x32_bf16 v[64:67], a[236:239], v[116:119], v[64:67]
    buffer_load_dwordx4 a[12:15], v5, s[20:23], s8 offen offset:1024 sc1
    s_waitcnt lgkmcnt(14)
    v_mfma_f32_16x16x32_bf16 v[56:59], a[224:227], v[120:123], v[56:59]
    s_add_u32 s19, s48, 33193984
    v_mfma_f32_16x16x32_bf16 v[60:63], a[228:231], v[120:123], v[60:63]
    s_waitcnt vmcnt(4)
    s_barrier
    v_mfma_f32_16x16x32_bf16 v[64:67], a[232:235], v[120:123], v[64:67]
    buffer_load_dwordx4 a[16:19], v5, s[20:23], s9 offen offset:1024 sc1
    s_waitcnt lgkmcnt(13)
    v_mfma_f32_16x16x32_bf16 v[60:63], a[224:227], v[124:127], v[60:63]
    buffer_store_dword v32, v30, s[20:23], s19 offen sc1
    v_mfma_f32_16x16x32_bf16 v[64:67], a[228:231], v[124:127], v[64:67]
    v_mov_b32 v32, s33
    s_waitcnt lgkmcnt(12)
    v_mfma_f32_16x16x32_bf16 v[64:67], a[224:227], v[128:131], v[64:67]
    buffer_load_dwordx4 a[20:23], v33, s[20:23], s10 offen offset:1024 sc1
    s_waitcnt lgkmcnt(11)
    v_mfma_f32_16x16x32_bf16 v[52:55], a[240:243], v[132:135], v[52:55]
    v_mfma_f32_16x16x32_bf16 v[56:59], a[244:247], v[132:135], v[56:59]
    v_mfma_f32_16x16x32_bf16 v[60:63], a[248:251], v[132:135], v[60:63]
    buffer_load_dwordx4 a[24:27], v5, s[20:23], s8 offen offset:2048 sc1
    v_mfma_f32_16x16x32_bf16 v[64:67], a[252:255], v[132:135], v[64:67]
    s_waitcnt lgkmcnt(10)
    v_mfma_f32_16x16x32_bf16 v[56:59], a[240:243], v[136:139], v[56:59]
    v_mfma_f32_16x16x32_bf16 v[60:63], a[244:247], v[136:139], v[60:63]
    buffer_load_dwordx4 a[28:31], v5, s[20:23], s9 offen offset:2048 sc1
    v_mfma_f32_16x16x32_bf16 v[64:67], a[248:251], v[136:139], v[64:67]
    s_waitcnt lgkmcnt(9)
    v_mfma_f32_16x16x32_bf16 v[60:63], a[240:243], v[140:143], v[60:63]
    v_mfma_f32_16x16x32_bf16 v[64:67], a[244:247], v[140:143], v[64:67]
    buffer_load_dwordx4 a[32:35], v33, s[20:23], s10 offen offset:2048 sc1
    s_waitcnt lgkmcnt(8)
    v_mfma_f32_16x16x32_bf16 v[64:67], a[240:243], v[144:147], v[64:67]
    v_mfma_f32_16x16x32_bf16 v[68:71], a[48:51], v[84:87], 0
    ds_write_b128 v11, v[52:55] offset:0
    v_mfma_f32_16x16x32_bf16 v[72:75], a[52:55], v[84:87], 0
    ds_write_b128 v11, v[56:59] offset:1152
    v_mfma_f32_16x16x32_bf16 v[76:79], a[56:59], v[84:87], 0
    ds_write_b128 v11, v[60:63] offset:2304
    v_mfma_f32_16x16x32_bf16 v[80:83], a[60:63], v[84:87], 0
    s_nop 0
    ds_write_b128 v11, v[64:67] offset:3456
    v_mfma_f32_16x16x32_bf16 v[68:71], a[204:207], v[88:91], v[68:71]
    ds_read_b128 v[164:167], v13 offset:0
    v_mfma_f32_16x16x32_bf16 v[72:75], a[48:51], v[88:91], v[72:75]
    s_waitcnt lgkmcnt(0)
    v_mfma_f32_16x16x32_bf16 v[76:79], a[52:55], v[88:91], v[76:79]
    s_barrier
    v_mfma_f32_16x16x32_bf16 v[80:83], a[56:59], v[88:91], v[80:83]
    v_mfma_f32_16x16x32_bf16 v[68:71], a[200:203], v[92:95], v[68:71]
    ds_read_b128 v[148:151], v12 offset:0
    ds_read_b128 v[156:159], v12 offset:4608
    ds_read_b128 v[152:155], v12 offset:256
    v_mfma_f32_16x16x32_bf16 v[72:75], a[204:207], v[92:95], v[72:75]
    ds_read_b128 v[160:163], v12 offset:4864
    v_lshlrev_b32 v168, 16, v164
    v_and_b32 v169, 0xffff0000, v164
    v_mfma_f32_16x16x32_bf16 v[76:79], a[48:51], v[92:95], v[76:79]
    v_lshlrev_b32 v170, 16, v165
    v_and_b32 v171, 0xffff0000, v165
    v_lshlrev_b32 v172, 16, v166
    v_mfma_f32_16x16x32_bf16 v[80:83], a[52:55], v[92:95], v[80:83]
    v_and_b32 v173, 0xffff0000, v166
    v_lshlrev_b32 v174, 16, v167
    v_and_b32 v175, 0xffff0000, v167
    v_mfma_f32_16x16x32_bf16 v[68:71], a[196:199], v[96:99], v[68:71]
    s_waitcnt lgkmcnt(3)
    v_add_f32 v168, v168, v148
    v_add_f32 v169, v169, v149
    v_add_f32 v170, v170, v150
    v_mfma_f32_16x16x32_bf16 v[72:75], a[200:203], v[96:99], v[72:75]
    v_add_f32 v171, v171, v151
    s_waitcnt lgkmcnt(1)
    v_add_f32 v172, v172, v152
    v_add_f32 v173, v173, v153
    v_mfma_f32_16x16x32_bf16 v[76:79], a[204:207], v[96:99], v[76:79]
    v_add_f32 v174, v174, v154
    v_add_f32 v175, v175, v155
    v_add_f32 v168, v168, v156
    v_mfma_f32_16x16x32_bf16 v[80:83], a[48:51], v[96:99], v[80:83]
    v_add_f32 v169, v169, v157
    v_add_f32 v170, v170, v158
    v_add_f32 v171, v171, v159
    v_mfma_f32_16x16x32_bf16 v[68:71], a[64:67], v[100:103], v[68:71]
    s_waitcnt lgkmcnt(0)
    v_add_f32 v172, v172, v160
    v_add_f32 v173, v173, v161
    v_add_f32 v174, v174, v162
    v_mfma_f32_16x16x32_bf16 v[72:75], a[68:71], v[100:103], v[72:75]
    v_add_f32 v175, v175, v163
    v_cvt_pk_bf16_f32 v176, v168, v169
    v_cvt_pk_bf16_f32 v177, v170, v171
    v_mfma_f32_16x16x32_bf16 v[76:79], a[72:75], v[100:103], v[76:79]
    v_cvt_pk_bf16_f32 v178, v172, v173
    v_cvt_pk_bf16_f32 v179, v174, v175
    buffer_store_dwordx4 v[176:179], v5, s[20:23], s36 offen offset:0 sc1
    v_mfma_f32_16x16x32_bf16 v[80:83], a[76:79], v[100:103], v[80:83]
    v_mfma_f32_16x16x32_bf16 v[68:71], a[220:223], v[104:107], v[68:71]
    v_mfma_f32_16x16x32_bf16 v[72:75], a[64:67], v[104:107], v[72:75]
    buffer_load_dwordx4 a[36:39], v5, s[20:23], s8 offen offset:3072 sc1
    v_mfma_f32_16x16x32_bf16 v[76:79], a[68:71], v[104:107], v[76:79]
    v_mfma_f32_16x16x32_bf16 v[80:83], a[72:75], v[104:107], v[80:83]
    v_mfma_f32_16x16x32_bf16 v[68:71], a[216:219], v[108:111], v[68:71]
    buffer_load_dwordx4 a[40:43], v5, s[20:23], s9 offen offset:3072 sc1
    v_mfma_f32_16x16x32_bf16 v[72:75], a[220:223], v[108:111], v[72:75]
    v_mfma_f32_16x16x32_bf16 v[76:79], a[64:67], v[108:111], v[76:79]
    v_mfma_f32_16x16x32_bf16 v[80:83], a[68:71], v[108:111], v[80:83]
    buffer_load_dwordx4 a[44:47], v33, s[20:23], s10 offen offset:3072 sc1
    v_mfma_f32_16x16x32_bf16 v[68:71], a[212:215], v[112:115], v[68:71]
    v_mfma_f32_16x16x32_bf16 v[72:75], a[216:219], v[112:115], v[72:75]
    v_mfma_f32_16x16x32_bf16 v[76:79], a[220:223], v[112:115], v[76:79]
    s_add_u32 s8, s40, 4096
    s_add_u32 s9, s40, 20480
    s_add_u32 s10, s40, 36864
    buffer_load_dwordx4 a[48:51], v5, s[20:23], s8 offen offset:0 sc1
    v_mfma_f32_16x16x32_bf16 v[80:83], a[64:67], v[112:115], v[80:83]
    v_mfma_f32_16x16x32_bf16 v[68:71], a[80:83], v[116:119], v[68:71]
    v_mfma_f32_16x16x32_bf16 v[72:75], a[84:87], v[116:119], v[72:75]
    buffer_load_dwordx4 a[52:55], v5, s[20:23], s9 offen offset:0 sc1
    v_mfma_f32_16x16x32_bf16 v[76:79], a[88:91], v[116:119], v[76:79]
    v_mfma_f32_16x16x32_bf16 v[80:83], a[92:95], v[116:119], v[80:83]
    v_mfma_f32_16x16x32_bf16 v[68:71], a[236:239], v[120:123], v[68:71]
    buffer_load_dwordx4 a[56:59], v33, s[20:23], s10 offen offset:0 sc1
    v_mfma_f32_16x16x32_bf16 v[72:75], a[80:83], v[120:123], v[72:75]
    v_mfma_f32_16x16x32_bf16 v[76:79], a[84:87], v[120:123], v[76:79]
    v_mfma_f32_16x16x32_bf16 v[80:83], a[88:91], v[120:123], v[80:83]
    buffer_load_dwordx4 a[60:63], v5, s[20:23], s8 offen offset:1024 sc1
    v_mfma_f32_16x16x32_bf16 v[68:71], a[232:235], v[124:127], v[68:71]
    v_mfma_f32_16x16x32_bf16 v[72:75], a[236:239], v[124:127], v[72:75]
    v_mfma_f32_16x16x32_bf16 v[76:79], a[80:83], v[124:127], v[76:79]
    buffer_load_dwordx4 a[64:67], v5, s[20:23], s9 offen offset:1024 sc1
    v_mfma_f32_16x16x32_bf16 v[80:83], a[84:87], v[124:127], v[80:83]
    v_mfma_f32_16x16x32_bf16 v[68:71], a[228:231], v[128:131], v[68:71]
    v_mfma_f32_16x16x32_bf16 v[72:75], a[232:235], v[128:131], v[72:75]
    buffer_load_dwordx4 a[68:71], v33, s[20:23], s10 offen offset:1024 sc1
    v_mfma_f32_16x16x32_bf16 v[76:79], a[236:239], v[128:131], v[76:79]
    v_mfma_f32_16x16x32_bf16 v[80:83], a[80:83], v[128:131], v[80:83]
    v_mfma_f32_16x16x32_bf16 v[68:71], a[96:99], v[132:135], v[68:71]
    v_mfma_f32_16x16x32_bf16 v[72:75], a[100:103], v[132:135], v[72:75]
    v_mfma_f32_16x16x32_bf16 v[76:79], a[104:107], v[132:135], v[76:79]
    v_mfma_f32_16x16x32_bf16 v[80:83], a[108:111], v[132:135], v[80:83]
    buffer_load_dwordx4 a[72:75], v5, s[20:23], s8 offen offset:2048 sc1
    v_mfma_f32_16x16x32_bf16 v[68:71], a[252:255], v[136:139], v[68:71]
    s_add_u32 s19, s46, 33030144
    s_waitcnt vmcnt(10)
    s_barrier
    buffer_store_dword v32, v30, s[20:23], s19 offen sc1
    v_mfma_f32_16x16x32_bf16 v[72:75], a[96:99], v[136:139], v[72:75]
    v_mfma_f32_16x16x32_bf16 v[76:79], a[100:103], v[136:139], v[76:79]
    buffer_load_dwordx4 a[76:79], v5, s[20:23], s9 offen offset:2048 sc1
    v_mfma_f32_16x16x32_bf16 v[80:83], a[104:107], v[136:139], v[80:83]
    v_mfma_f32_16x16x32_bf16 v[68:71], a[248:251], v[140:143], v[68:71]
    v_mfma_f32_16x16x32_bf16 v[72:75], a[252:255], v[140:143], v[72:75]
    buffer_load_dwordx4 a[80:83], v33, s[20:23], s10 offen offset:2048 sc1
    v_mfma_f32_16x16x32_bf16 v[76:79], a[96:99], v[140:143], v[76:79]
    v_mfma_f32_16x16x32_bf16 v[80:83], a[100:103], v[140:143], v[80:83]
    v_mfma_f32_16x16x32_bf16 v[68:71], a[244:247], v[144:147], v[68:71]
    buffer_load_dwordx4 a[84:87], v5, s[20:23], s8 offen offset:3072 sc1
    s_mov_b32 s19, 33193984
    buffer_load_dword v48, v29, s[20:23], s19 offen sc1
    v_mfma_f32_16x16x32_bf16 v[72:75], a[248:251], v[144:147], v[72:75]
    v_mfma_f32_16x16x32_bf16 v[76:79], a[252:255], v[144:147], v[76:79]
    v_mfma_f32_16x16x32_bf16 v[80:83], a[96:99], v[144:147], v[80:83]
    buffer_load_dwordx4 a[88:91], v5, s[20:23], s9 offen offset:3072 sc1
    s_waitcnt vmcnt(1)
    v_cmp_gt_u32 vcc, s32, v48
    s_nop 1
    s_cbranch_vccz pok11
    s_mov_b32 s18, 40000
    s_mov_b32 s19, 33193984
psp11:
    s_sleep 2
    buffer_load_dword v48, v29, s[20:23], s19 offen sc1
    s_waitcnt vmcnt(0)
    v_cmp_gt_u32 vcc, s32, v48
    s_nop 1
    s_cbranch_vccz pok11
    s_sub_u32 s18, s18, 1
    s_cbranch_scc0 psp11
    s_endpgm
pok11:
    s_add_u32 s4, s35, 4096
    s_add_u32 s5, s35, 12288
    s_add_u32 s6, s34, 4096
    buffer_load_dwordx4 v[216:219], v6, s[20:23], s4 offen sc1
    buffer_load_dwordx4 v[220:223], v6, s[20:23], s5 offen sc1
    buffer_load_dwordx2 v[224:225], v7, s[20:23], s34 offen offset:2048 sc1
    buffer_load_dwordx2 v[226:227], v7, s[20:23], s6 offen offset:2048 sc1
    buffer_load_dwordx4 a[92:95], v33, s[20:23], s10 offen offset:3072 sc1
    s_add_u32 s8, s40, 8192
    s_add_u32 s9, s40, 24576
    s_add_u32 s10, s40, 40960
    buffer_load_dwordx4 a[96:99], v5, s[20:23], s8 offen offset:0 sc1
    buffer_load_dwordx4 a[100:103], v5, s[20:23], s9 offen offset:0 sc1
    buffer_load_dwordx4 a[104:107], v33, s[20:23], s10 offen offset:0 sc1
    buffer_load_dwordx4 a[108:111], v5, s[20:23], s8 offen offset:1024 sc1
    s_mov_b32 s19, 33030144
    buffer_load_dword v48, v29, s[20:23], s19 offen sc1
    s_waitcnt vmcnt(9)
    v_mul_f32 v216, s49, v216
    v_mul_f32 v217, s49, v217
    v_mul_f32 v218, s49, v218
    v_mul_f32 v219, s49, v219
    s_waitcnt vmcnt(8)
    v_fma_f32 v220, v220, s49, v35
    v_fma_f32 v221, v221, s49, v35
    v_fma_f32 v222, v222, s49, v35
    v_fma_f32 v223, v223, s49, v35
    v_fma_f32 v220, -v216, v216, v220
    v_fma_f32 v221, -v217, v217, v221
    v_fma_f32 v222, -v218, v218, v222
    v_fma_f32 v223, -v219, v219, v223
    v_max_f32 v220, v35, v220
    v_max_f32 v221, v35, v221
    v_max_f32 v222, v35, v222
    v_max_f32 v223, v35, v223
    v_rsq_f32 v220, v220
    v_rsq_f32 v221, v221
    v_rsq_f32 v222, v222
    v_rsq_f32 v223, v223
    s_waitcnt vmcnt(7)
    ds_write_b64 v8, v[224:225] offset:2048
    v_lshlrev_b32 v228, 16, v224
    s_waitcnt vmcnt(0)
    v_cmp_gt_u32 vcc, s33, v48
    s_nop 1
    s_cbranch_vccz pok12
    s_mov_b32 s18, 40000
    s_mov_b32 s19, 33030144
psp12:
    s_sleep 2
    buffer_load_dword v48, v29, s[20:23], s19 offen sc1
    s_waitcnt vmcnt(0)
    v_cmp_gt_u32 vcc, s33, v48
    s_nop 1
    s_cbranch_vccz pok12
    s_sub_u32 s18, s18, 1
    s_cbranch_scc0 psp12
    s_endpgm
pok12:
    v_and_b32 v229, 0xffff0000, v224
    v_lshlrev_b32 v230, 16, v225
    v_and_b32 v231, 0xffff0000, v225
    v_sub_f32 v228, v228, v216
    v_sub_f32 v229, v229, v217
    v_sub_f32 v230, v230, v218
    v_sub_f32 v231, v231, v219
    v_mul_f32 v228, v228, v220
    s_add_u32 m0, s39, 0
    s_add_u32 s12, s38, 0
    buffer_load_dwordx4 v14, s[20:23], s12 offen sc1 lds
    v_mul_f32 v229, v229, v221
    v_mul_f32 v230, v230, v222
    v_mul_f32 v231, v231, v223
    v_cvt_pk_bf16_f32 v236, v228, v229
    v_cvt_pk_bf16_f32 v237, v230, v231
    ds_write_b64 v8, v[236:237] offset:31232
    ds_write_b64 v8, v[226:227] offset:6144
    v_lshlrev_b32 v232, 16, v226
    s_add_u32 m0, s39, 4096
    s_add_u32 s12, s38, 131072
    buffer_load_dwordx4 v14, s[20:23], s12 offen sc1 lds
    v_and_b32 v233, 0xffff0000, v226
    v_lshlrev_b32 v234, 16, v227
    v_and_b32 v235, 0xffff0000, v227
    v_sub_f32 v232, v232, v216
    v_sub_f32 v233, v233, v217
    v_sub_f32 v234, v234, v218
    v_sub_f32 v235, v235, v219
    v_mul_f32 v232, v232, v220
    s_add_u32 m0, s39, 8192
    s_add_u32 s12, s38, 262144
    buffer_load_dwordx4 v14, s[20:23], s12 offen sc1 lds
    v_mul_f32 v233, v233, v221
    v_mul_f32 v234, v234, v222
    v_mul_f32 v235, v235, v223
    v_cvt_pk_bf16_f32 v238, v232, v233
    v_cvt_pk_bf16_f32 v239, v234, v235
    ds_write_b64 v8, v[238:239] offset:35840
    s_waitcnt lgkmcnt(0)
    s_barrier
    ds_read_b128 v[84:87], v10 offset:2240
    ds_read_b128 v[88:91], v10 offset:2752
    ds_read_b128 v[92:95], v10 offset:3264
    ds_read_b128 v[96:99], v10 offset:3776
    s_add_u32 m0, s39, 12288
    s_add_u32 s12, s38, 393216
    buffer_load_dwordx4 v14, s[20:23], s12 offen sc1 lds
    s_add_u32 m0, s39, 16384
    s_add_u32 s12, s38, 524288
    buffer_load_dwordx4 v14, s[20:23], s12 offen sc1 lds
    s_waitcnt lgkmcnt(3)
    v_mfma_f32_16x16x32_bf16 v[68:71], a[192:195], v[84:87], v[68:71]
    ds_read_b128 v[100:103], v10 offset:2176
    v_mfma_f32_16x16x32_bf16 v[72:75], a[196:199], v[84:87], v[72:75]
    ds_read_b128 v[104:107], v10 offset:2688
    v_mfma_f32_16x16x32_bf16 v[76:79], a[200:203], v[84:87], v[76:79]
    ds_read_b128 v[108:111], v10 offset:3200
    v_mfma_f32_16x16x32_bf16 v[80:83], a[204:207], v[84:87], v[80:83]
    s_add_u32 m0, s39, 20480
    s_add_u32 s12, s38, 655360
    buffer_load_dwordx4 v14, s[20:23], s12 offen sc1 lds
    s_waitcnt lgkmcnt(5)
    v_mfma_f32_16x16x32_bf16 v[72:75], a[192:195], v[88:91], v[72:75]
    ds_read_b128 v[112:115], v10 offset:3712
    v_mfma_f32_16x16x32_bf16 v[76:79], a[196:199], v[88:91], v[76:79]
    ds_read_b128 v[116:119], v10 offset:2112
    v_mfma_f32_16x16x32_bf16 v[80:83], a[200:203], v[88:91], v[80:83]
    ds_read_b128 v[120:123], v10 offset:2624
    s_waitcnt lgkmcnt(7)
    v_mfma_f32_16x16x32_bf16 v[76:79], a[192:195], v[92:95], v[76:79]
    s_add_u32 m0, s39, 24576
    s_add_u32 s12, s38, 786432
    buffer_load_dwordx4 v14, s[20:23], s12 offen sc1 lds
    v_mfma_f32_16x16x32_bf16 v[80:83], a[196:199], v[92:95], v[80:83]
    ds_read_b128 v[124:127], v10 offset:3136
    s_waitcnt lgkmcnt(7)
    v_mfma_f32_16x16x32_bf16 v[80:83], a[192:195], v[96:99], v[80:83]
    ds_read_b128 v[128:131], v10 offset:3648
    s_waitcnt lgkmcnt(7)
    v_mfma_f32_16x16x32_bf16 v[68:71], a[208:211], v[100:103], v[68:71]
    ds_read_b128 v[132:135], v10 offset:2048
    v_mfma_f32_16x16x32_bf16 v[72:75], a[212:215], v[100:103], v[72:75]
    s_add_u32 m0, s39, 28672
    s_add_u32 s12, s38, 917504
    buffer_load_dwordx4 v14, s[20:23], s12 offen sc1 lds
    v_mfma_f32_16x16x32_bf16 v[76:79], a[216:219], v[100:103], v[76:79]
    ds_read_b128 v[136:139], v10 offset:2560
    v_mfma_f32_16x16x32_bf16 v[80:83], a[220:223], v[100:103], v[80:83]
    ds_read_b128 v[140:143], v10 offset:3072
    s_waitcnt lgkmcnt(9)
    v_mfma_f32_16x16x32_bf16 v[72:75], a[208:211], v[104:107], v[72:75]
    ds_read_b128 v[144:147], v10 offset:3584
    v_mfma_f32_16x16x32_bf16 v[76:79], a[212:215], v[104:107], v[76:79]
    s_add_u32 m0, s39, 32768
    s_add_u32 s12, s38, 1048576
    buffer_load_dwordx4 v14, s[20:23], s12 offen sc1 lds
    v_mfma_f32_16x16x32_bf16 v[80:83], a[216:219], v[104:107], v[80:83]
    s_waitcnt lgkmcnt(9)
    v_mfma_f32_16x16x32_bf16 v[76:79], a[208:211], v[108:111], v[76:79]
    v_mfma_f32_16x16x32_bf16 v[80:83], a[212:215], v[108:111], v[80:83]
    s_waitcnt lgkmcnt(8)
    v_mfma_f32_16x16x32_bf16 v[80:83], a[208:211], v[112:115], v[80:83]
    s_add_u32 m0, s39, 36864
    s_add_u32 s12, s38, 1179648
    buffer_load_dwordx4 v14, s[20:23], s12 offen sc1 lds
    s_waitcnt lgkmcnt(7)
    v_mfma_f32_16x16x32_bf16 v[68:71], a[224:227], v[116:119], v[68:71]
    v_mfma_f32_16x16x32_bf16 v[72:75], a[228:231], v[116:119], v[72:75]
    v_mfma_f32_16x16x32_bf16 v[76:79], a[232:235], v[116:119], v[76:79]
    v_mfma_f32_16x16x32_bf16 v[80:83], a[236:239], v[116:119], v[80:83]
    s_add_u32 m0, s39, 40960
    s_add_u32 s12, s38, 1310720
    buffer_load_dwordx4 v14, s[20:23], s12 offen sc1 lds
    s_waitcnt lgkmcnt(6)
    v_mfma_f32_16x16x32_bf16 v[72:75], a[224:227], v[120:123], v[72:75]
    v_mfma_f32_16x16x32_bf16 v[76:79], a[228:231], v[120:123], v[76:79]
    v_mfma_f32_16x16x32_bf16 v[80:83], a[232:235], v[120:123], v[80:83]
    s_waitcnt lgkmcnt(5)
    v_mfma_f32_16x16x32_bf16 v[76:79], a[224:227], v[124:127], v[76:79]
    s_add_u32 m0, s39, 45056
    s_add_u32 s12, s38, 1441792
    buffer_load_dwordx4 v14, s[20:23], s12 offen sc1 lds
    v_mfma_f32_16x16x32_bf16 v[80:83], a[228:231], v[124:127], v[80:83]
    s_waitcnt lgkmcnt(4)
    v_mfma_f32_16x16x32_bf16 v[80:83], a[224:227], v[128:131], v[80:83]
    s_waitcnt lgkmcnt(3)
    v_mfma_f32_16x16x32_bf16 v[68:71], a[240:243], v[132:135], v[68:71]
    v_mfma_f32_16x16x32_bf16 v[72:75], a[244:247], v[132:135], v[72:75]
    s_add_u32 m0, s39, 49152
    s_add_u32 s12, s38, 1572864
    buffer_load_dwordx4 v14, s[20:23], s12 offen sc1 lds
    v_mfma_f32_16x16x32_bf16 v[76:79], a[248:251], v[132:135], v[76:79]
    v_mfma_f32_16x16x32_bf16 v[80:83], a[252:255], v[132:135], v[80:83]
    s_waitcnt lgkmcnt(2)
    v_mfma_f32_16x16x32_bf16 v[72:75], a[240:243], v[136:139], v[72:75]
    v_mfma_f32_16x16x32_bf16 v[76:79], a[244:247], v[136:139], v[76:79]
    s_add_u32 m0, s39, 53248
    s_add_u32 s12, s38, 1703936
    buffer_load_dwordx4 v14, s[20:23], s12 offen sc1 lds
    v_mfma_f32_16x16x32_bf16 v[80:83], a[248:251], v[136:139], v[80:83]
    s_waitcnt lgkmcnt(1)
    v_mfma_f32_16x16x32_bf16 v[76:79], a[240:243], v[140:143], v[76:79]
    v_mfma_f32_16x16x32_bf16 v[80:83], a[244:247], v[140:143], v[80:83]
    s_waitcnt lgkmcnt(0)
    v_mfma_f32_16x16x32_bf16 v[80:83], a[240:243], v[144:147], v[80:83]
    s_add_u32 m0, s39, 57344
    s_add_u32 s12, s38, 1835008
    buffer_load_dwordx4 v14, s[20:23], s12 offen sc1 lds
    ds_write_b128 v11, v[68:71] offset:18432
    ds_write_b128 v11, v[72:75] offset:19584
    ds_write_b128 v11, v[76:79] offset:20736
    s_add_u32 m0, s39, 61440
    s_add_u32 s12, s38, 1966080
    buffer_load_dwordx4 v14, s[20:23], s12 offen sc1 lds
    ds_write_b128 v11, v[80:83] offset:21888
    ds_read_b128 v[164:167], v13 offset:2048
    s_waitcnt lgkmcnt(0)
    s_barrier
    ds_read_b128 v[148:151], v12 offset:18432
    ds_read_b128 v[156:159], v12 offset:23040
    ds_read_b128 v[152:155], v12 offset:18688
    ds_read_b128 v[160:163], v12 offset:23296
    v_lshlrev_b32 v168, 16, v164
    v_and_b32 v169, 0xffff0000, v164
    v_lshlrev_b32 v170, 16, v165
    v_and_b32 v171, 0xffff0000, v165
    v_lshlrev_b32 v172, 16, v166
    v_and_b32 v173, 0xffff0000, v166
    v_lshlrev_b32 v174, 16, v167
    v_and_b32 v175, 0xffff0000, v167
    s_waitcnt lgkmcnt(3)
    v_add_f32 v168, v168, v148
    v_add_f32 v169, v169, v149
    v_add_f32 v170, v170, v150
    v_add_f32 v171, v171, v151
    s_waitcnt lgkmcnt(1)
    v_add_f32 v172, v172, v152
    v_add_f32 v173, v173, v153
    v_add_f32 v174, v174, v154
    v_add_f32 v175, v175, v155
    v_add_f32 v168, v168, v156
    v_add_f32 v169, v169, v157
    v_add_f32 v170, v170, v158
    v_add_f32 v171, v171, v159
    s_waitcnt lgkmcnt(0)
    v_add_f32 v172, v172, v160
    v_add_f32 v173, v173, v161
    v_add_f32 v174, v174, v162
    v_add_f32 v175, v175, v163
    v_cvt_pk_bf16_f32 v176, v168, v169
    v_cvt_pk_bf16_f32 v177, v170, v171
    v_cvt_pk_bf16_f32 v178, v172, v173
    v_cvt_pk_bf16_f32 v179, v174, v175
    buffer_store_dwordx4 v[176:179], v5, s[20:23], s36 offen offset:2048 sc1
    s_nop 0
    s_branch layer
fin:
    v_xor_b32 v133, 8192, v22
    v_xor_b32 v134, 16384, v22
    v_xor_b32 v135, 24576, v22
    ds_write_b128 v22, v[104:107] offset:2048
    ds_write_b128 v22, v[120:123] offset:3072
    ds_write_b128 v22, v[108:111] offset:4096
    ds_write_b128 v22, v[124:127] offset:5120
    ds_write_b128 v22, v[112:115] offset:6144
    ds_write_b128 v22, v[128:131] offset:7168
    s_mov_b32 s19, 33128448
    buffer_load_dword v48, v28, s[20:23], s19 offen sc1
    v_lshlrev_b32 v136, 16, v240
    v_and_b32 v137, 0xffff0000, v240
    v_add_f32 v100, v100, v136
    v_add_f32 v101, v101, v137
    v_lshlrev_b32 v136, 16, v241
    v_and_b32 v137, 0xffff0000, v241
    v_add_f32 v102, v102, v136
    v_add_f32 v103, v103, v137
    v_lshlrev_b32 v136, 16, v242
    v_and_b32 v137, 0xffff0000, v242
    v_add_f32 v116, v116, v136
    v_add_f32 v117, v117, v137
    v_lshlrev_b32 v136, 16, v243
    v_and_b32 v137, 0xffff0000, v243
    v_add_f32 v118, v118, v136
    v_add_f32 v119, v119, v137
    s_waitcnt lgkmcnt(0)
    s_barrier
    ds_read_b128 v[180:183], v133 offset:2048
    ds_read_b128 v[184:187], v134 offset:4096
    ds_read_b128 v[188:191], v135 offset:6144
    ds_read_b128 v[192:195], v133 offset:3072
    ds_read_b128 v[196:199], v134 offset:5120
    ds_read_b128 v[200:203], v135 offset:7168
    s_waitcnt lgkmcnt(5)
    v_add_f32 v100, v100, v180
    v_add_f32 v101, v101, v181
    v_add_f32 v102, v102, v182
    v_add_f32 v103, v103, v183
    s_waitcnt lgkmcnt(4)
    v_add_f32 v100, v100, v184
    s_waitcnt vmcnt(0)
    v_cmp_gt_u32 vcc, s33, v48
    s_nop 1
    s_cbranch_vccz pok13
    s_mov_b32 s18, 40000
    s_mov_b32 s19, 33128448
psp13:
    s_sleep 2
    buffer_load_dword v48, v28, s[20:23], s19 offen sc1
    s_waitcnt vmcnt(0)
    v_cmp_gt_u32 vcc, s33, v48
    s_nop 1
    s_cbranch_vccz pok13
    s_sub_u32 s18, s18, 1
    s_cbranch_scc0 psp13
    s_endpgm
pok13:
    v_add_f32 v101, v101, v185
    v_add_f32 v102, v102, v186
    v_add_f32 v103, v103, v187
    s_add_u32 s14, s42, 16384
    buffer_load_dwordx4 v[52:55], v21, s[20:23], s14 offen offset:0 sc1
    s_waitcnt lgkmcnt(3)
    v_add_f32 v100, v100, v188
    v_add_f32 v101, v101, v189
    v_add_f32 v102, v102, v190
    buffer_load_dwordx4 v[56:59], v21, s[20:23], s14 offen offset:256 sc1
    v_add_f32 v103, v103, v191
    v_cvt_pk_bf16_f32 v140, v100, v101
    v_cvt_pk_bf16_f32 v141, v102, v103
    s_add_u32 s14, s42, 147456
    buffer_load_dwordx4 v[60:63], v21, s[20:23], s14 offen offset:0 sc1
    s_waitcnt lgkmcnt(2)
    v_add_f32 v116, v116, v192
    v_add_f32 v117, v117, v193
    v_add_f32 v118, v118, v194
    buffer_load_dwordx4 v[64:67], v21, s[20:23], s14 offen offset:256 sc1
    v_add_f32 v119, v119, v195
    s_waitcnt lgkmcnt(1)
    v_add_f32 v116, v116, v196
    v_add_f32 v117, v117, v197
    s_add_u32 s14, s42, 278528
    buffer_load_dwordx4 v[68:71], v21, s[20:23], s14 offen offset:0 sc1
    v_add_f32 v118, v118, v198
    v_add_f32 v119, v119, v199
    s_waitcnt lgkmcnt(0)
    v_add_f32 v116, v116, v200
    buffer_load_dwordx4 v[72:75], v21, s[20:23], s14 offen offset:256 sc1
    v_add_f32 v117, v117, v201
    v_add_f32 v118, v118, v202
    v_add_f32 v119, v119, v203
    s_add_u32 s14, s42, 409600
    buffer_load_dwordx4 v[76:79], v21, s[20:23], s14 offen offset:0 sc1
    v_cvt_pk_bf16_f32 v142, v116, v117
    v_cvt_pk_bf16_f32 v143, v118, v119
    ds_write_b128 v25, v[140:143]
    buffer_load_dwordx4 v[80:83], v21, s[20:23], s14 offen offset:256 sc1
    s_waitcnt lgkmcnt(0)
    ds_read_b64_tr_b16 v[144:145], v26
    ds_read_b64_tr_b16 v[146:147], v26 offset:320
    s_add_u32 s14, s42, 540672
    buffer_load_dwordx4 v[84:87], v21, s[20:23], s14 offen offset:0 sc1
    s_add_u32 s15, s51, 0
    s_waitcnt lgkmcnt(0)
    buffer_store_dwordx4 v[144:147], v27, s[28:31], s15 offen
    buffer_load_dwordx4 v[88:91], v21, s[20:23], s14 offen offset:256 sc1
    s_add_u32 s14, s42, 671744
    buffer_load_dwordx4 v[92:95], v21, s[20:23], s14 offen offset:0 sc1
    buffer_load_dwordx4 v[96:99], v21, s[20:23], s14 offen offset:256 sc1
    s_add_u32 s14, s42, 802816
    buffer_load_dwordx4 v[148:151], v21, s[20:23], s14 offen offset:0 sc1
    buffer_load_dwordx4 v[152:155], v21, s[20:23], s14 offen offset:256 sc1
    s_add_u32 s14, s42, 933888
    buffer_load_dwordx4 v[156:159], v21, s[20:23], s14 offen offset:0 sc1
    buffer_load_dwordx4 v[160:163], v21, s[20:23], s14 offen offset:256 sc1
    s_add_u32 s14, s42, 1064960
    buffer_load_dwordx4 v[164:167], v21, s[20:23], s14 offen offset:0 sc1
    buffer_load_dwordx4 v[168:171], v21, s[20:23], s14 offen offset:256 sc1
    s_add_u32 s14, s42, 1196032
    buffer_load_dwordx4 v[172:175], v21, s[20:23], s14 offen offset:0 sc1
    buffer_load_dwordx4 v[176:179], v21, s[20:23], s14 offen offset:256 sc1
    s_add_u32 s14, s42, 1327104
    buffer_load_dwordx4 v[232:235], v21, s[20:23], s14 offen offset:0 sc1
    buffer_load_dwordx4 v[236:239], v21, s[20:23], s14 offen offset:256 sc1
    buffer_load_dwordx4 v[240:243], v23, s[20:23], s44 offen offset:2048 sc1
    s_waitcnt vmcnt(23)
    v_mfma_f32_16x16x32_bf16 v[100:103], v[52:55], a[192:195], 0
    v_mfma_f32_16x16x32_bf16 v[104:107], v[52:55], a[196:199], 0
    v_mfma_f32_16x16x32_bf16 v[108:111], v[52:55], a[200:203], 0
    v_mfma_f32_16x16x32_bf16 v[112:115], v[52:55], a[204:207], 0
    s_waitcnt vmcnt(22)
    v_mfma_f32_16x16x32_bf16 v[116:119], v[56:59], a[192:195], 0
    v_mfma_f32_16x16x32_bf16 v[120:123], v[56:59], a[196:199], 0
    v_mfma_f32_16x16x32_bf16 v[124:127], v[56:59], a[200:203], 0
    v_mfma_f32_16x16x32_bf16 v[128:131], v[56:59], a[204:207], 0
    s_waitcnt vmcnt(21)
    v_mfma_f32_16x16x32_bf16 v[100:103], v[60:63], a[208:211], v[100:103]
    v_mfma_f32_16x16x32_bf16 v[104:107], v[60:63], a[212:215], v[104:107]
    v_mfma_f32_16x16x32_bf16 v[108:111], v[60:63], a[216:219], v[108:111]
    v_mfma_f32_16x16x32_bf16 v[112:115], v[60:63], a[220:223], v[112:115]
    s_waitcnt vmcnt(20)
    v_mfma_f32_16x16x32_bf16 v[116:119], v[64:67], a[208:211], v[116:119]
    v_mfma_f32_16x16x32_bf16 v[120:123], v[64:67], a[212:215], v[120:123]
    v_mfma_f32_16x16x32_bf16 v[124:127], v[64:67], a[216:219], v[124:127]
    v_mfma_f32_16x16x32_bf16 v[128:131], v[64:67], a[220:223], v[128:131]
    s_waitcnt vmcnt(19)
    v_mfma_f32_16x16x32_bf16 v[100:103], v[68:71], a[224:227], v[100:103]
    v_mfma_f32_16x16x32_bf16 v[104:107], v[68:71], a[228:231], v[104:107]
    v_mfma_f32_16x16x32_bf16 v[108:111], v[68:71], a[232:235], v[108:111]
    v_mfma_f32_16x16x32_bf16 v[112:115], v[68:71], a[236:239], v[112:115]
    s_waitcnt vmcnt(18)
    v_mfma_f32_16x16x32_bf16 v[116:119], v[72:75], a[224:227], v[116:119]
    v_mfma_f32_16x16x32_bf16 v[120:123], v[72:75], a[228:231], v[120:123]
    v_mfma_f32_16x16x32_bf16 v[124:127], v[72:75], a[232:235], v[124:127]
    v_mfma_f32_16x16x32_bf16 v[128:131], v[72:75], a[236:239], v[128:131]
    s_waitcnt vmcnt(17)
    v_mfma_f32_16x16x32_bf16 v[100:103], v[76:79], a[240:243], v[100:103]
    v_mfma_f32_16x16x32_bf16 v[104:107], v[76:79], a[244:247], v[104:107]
    v_mfma_f32_16x16x32_bf16 v[108:111], v[76:79], a[248:251], v[108:111]
    v_mfma_f32_16x16x32_bf16 v[112:115], v[76:79], a[252:255], v[112:115]
    s_waitcnt vmcnt(16)
    v_mfma_f32_16x16x32_bf16 v[116:119], v[80:83], a[240:243], v[116:119]
    v_mfma_f32_16x16x32_bf16 v[120:123], v[80:83], a[244:247], v[120:123]
    v_mfma_f32_16x16x32_bf16 v[124:127], v[80:83], a[248:251], v[124:127]
    v_mfma_f32_16x16x32_bf16 v[128:131], v[80:83], a[252:255], v[128:131]
    s_waitcnt vmcnt(15)
    v_mfma_f32_16x16x32_bf16 v[100:103], v[84:87], a[0:3], v[100:103]
    v_mfma_f32_16x16x32_bf16 v[104:107], v[84:87], a[4:7], v[104:107]
    v_mfma_f32_16x16x32_bf16 v[108:111], v[84:87], a[8:11], v[108:111]
    v_mfma_f32_16x16x32_bf16 v[112:115], v[84:87], a[12:15], v[112:115]
    s_waitcnt vmcnt(13)
    v_mfma_f32_16x16x32_bf16 v[116:119], v[88:91], a[0:3], v[116:119]
    v_mfma_f32_16x16x32_bf16 v[120:123], v[88:91], a[4:7], v[120:123]
    v_mfma_f32_16x16x32_bf16 v[124:127], v[88:91], a[8:11], v[124:127]
    v_mfma_f32_16x16x32_bf16 v[128:131], v[88:91], a[12:15], v[128:131]
    s_waitcnt vmcnt(12)
    v_mfma_f32_16x16x32_bf16 v[100:103], v[92:95], a[16:19], v[100:103]
    v_mfma_f32_16x16x32_bf16 v[104:107], v[92:95], a[20:23], v[104:107]
    v_mfma_f32_16x16x32_bf16 v[108:111], v[92:95], a[24:27], v[108:111]
    v_mfma_f32_16x16x32_bf16 v[112:115], v[92:95], a[28:31], v[112:115]
    s_waitcnt vmcnt(11)
    v_mfma_f32_16x16x32_bf16 v[116:119], v[96:99], a[16:19], v[116:119]
    v_mfma_f32_16x16x32_bf16 v[120:123], v[96:99], a[20:23], v[120:123]
    v_mfma_f32_16x16x32_bf16 v[124:127], v[96:99], a[24:27], v[124:127]
    v_mfma_f32_16x16x32_bf16 v[128:131], v[96:99], a[28:31], v[128:131]
    s_waitcnt vmcnt(10)
    v_mfma_f32_16x16x32_bf16 v[100:103], v[148:151], a[32:35], v[100:103]
    v_mfma_f32_16x16x32_bf16 v[104:107], v[148:151], a[36:39], v[104:107]
    v_mfma_f32_16x16x32_bf16 v[108:111], v[148:151], a[40:43], v[108:111]
    v_mfma_f32_16x16x32_bf16 v[112:115], v[148:151], a[44:47], v[112:115]
    s_waitcnt vmcnt(9)
    v_mfma_f32_16x16x32_bf16 v[116:119], v[152:155], a[32:35], v[116:119]
    v_mfma_f32_16x16x32_bf16 v[120:123], v[152:155], a[36:39], v[120:123]
    v_mfma_f32_16x16x32_bf16 v[124:127], v[152:155], a[40:43], v[124:127]
    v_mfma_f32_16x16x32_bf16 v[128:131], v[152:155], a[44:47], v[128:131]
    s_waitcnt vmcnt(8)
    v_mfma_f32_16x16x32_bf16 v[100:103], v[156:159], a[48:51], v[100:103]
    v_mfma_f32_16x16x32_bf16 v[104:107], v[156:159], a[52:55], v[104:107]
    v_mfma_f32_16x16x32_bf16 v[108:111], v[156:159], a[56:59], v[108:111]
    v_mfma_f32_16x16x32_bf16 v[112:115], v[156:159], a[60:63], v[112:115]
    s_waitcnt vmcnt(7)
    v_mfma_f32_16x16x32_bf16 v[116:119], v[160:163], a[48:51], v[116:119]
    v_mfma_f32_16x16x32_bf16 v[120:123], v[160:163], a[52:55], v[120:123]
    v_mfma_f32_16x16x32_bf16 v[124:127], v[160:163], a[56:59], v[124:127]
    v_mfma_f32_16x16x32_bf16 v[128:131], v[160:163], a[60:63], v[128:131]
    s_waitcnt vmcnt(6)
    v_mfma_f32_16x16x32_bf16 v[100:103], v[164:167], a[64:67], v[100:103]
    v_mfma_f32_16x16x32_bf16 v[104:107], v[164:167], a[68:71], v[104:107]
    v_mfma_f32_16x16x32_bf16 v[108:111], v[164:167], a[72:75], v[108:111]
    v_mfma_f32_16x16x32_bf16 v[112:115], v[164:167], a[76:79], v[112:115]
    s_waitcnt vmcnt(5)
    v_mfma_f32_16x16x32_bf16 v[116:119], v[168:171], a[64:67], v[116:119]
    v_mfma_f32_16x16x32_bf16 v[120:123], v[168:171], a[68:71], v[120:123]
    v_mfma_f32_16x16x32_bf16 v[124:127], v[168:171], a[72:75], v[124:127]
    v_mfma_f32_16x16x32_bf16 v[128:131], v[168:171], a[76:79], v[128:131]
    s_waitcnt vmcnt(4)
    v_mfma_f32_16x16x32_bf16 v[100:103], v[172:175], a[80:83], v[100:103]
    v_mfma_f32_16x16x32_bf16 v[104:107], v[172:175], a[84:87], v[104:107]
    v_mfma_f32_16x16x32_bf16 v[108:111], v[172:175], a[88:91], v[108:111]
    v_mfma_f32_16x16x32_bf16 v[112:115], v[172:175], a[92:95], v[112:115]
    s_waitcnt vmcnt(3)
    v_mfma_f32_16x16x32_bf16 v[116:119], v[176:179], a[80:83], v[116:119]
    v_mfma_f32_16x16x32_bf16 v[120:123], v[176:179], a[84:87], v[120:123]
    v_mfma_f32_16x16x32_bf16 v[124:127], v[176:179], a[88:91], v[124:127]
    v_mfma_f32_16x16x32_bf16 v[128:131], v[176:179], a[92:95], v[128:131]
    s_waitcnt vmcnt(2)
    v_mfma_f32_16x16x32_bf16 v[100:103], v[232:235], a[96:99], v[100:103]
    v_mfma_f32_16x16x32_bf16 v[104:107], v[232:235], a[100:103], v[104:107]
    v_mfma_f32_16x16x32_bf16 v[108:111], v[232:235], a[104:107], v[108:111]
    v_mfma_f32_16x16x32_bf16 v[112:115], v[232:235], a[108:111], v[112:115]
    s_waitcnt vmcnt(1)
    v_mfma_f32_16x16x32_bf16 v[116:119], v[236:239], a[96:99], v[116:119]
    v_mfma_f32_16x16x32_bf16 v[120:123], v[236:239], a[100:103], v[120:123]
    v_mfma_f32_16x16x32_bf16 v[124:127], v[236:239], a[104:107], v[124:127]
    v_mfma_f32_16x16x32_bf16 v[128:131], v[236:239], a[108:111], v[128:131]
    v_xor_b32 v133, 8192, v22
    v_xor_b32 v134, 16384, v22
    v_xor_b32 v135, 24576, v22
    ds_write_b128 v22, v[104:107] offset:34816
    s_nop 1
    ds_write_b128 v22, v[120:123] offset:35840
    ds_write_b128 v22, v[108:111] offset:36864
    ds_write_b128 v22, v[124:127] offset:37888
    ds_write_b128 v22, v[112:115] offset:38912
    ds_write_b128 v22, v[128:131] offset:39936
    s_waitcnt vmcnt(0)
    v_lshlrev_b32 v136, 16, v240
    v_and_b32 v137, 0xffff0000, v240
    v_add_f32 v100, v100, v136
    v_add_f32 v101, v101, v137
    v_lshlrev_b32 v136, 16, v241
    v_and_b32 v137, 0xffff0000, v241
    v_add_f32 v102, v102, v136
    v_add_f32 v103, v103, v137
    v_lshlrev_b32 v136, 16, v242
    v_and_b32 v137, 0xffff0000, v242
    v_add_f32 v116, v116, v136
    v_add_f32 v117, v117, v137
    v_lshlrev_b32 v136, 16, v243
    v_and_b32 v137, 0xffff0000, v243
    v_add_f32 v118, v118, v136
    v_add_f32 v119, v119, v137
    s_waitcnt lgkmcnt(0)
    s_barrier
    ds_read_b128 v[180:183], v133 offset:34816
    ds_read_b128 v[184:187], v134 offset:36864
    ds_read_b128 v[188:191], v135 offset:38912
    ds_read_b128 v[192:195], v133 offset:35840
    ds_read_b128 v[196:199], v134 offset:37888
    ds_read_b128 v[200:203], v135 offset:39936
    s_waitcnt lgkmcnt(5)
    v_add_f32 v100, v100, v180
    v_add_f32 v101, v101, v181
    v_add_f32 v102, v102, v182
    v_add_f32 v103, v103, v183
    s_waitcnt lgkmcnt(4)
    v_add_f32 v100, v100, v184
    v_add_f32 v101, v101, v185
    v_add_f32 v102, v102, v186
    v_add_f32 v103, v103, v187
    s_waitcnt lgkmcnt(3)
    v_add_f32 v100, v100, v188
    v_add_f32 v101, v101, v189
    v_add_f32 v102, v102, v190
    v_add_f32 v103, v103, v191
    v_cvt_pk_bf16_f32 v140, v100, v101
    v_cvt_pk_bf16_f32 v141, v102, v103
    s_waitcnt lgkmcnt(2)
    v_add_f32 v116, v116, v192
    v_add_f32 v117, v117, v193
    v_add_f32 v118, v118, v194
    v_add_f32 v119, v119, v195
    s_waitcnt lgkmcnt(1)
    v_add_f32 v116, v116, v196
    v_add_f32 v117, v117, v197
    v_add_f32 v118, v118, v198
    v_add_f32 v119, v119, v199
    s_waitcnt lgkmcnt(0)
    v_add_f32 v116, v116, v200
    v_add_f32 v117, v117, v201
    v_add_f32 v118, v118, v202
    v_add_f32 v119, v119, v203
    v_cvt_pk_bf16_f32 v142, v116, v117
    v_cvt_pk_bf16_f32 v143, v118, v119
    ds_write_b128 v25, v[140:143]
    s_waitcnt lgkmcnt(0)
    ds_read_b64_tr_b16 v[144:145], v26
    ds_read_b64_tr_b16 v[146:147], v26 offset:320
    s_add_u32 s15, s51, 1048576
    s_waitcnt lgkmcnt(0)
    buffer_store_dwordx4 v[144:147], v27, s[28:31], s15 offen
    s_endpgm
done:
    s_endpgm
.section .rodata,"a"
.p2align 6
.amdhsa_kernel interleave_layers__ssm_conv_s4__geglu_ffn__prompt_kernel
  .amdhsa_next_free_vgpr 512
  .amdhsa_next_free_sgpr 102
  .amdhsa_accum_offset 256
  .amdhsa_group_segment_fixed_size 0
  .amdhsa_kernarg_size 128
  .amdhsa_user_sgpr_count 2
  .amdhsa_user_sgpr_kernarg_segment_ptr 1
  .amdhsa_system_sgpr_workgroup_id_x 1
.end_amdhsa_kernel
```
